```python
import torch

def _softmax(x, axis=-1):
    return torch.softmax(x, dim=axis)

def _gelu(x):
    return torch.nn.functional.gelu(x, approximate='tanh')

def _silu(x):
    return torch.nn.functional.silu(x)

def _sigmoid(x):
    return torch.sigmoid(x)

def _layernorm(x, axis=-1, eps=1e-05):
    m = x.mean(dim=axis, keepdim=True)
    v = x.var(dim=axis, keepdim=True, unbiased=False)
    return (x - m) / torch.sqrt(v + eps)

def _scatter_add(tgt, idx, src, axis=0):
    return tgt.clone().index_add_(axis, idx, src)

def _segment_sum(src, seg, n):
    out = torch.zeros((n,) + src.shape[1:], dtype=src.dtype)
    return out.index_add_(0, seg, src)

def _pad(x, pw):
    flat = tuple((v for pair in reversed(pw) for v in pair))
    return torch.nn.functional.pad(x, flat)
kernel_name = 'adaLN_cond__mha_block__moe_arch_mod__prompt'

def setup_inputs():

    _w = lambda a: (lambda t: t.to(torch.bfloat16) if t.is_floating_point() else t)(torch.as_tensor(a))

    def _A_setup():
        B, S, D, H = (1, 2048, 1024, 32)
        return {'x': _w((lambda *s: torch.randn(*s, dtype=torch.bfloat16) * 0.05)(B, S, D)), 'wqkv': _w((lambda *s: torch.randn(*s, dtype=torch.bfloat16) * 0.05)(D, 3 * D)), 'wo': _w((lambda *s: torch.randn(*s, dtype=torch.bfloat16) * 0.05)(D, D))}
    _A_in = _A_setup()

    def _B_setup():
        B, S, D, F, C = (1, 2048, 1024, 3584, 1)
        return {'x': _w((lambda *s: torch.randn(*s, dtype=torch.bfloat16) * 0.05)(B, S, D)), 'w_r': _w((lambda *s: torch.randn(*s, dtype=torch.bfloat16) * 0.05)(D)), 'w_gate': _w((lambda *s: torch.randn(*s, dtype=torch.bfloat16) * 0.05)(D, F)), 'w_up': _w((lambda *s: torch.randn(*s, dtype=torch.bfloat16) * 0.05)(D, F)), 'w_down': _w((lambda *s: torch.randn(*s, dtype=torch.bfloat16) * 0.05)(F, D))}
    _B_in = _B_setup()
    return {'A_x': _A_in['x'], 'A_wqkv': _A_in['wqkv'], 'A_wo': _A_in['wo'], 'B_x': _B_in['x'], 'B_w_r': _B_in['w_r'], 'B_w_gate': _B_in['w_gate'], 'B_w_up': _B_in['w_up'], 'B_w_down': _B_in['w_down'], 'c': _w((lambda *s: torch.randn(*s, dtype=torch.bfloat16) * 0.1)(1, 1024) * 8.0), 'w_mod': _w((lambda *s: torch.randn(*s, dtype=torch.bfloat16) * 0.1)(1024, 6 * 1024) * 1024 ** (-0.5) * 8.0)}

def reference(A_x, A_wqkv, A_wo, B_x, B_w_r, B_w_gate, B_w_up, B_w_down, c, w_mod):

    def _A_ref(x, wqkv, wo):
        B, S, D = x.shape
        H = 32
        Dh = D // H
        qkv = (lambda x, *d: x.permute(*d))((x @ wqkv).reshape(B, S, 3, H, Dh), 2, 0, 3, 1, 4)
        q, k, v = (qkv[0], qkv[1], qkv[2])
        scores = torch.einsum('bhqd,bhkd->bhqk', q, k) * Dh ** (-0.5)
        p = _softmax(scores, axis=-1)
        o = torch.einsum('bhqk,bhkd->bhqd', p, v)
        return (lambda x, *d: x.permute(*d))(o, 0, 2, 1, 3).reshape(B, S, D) @ wo

    def _B_ref(x, w_r, w_gate, w_up, w_down):
        B, S, D = x.shape
        C = 1
        r = x @ w_r
        idx = torch.argsort(-r, axis=-1)[:, :C]
        idx_e = (lambda x, n, axis: torch.repeat_interleave(x, n, dim=axis))(idx.reshape(B, C, 1), D, axis=2)
        x_sel = (lambda x, i, axis: torch.take_along_dim(x, i, dim=axis))(x, idx_e, axis=1)
        g = _silu(x_sel @ w_gate)
        u = x_sel @ w_up
        y = g * u @ w_down
        r_sel = _sigmoid((lambda x, i, axis: torch.take_along_dim(x, i, dim=axis))(r, idx, axis=1))
        y = y * r_sel.reshape(B, C, 1)
        b_off = (torch.arange(B) * S).reshape(B, 1)
        flat_idx = (idx + b_off).reshape(B * C)
        zero = (x * 0.0).reshape(B * S, D)
        upd = _scatter_add(zero, flat_idx, y.reshape(B * C, D), axis=0)
        return x + upd.reshape(B, S, D)
    x = A_x
    mod = (_silu(c) @ w_mod).reshape(c.shape[0], 6, 1, -1)
    sa, ca, ga, sb, cb, gb = (mod[:, 0].clone(), mod[:, 1].clone(), mod[:, 2].clone(), mod[:, 3].clone(), mod[:, 4].clone(), mod[:, 5].clone())
    h = _layernorm(x, axis=-1) * (1 + ca) + sa
    x = x + ga * _A_ref(h, A_wqkv, A_wo)
    h = _layernorm(x, axis=-1) * (1 + cb) + sb
    x = x + gb * _B_ref(h, B_w_r, B_w_gate, B_w_up, B_w_down)
    return x
```

```asm
; @launch kernel=ka_mod_kernel grid=(256,1,1) block=(256,1,1) lds=512
; @launch kernel=kb_qkv_kernel grid=(256,1,1) block=(512,1,1) lds=139264
; @launch kernel=kc_attn_kernel grid=(256,1,1) block=(512,1,1) lds=139328
; @launch kernel=ke_tail_kernel grid=(256,1,1) block=(512,1,1) lds=152128
.amdgcn_target "amdgcn-amd-amdhsa--gfx950"
.text
.globl ka_mod_kernel
.p2align 8
.type ka_mod_kernel,@function
ka_mod_kernel:
    s_cmp_ge_u32 s2, 256
    s_cbranch_scc1 L_ka_done
    s_load_dwordx4 s[4:7], s[0:1], 64
    s_load_dwordx2 s[8:9], s[0:1], 96
    s_load_dwordx4 s[40:43], s[0:1], 0
    v_and_b32 v116, 63, v0
    v_lshrrev_b32 v117, 6, v0
    v_lshlrev_b32 v118, 12, v117
    v_lshl_add_u32 v118, v116, 4, v118
    v_readfirstlane_b32 s27, v117
    s_and_b32 s3, s2, 1
    s_lshl_b32 s3, s3, 7
    s_lshr_b32 s39, s2, 1
    s_add_u32 s3, s3, s39
    s_lshl_b32 s39, s3, 14
    s_lshr_b32 s28, s2, 3
    s_and_b32 s29, s2, 7
    s_lshr_b32 s30, s28, 3
    s_lshl_b32 s30, s30, 4
    s_lshl_b32 s31, s29, 1
    s_add_u32 s30, s30, s31
    s_and_b32 s31, s28, 1
    s_add_u32 s30, s30, s31
    s_bfe_u32 s26, s28, 0x20001
    s_mul_i32 s31, s26, 3145728
    s_lshl_b32 s32, s30, 6
    s_add_u32 s31, s31, s32
    s_lshl_b32 s25, s26, 9
    v_lshrrev_b32 v1, 2, v0
    v_and_b32 v2, 3, v0
    s_mov_b32 s32, 49152
    v_mul_lo_u32 v3, v1, s32
    v_lshl_add_u32 v3, v2, 4, v3
    v_lshlrev_b32 v4, 3, v1
    v_and_b32 v5, 31, v1
    s_movk_i32 s32, 6144
    v_mul_lo_u32 v5, v5, s32
    v_lshl_add_u32 v5, v2, 7, v5
    v_lshrrev_b32 v6, 7, v0
    v_lshl_add_u32 v5, v6, 11, v5
    s_mul_i32 s24, s28, 196608
    s_lshr_b32 s32, s29, 1
    s_lshl_b32 s32, s32, 9
    s_add_u32 s24, s24, s32
    s_waitcnt lgkmcnt(0)
    s_mov_b32 s12, s4
    s_mov_b32 s13, s5
    s_mov_b32 s14, 0x800
    s_mov_b32 s15, 0x00020000
    buffer_load_dwordx2 v[6:7], v4, s[12:15], s25 offen
    s_mov_b32 s16, s6
    s_mov_b32 s17, s7
    s_mov_b32 s18, 0xc00000
    s_mov_b32 s19, 0x00020000
    buffer_load_dwordx4 v[32:35], v3, s[16:19], s31 offen nt
    s_add_u32 s31, s31, 12288
    buffer_load_dwordx4 v[36:39], v3, s[16:19], s31 offen nt
    s_add_u32 s31, s31, 12288
    buffer_load_dwordx4 v[40:43], v3, s[16:19], s31 offen nt
    s_add_u32 s31, s31, 12288
    buffer_load_dwordx4 v[44:47], v3, s[16:19], s31 offen nt
    s_mov_b32 s44, s40
    s_mov_b32 s45, s41
    s_mov_b32 s46, 0x400000
    s_mov_b32 s47, 0x00020000
    buffer_load_dwordx4 v[120:123], v118, s[44:47], s39 offen offset:0 nt
    buffer_load_dwordx4 v[124:127], v118, s[44:47], s39 offen offset:1024 nt
    buffer_load_dwordx4 v[128:131], v118, s[44:47], s39 offen offset:2048 nt
    buffer_load_dwordx4 v[132:135], v118, s[44:47], s39 offen offset:3072 nt
    s_mov_b32 s52, s42
    s_mov_b32 s53, s43
    s_mov_b32 s54, 0x600000
    s_mov_b32 s55, 0x00020000
    s_cmp_ge_u32 s28, 20
    s_cselect_b32 s32, 0x7fffffff, 0
    v_or_b32 v5, s32, v5
    s_cmp_ge_u32 s27, 2
    s_cselect_b32 s32, 0x7fffffff, 0
    v_or_b32 v62, s32, v5
    buffer_load_dword v60, v5, s[52:55], s24 offen
    s_add_u32 s24, s24, 4096
    buffer_load_dword v61, v62, s[52:55], s24 offen
    s_mov_b32 s20, s8
    s_mov_b32 s21, s9
    s_mov_b32 s22, 0x40000
    s_mov_b32 s23, 0x00020000
    s_add_u32 s48, s8, 0x100000
    s_addc_u32 s49, s9, 0
    s_mov_b32 s50, 0x400000
    s_mov_b32 s51, 0x00020000
    s_mov_b32 s60, 0x05040100
    s_mov_b32 s61, 0x07060302
    v_lshrrev_b32 v8, 4, v116
    v_lshlrev_b32 v8, 3, v8
    v_lshl_add_u32 v8, v2, 5, v8
    v_lshl_add_u32 v20, v117, 7, v8
    v_mov_b32 v100, 0
    v_mov_b32 v101, 0
    v_mov_b32 v102, 0
    v_mov_b32 v103, 0
    v_mov_b32 v104, 0
    v_mov_b32 v105, 0
    v_mov_b32 v106, 0
    v_mov_b32 v107, 0
    s_waitcnt vmcnt(10)
    v_lshlrev_b32 v8, 16, v6
    v_and_b32 v9, 0xffff0000, v6
    v_lshlrev_b32 v10, 16, v7
    v_and_b32 v11, 0xffff0000, v7
    s_mov_b32 s34, 0xbfb8aa3b
    v_mul_f32 v12, s34, v8
    v_mul_f32 v13, s34, v9
    v_mul_f32 v14, s34, v10
    v_mul_f32 v15, s34, v11
    v_exp_f32 v12, v12
    v_exp_f32 v13, v13
    v_exp_f32 v14, v14
    v_exp_f32 v15, v15
    s_nop 0
    v_add_f32 v12, 1.0, v12
    v_add_f32 v13, 1.0, v13
    v_add_f32 v14, 1.0, v14
    v_add_f32 v15, 1.0, v15
    v_rcp_f32 v12, v12
    v_rcp_f32 v13, v13
    v_rcp_f32 v14, v14
    v_rcp_f32 v15, v15
    s_nop 0
    v_mul_f32 v8, v8, v12
    v_mul_f32 v9, v9, v13
    v_mul_f32 v10, v10, v14
    v_mul_f32 v11, v11, v15
    v_cvt_pk_bf16_f32 v12, v8, v9
    v_cvt_pk_bf16_f32 v13, v10, v11
    s_cmp_lg_u32 s30, 0
    s_cbranch_scc1 L_ka_nosc
    s_add_u32 s33, s25, 196608
    buffer_store_dwordx2 v[12:13], v4, s[20:23], s33 offen
L_ka_nosc:
    s_waitcnt vmcnt(8)
    v_perm_b32 v24, v36, v32, s60
    v_perm_b32 v25, v36, v32, s61
    v_perm_b32 v26, v37, v33, s60
    v_perm_b32 v27, v37, v33, s61
    v_perm_b32 v28, v38, v34, s60
    v_perm_b32 v29, v38, v34, s61
    v_perm_b32 v30, v39, v35, s60
    v_perm_b32 v31, v39, v35, s61
    v_dot2c_f32_bf16 v100, v24, v12
    v_dot2c_f32_bf16 v101, v25, v12
    v_dot2c_f32_bf16 v102, v26, v12
    v_dot2c_f32_bf16 v103, v27, v12
    v_dot2c_f32_bf16 v104, v28, v12
    v_dot2c_f32_bf16 v105, v29, v12
    v_dot2c_f32_bf16 v106, v30, v12
    v_dot2c_f32_bf16 v107, v31, v12
    s_waitcnt vmcnt(6)
    v_perm_b32 v24, v44, v40, s60
    v_perm_b32 v25, v44, v40, s61
    v_perm_b32 v26, v45, v41, s60
    v_perm_b32 v27, v45, v41, s61
    v_perm_b32 v28, v46, v42, s60
    v_perm_b32 v29, v46, v42, s61
    v_perm_b32 v30, v47, v43, s60
    v_perm_b32 v31, v47, v43, s61
    v_dot2c_f32_bf16 v100, v24, v13
    v_dot2c_f32_bf16 v101, v25, v13
    v_dot2c_f32_bf16 v102, v26, v13
    v_dot2c_f32_bf16 v103, v27, v13
    v_dot2c_f32_bf16 v104, v28, v13
    v_dot2c_f32_bf16 v105, v29, v13
    v_dot2c_f32_bf16 v106, v30, v13
    v_dot2c_f32_bf16 v107, v31, v13
    s_nop 3
    v_permlane32_swap_b32 v100, v104
    v_permlane32_swap_b32 v101, v105
    v_permlane32_swap_b32 v102, v106
    v_permlane32_swap_b32 v103, v107
    v_add_f32 v100, v100, v104
    v_add_f32 v101, v101, v105
    v_add_f32 v102, v102, v106
    v_add_f32 v103, v103, v107
    s_nop 0
    v_permlane16_swap_b32 v100, v102
    v_permlane16_swap_b32 v101, v103
    s_nop 0
    v_add_f32 v100, v100, v102
    v_add_f32 v101, v101, v103
    s_nop 0
    v_add_f32_dpp v100, v100, v100 row_ror:4 row_mask:0xf bank_mask:0xf
    v_add_f32_dpp v101, v101, v101 row_ror:4 row_mask:0xf bank_mask:0xf
    s_nop 0
    v_add_f32_dpp v100, v100, v100 row_ror:8 row_mask:0xf bank_mask:0xf
    v_add_f32_dpp v101, v101, v101 row_ror:8 row_mask:0xf bank_mask:0xf
    ds_write_b64 v20, v[100:101]
    s_waitcnt vmcnt(2)
    v_lshlrev_b32 v136, 16, v120
    v_and_b32 v137, 0xffff0000, v120
    v_lshlrev_b32 v138, 16, v121
    v_and_b32 v139, 0xffff0000, v121
    v_lshlrev_b32 v140, 16, v122
    v_and_b32 v141, 0xffff0000, v122
    v_lshlrev_b32 v142, 16, v123
    v_and_b32 v143, 0xffff0000, v123
    v_lshlrev_b32 v144, 16, v124
    v_and_b32 v145, 0xffff0000, v124
    v_lshlrev_b32 v146, 16, v125
    v_and_b32 v147, 0xffff0000, v125
    v_lshlrev_b32 v148, 16, v126
    v_and_b32 v149, 0xffff0000, v126
    v_lshlrev_b32 v150, 16, v127
    v_and_b32 v151, 0xffff0000, v127
    v_lshlrev_b32 v152, 16, v128
    v_and_b32 v153, 0xffff0000, v128
    v_lshlrev_b32 v154, 16, v129
    v_and_b32 v155, 0xffff0000, v129
    v_lshlrev_b32 v156, 16, v130
    v_and_b32 v157, 0xffff0000, v130
    v_lshlrev_b32 v158, 16, v131
    v_and_b32 v159, 0xffff0000, v131
    v_lshlrev_b32 v160, 16, v132
    v_and_b32 v161, 0xffff0000, v132
    v_lshlrev_b32 v162, 16, v133
    v_and_b32 v163, 0xffff0000, v133
    v_lshlrev_b32 v164, 16, v134
    v_and_b32 v165, 0xffff0000, v134
    v_lshlrev_b32 v166, 16, v135
    v_and_b32 v167, 0xffff0000, v135
    v_add_f32 v168, v136, v137
    v_add_f32 v168, v168, v138
    v_add_f32 v168, v168, v139
    v_add_f32 v168, v168, v140
    v_add_f32 v168, v168, v141
    v_add_f32 v168, v168, v142
    v_add_f32 v168, v168, v143
    v_add_f32 v168, v168, v144
    v_add_f32 v168, v168, v145
    v_add_f32 v168, v168, v146
    v_add_f32 v168, v168, v147
    v_add_f32 v168, v168, v148
    v_add_f32 v168, v168, v149
    v_add_f32 v168, v168, v150
    v_add_f32 v168, v168, v151
    v_add_f32 v169, v152, v153
    v_add_f32 v169, v169, v154
    v_add_f32 v169, v169, v155
    v_add_f32 v169, v169, v156
    v_add_f32 v169, v169, v157
    v_add_f32 v169, v169, v158
    v_add_f32 v169, v169, v159
    v_add_f32 v169, v169, v160
    v_add_f32 v169, v169, v161
    v_add_f32 v169, v169, v162
    v_add_f32 v169, v169, v163
    v_add_f32 v169, v169, v164
    v_add_f32 v169, v169, v165
    v_add_f32 v169, v169, v166
    v_add_f32 v169, v169, v167
    s_nop 1
    s_nop 0
    v_add_f32_dpp v168, v168, v168 quad_perm:[1,0,3,2] row_mask:0xf bank_mask:0xf
    v_add_f32_dpp v169, v169, v169 quad_perm:[1,0,3,2] row_mask:0xf bank_mask:0xf
    s_nop 0
    v_add_f32_dpp v168, v168, v168 quad_perm:[2,3,0,1] row_mask:0xf bank_mask:0xf
    v_add_f32_dpp v169, v169, v169 quad_perm:[2,3,0,1] row_mask:0xf bank_mask:0xf
    s_nop 0
    v_add_f32_dpp v168, v168, v168 row_half_mirror row_mask:0xf bank_mask:0xf
    v_add_f32_dpp v169, v169, v169 row_half_mirror row_mask:0xf bank_mask:0xf
    s_nop 0
    v_add_f32_dpp v168, v168, v168 row_mirror row_mask:0xf bank_mask:0xf
    v_add_f32_dpp v169, v169, v169 row_mirror row_mask:0xf bank_mask:0xf
    v_mov_b32 v170, v168
    v_mov_b32 v171, v169
    s_nop 1
    v_permlane16_swap_b32 v170, v168
    v_permlane16_swap_b32 v171, v169
    s_nop 0
    v_add_f32 v168, v168, v170
    v_add_f32 v169, v169, v171
    v_mov_b32 v170, v168
    v_mov_b32 v171, v169
    s_nop 1
    v_permlane32_swap_b32 v170, v168
    v_permlane32_swap_b32 v171, v169
    s_nop 0
    v_add_f32 v168, v168, v170
    v_add_f32 v169, v169, v171
    s_mov_b32 s38, 0x3a800000
    v_mul_f32 v168, s38, v168
    v_mul_f32 v169, s38, v169
    v_sub_f32 v136, v136, v168
    v_sub_f32 v137, v137, v168
    v_sub_f32 v138, v138, v168
    v_sub_f32 v139, v139, v168
    v_sub_f32 v140, v140, v168
    v_sub_f32 v141, v141, v168
    v_sub_f32 v142, v142, v168
    v_sub_f32 v143, v143, v168
    v_sub_f32 v144, v144, v168
    v_sub_f32 v145, v145, v168
    v_sub_f32 v146, v146, v168
    v_sub_f32 v147, v147, v168
    v_sub_f32 v148, v148, v168
    v_sub_f32 v149, v149, v168
    v_sub_f32 v150, v150, v168
    v_sub_f32 v151, v151, v168
    v_sub_f32 v152, v152, v169
    v_sub_f32 v153, v153, v169
    v_sub_f32 v154, v154, v169
    v_sub_f32 v155, v155, v169
    v_sub_f32 v156, v156, v169
    v_sub_f32 v157, v157, v169
    v_sub_f32 v158, v158, v169
    v_sub_f32 v159, v159, v169
    v_sub_f32 v160, v160, v169
    v_sub_f32 v161, v161, v169
    v_sub_f32 v162, v162, v169
    v_sub_f32 v163, v163, v169
    v_sub_f32 v164, v164, v169
    v_sub_f32 v165, v165, v169
    v_sub_f32 v166, v166, v169
    v_sub_f32 v167, v167, v169
    v_mul_f32 v172, v136, v136
    v_fmac_f32 v172, v137, v137
    v_fmac_f32 v172, v138, v138
    v_fmac_f32 v172, v139, v139
    v_fmac_f32 v172, v140, v140
    v_fmac_f32 v172, v141, v141
    v_fmac_f32 v172, v142, v142
    v_fmac_f32 v172, v143, v143
    v_fmac_f32 v172, v144, v144
    v_fmac_f32 v172, v145, v145
    v_fmac_f32 v172, v146, v146
    v_fmac_f32 v172, v147, v147
    v_fmac_f32 v172, v148, v148
    v_fmac_f32 v172, v149, v149
    v_fmac_f32 v172, v150, v150
    v_fmac_f32 v172, v151, v151
    v_mul_f32 v173, v152, v152
    v_fmac_f32 v173, v153, v153
    v_fmac_f32 v173, v154, v154
    v_fmac_f32 v173, v155, v155
    v_fmac_f32 v173, v156, v156
    v_fmac_f32 v173, v157, v157
    v_fmac_f32 v173, v158, v158
    v_fmac_f32 v173, v159, v159
    v_fmac_f32 v173, v160, v160
    v_fmac_f32 v173, v161, v161
    v_fmac_f32 v173, v162, v162
    v_fmac_f32 v173, v163, v163
    v_fmac_f32 v173, v164, v164
    v_fmac_f32 v173, v165, v165
    v_fmac_f32 v173, v166, v166
    v_fmac_f32 v173, v167, v167
    s_nop 1
    s_nop 0
    v_add_f32_dpp v172, v172, v172 quad_perm:[1,0,3,2] row_mask:0xf bank_mask:0xf
    v_add_f32_dpp v173, v173, v173 quad_perm:[1,0,3,2] row_mask:0xf bank_mask:0xf
    s_nop 0
    v_add_f32_dpp v172, v172, v172 quad_perm:[2,3,0,1] row_mask:0xf bank_mask:0xf
    v_add_f32_dpp v173, v173, v173 quad_perm:[2,3,0,1] row_mask:0xf bank_mask:0xf
    s_nop 0
    v_add_f32_dpp v172, v172, v172 row_half_mirror row_mask:0xf bank_mask:0xf
    v_add_f32_dpp v173, v173, v173 row_half_mirror row_mask:0xf bank_mask:0xf
    s_nop 0
    v_add_f32_dpp v172, v172, v172 row_mirror row_mask:0xf bank_mask:0xf
    v_add_f32_dpp v173, v173, v173 row_mirror row_mask:0xf bank_mask:0xf
    v_mov_b32 v170, v172
    v_mov_b32 v171, v173
    s_nop 1
    v_permlane16_swap_b32 v170, v172
    v_permlane16_swap_b32 v171, v173
    s_nop 0
    v_add_f32 v172, v172, v170
    v_add_f32 v173, v173, v171
    v_mov_b32 v170, v172
    v_mov_b32 v171, v173
    s_nop 1
    v_permlane32_swap_b32 v170, v172
    v_permlane32_swap_b32 v171, v173
    s_nop 0
    v_add_f32 v172, v172, v170
    v_add_f32 v173, v173, v171
    v_mov_b32 v170, 0x3727c5ac
    v_fma_f32 v172, v172, s38, v170
    v_fma_f32 v173, v173, s38, v170
    v_rsq_f32 v172, v172
    v_rsq_f32 v173, v173
    s_nop 0
    v_mul_f32 v136, v136, v172
    v_mul_f32 v137, v137, v172
    v_mul_f32 v138, v138, v172
    v_mul_f32 v139, v139, v172
    v_mul_f32 v140, v140, v172
    v_mul_f32 v141, v141, v172
    v_mul_f32 v142, v142, v172
    v_mul_f32 v143, v143, v172
    v_mul_f32 v144, v144, v172
    v_mul_f32 v145, v145, v172
    v_mul_f32 v146, v146, v172
    v_mul_f32 v147, v147, v172
    v_mul_f32 v148, v148, v172
    v_mul_f32 v149, v149, v172
    v_mul_f32 v150, v150, v172
    v_mul_f32 v151, v151, v172
    v_cvt_pk_f16_f32 v120, v136, v137
    v_cvt_pk_f16_f32 v121, v138, v139
    v_cvt_pk_f16_f32 v122, v140, v141
    v_cvt_pk_f16_f32 v123, v142, v143
    v_cvt_pk_f16_f32 v124, v144, v145
    v_cvt_pk_f16_f32 v125, v146, v147
    v_cvt_pk_f16_f32 v126, v148, v149
    v_cvt_pk_f16_f32 v127, v150, v151
    v_mul_f32 v152, v152, v173
    v_mul_f32 v153, v153, v173
    v_mul_f32 v154, v154, v173
    v_mul_f32 v155, v155, v173
    v_mul_f32 v156, v156, v173
    v_mul_f32 v157, v157, v173
    v_mul_f32 v158, v158, v173
    v_mul_f32 v159, v159, v173
    v_mul_f32 v160, v160, v173
    v_mul_f32 v161, v161, v173
    v_mul_f32 v162, v162, v173
    v_mul_f32 v163, v163, v173
    v_mul_f32 v164, v164, v173
    v_mul_f32 v165, v165, v173
    v_mul_f32 v166, v166, v173
    v_mul_f32 v167, v167, v173
    v_cvt_pk_f16_f32 v128, v152, v153
    v_cvt_pk_f16_f32 v129, v154, v155
    v_cvt_pk_f16_f32 v130, v156, v157
    v_cvt_pk_f16_f32 v131, v158, v159
    v_cvt_pk_f16_f32 v132, v160, v161
    v_cvt_pk_f16_f32 v133, v162, v163
    v_cvt_pk_f16_f32 v134, v164, v165
    v_cvt_pk_f16_f32 v135, v166, v167
    v_lshrrev_b32 v119, 3, v116
    v_lshlrev_b32 v119, 14, v119
    v_and_b32 v114, 7, v116
    v_lshl_add_u32 v119, v114, 4, v119
    v_lshl_add_u32 v119, v117, 8, v119
    s_lshr_b32 s56, s3, 4
    s_lshl_b32 s56, s56, 18
    s_and_b32 s57, s3, 15
    s_lshl_b32 s57, s57, 10
    s_add_u32 s56, s56, s57
    s_add_u32 s57, s56, 0x20000
    buffer_store_dwordx4 v[120:123], v119, s[48:51], s56 offen offset:0
    buffer_store_dwordx4 v[124:127], v119, s[48:51], s57 offen offset:0
    buffer_store_dwordx4 v[128:131], v119, s[48:51], s56 offen offset:128
    buffer_store_dwordx4 v[132:135], v119, s[48:51], s57 offen offset:128
    s_waitcnt lgkmcnt(0)
    s_barrier
    s_cmp_lg_u32 s27, 0
    s_cbranch_scc1 L_ka_done
    v_and_b32 v4, 31, v0
    v_lshlrev_b32 v4, 2, v4
    ds_read_b32 v12, v4 offset:0
    ds_read_b32 v13, v4 offset:128
    ds_read_b32 v14, v4 offset:256
    ds_read_b32 v15, v4 offset:384
    v_bfe_u32 v5, v0, 3, 2
    v_and_b32 v6, 7, v0
    v_lshlrev_b32 v5, 6, v5
    v_lshl_add_u32 v5, v6, 2, v5
    s_and_b32 s33, s30, 31
    s_lshl_b32 s33, s33, 8
    s_cmp_ge_u32 s30, 32
    s_cselect_b32 s34, 0, 32
    s_add_u32 s33, s33, s34
    s_lshl_b32 s34, s26, 13
    s_add_u32 s33, s33, s34
    s_add_u32 s33, s33, 32768
    s_waitcnt lgkmcnt(0)
    v_add_f32 v12, v12, v13
    v_add_f32 v14, v14, v15
    v_add_f32 v12, v12, v14
    buffer_store_dword v12, v5, s[20:23], s33 offen
L_ka_done:
    s_endpgm
.globl kb_qkv_kernel
.p2align 8
.type kb_qkv_kernel,@function
kb_qkv_kernel:
    s_cmp_ge_u32 s2, 256
    s_cbranch_scc1 L_kb_done
    s_load_dwordx2 s[4:5], s[0:1], 8
    s_load_dwordx2 s[8:9], s[0:1], 96
    s_load_dwordx2 s[6:7], s[0:1], 72
    s_and_b32 s24, s2, 7
    s_lshr_b32 s25, s2, 3
    s_and_b32 s26, s24, 1
    s_lshr_b32 s27, s24, 1
    s_and_b32 s28, s25, 7
    s_lshr_b32 s29, s25, 3
    s_lshl_b32 s26, s26, 3
    s_add_u32 s26, s26, s28
    s_lshl_b32 s27, s27, 2
    s_add_u32 s27, s27, s29
    v_bfe_u32 v1, v0, 6, 2
    v_lshrrev_b32 v3, 6, v0
    v_and_b32 v2, 63, v0
    v_readfirstlane_b32 s30, v1
    v_readfirstlane_b32 s43, v3
    s_mov_b32 s14, 4194304
    s_mov_b32 s15, 0x00020000
    s_mov_b32 s18, 6291456
    s_mov_b32 s19, 0x00020000
    s_and_b32 s31, s30, 1
    s_lshr_b32 s32, s30, 1
    s_lshl_b32 s33, s26, 18
    s_lshl_b32 s34, s27, 7
    s_lshl_b32 s35, s30, 12
    s_lshl_b32 s36, s30, 11
    s_cmp_lt_u32 s43, 4
    s_cbranch_scc1 L_kb_compute
    v_lshlrev_b32 v19, 4, v2
    s_lshl_b32 s37, s30, 0
    s_add_u32 s37, 0, 131072
    s_mov_b32 m0, s37
    v_lshrrev_b32 v3, 3, v2
    v_lshl_add_u32 v3, v1, 5, v3
    v_and_b32 v4, 7, v2
    v_lshlrev_b32 v5, 7, v3
    v_lshl_add_u32 v14, v4, 4, v5
    v_lshrrev_b32 v5, 4, v2
    v_xor_b32 v5, v4, v5
    v_lshlrev_b32 v5, 4, v5
    v_lshl_add_u32 v15, v3, 7, v5
    v_xor_b32 v16, 64, v15
    v_lshl_add_u32 v18, v4, 6, s37
    v_bfe_u32 v3, v2, 2, 3
    v_lshl_add_u32 v3, v1, 4, v3
    s_movk_i32 s37, 6144
    v_mul_lo_u32 v3, v3, s37
    v_lshrrev_b32 v4, 5, v2
    v_lshl_add_u32 v3, v4, 6, v3
    v_and_b32 v4, 3, v2
    v_lshl_add_u32 v17, v4, 4, v3
    s_waitcnt lgkmcnt(0)
    s_add_u32 s12, s8, 1048576
    s_addc_u32 s13, s9, 0
    s_mov_b32 s16, s4
    s_mov_b32 s17, s5
    s_add_u32 s38, s33, 0
    buffer_load_dwordx4 v[64:67], v14, s[12:15], s38 offen
    s_add_u32 s38, s33, 1024
    buffer_load_dwordx4 v[68:71], v14, s[12:15], s38 offen
    s_add_u32 s38, s33, 2048
    buffer_load_dwordx4 v[72:75], v14, s[12:15], s38 offen
    s_add_u32 s38, s33, 3072
    buffer_load_dwordx4 v[76:79], v14, s[12:15], s38 offen
    s_add_u32 m0, s36, 32768
    s_add_u32 s38, s34, 0
    buffer_load_dwordx4 v17, s[16:19], s38 offen lds
    s_add_u32 m0, s36, 33792
    s_add_u32 s38, s34, 49152
    buffer_load_dwordx4 v17, s[16:19], s38 offen lds
    s_add_u32 m0, s36, 40960
    s_add_u32 s38, s34, 2048
    buffer_load_dwordx4 v17, s[16:19], s38 offen lds
    s_add_u32 s38, s33, 16384
    buffer_load_dwordx4 v[80:83], v14, s[12:15], s38 offen
    s_add_u32 s38, s33, 17408
    buffer_load_dwordx4 v[84:87], v14, s[12:15], s38 offen
    s_add_u32 s38, s33, 18432
    buffer_load_dwordx4 v[88:91], v14, s[12:15], s38 offen
    s_add_u32 s38, s33, 19456
    buffer_load_dwordx4 v[92:95], v14, s[12:15], s38 offen
    s_add_u32 m0, s36, 57344
    s_add_u32 s38, s34, 393216
    buffer_load_dwordx4 v17, s[16:19], s38 offen lds
    s_add_u32 m0, s36, 58368
    s_add_u32 s38, s34, 442368
    buffer_load_dwordx4 v17, s[16:19], s38 offen lds
    s_add_u32 m0, s36, 65536
    s_add_u32 s38, s34, 395264
    buffer_load_dwordx4 v17, s[16:19], s38 offen lds
    s_barrier
    ds_read_b128 v[32:35], v18 offset:0
    ds_read_b128 v[36:39], v18 offset:16
    ds_read_b128 v[40:43], v18 offset:32
    ds_read_b128 v[44:47], v18 offset:48
    s_waitcnt vmcnt(10) lgkmcnt(0)
    s_add_u32 s38, s33, 32768
    buffer_load_dwordx4 v[96:99], v14, s[12:15], s38 offen
    v_fma_mix_f32 v48, v64, v32, v40 op_sel_hi:[1,0,0]
    v_fma_mix_f32 v49, v64, v33, v41 op_sel:[1,0,0] op_sel_hi:[1,0,0]
    v_fma_mix_f32 v50, v65, v34, v42 op_sel_hi:[1,0,0]
    v_fma_mix_f32 v51, v65, v35, v43 op_sel:[1,0,0] op_sel_hi:[1,0,0]
    v_fma_mix_f32 v52, v66, v36, v44 op_sel_hi:[1,0,0]
    v_fma_mix_f32 v53, v66, v37, v45 op_sel:[1,0,0] op_sel_hi:[1,0,0]
    v_fma_mix_f32 v54, v67, v38, v46 op_sel_hi:[1,0,0]
    v_fma_mix_f32 v55, v67, v39, v47 op_sel:[1,0,0] op_sel_hi:[1,0,0]
    v_cvt_pk_bf16_f32 v64, v48, v49
    v_cvt_pk_bf16_f32 v65, v50, v51
    v_cvt_pk_bf16_f32 v66, v52, v53
    v_cvt_pk_bf16_f32 v67, v54, v55
    s_add_u32 s38, s33, 33792
    buffer_load_dwordx4 v[100:103], v14, s[12:15], s38 offen
    v_fma_mix_f32 v48, v68, v32, v40 op_sel_hi:[1,0,0]
    v_fma_mix_f32 v49, v68, v33, v41 op_sel:[1,0,0] op_sel_hi:[1,0,0]
    v_fma_mix_f32 v50, v69, v34, v42 op_sel_hi:[1,0,0]
    v_fma_mix_f32 v51, v69, v35, v43 op_sel:[1,0,0] op_sel_hi:[1,0,0]
    v_fma_mix_f32 v52, v70, v36, v44 op_sel_hi:[1,0,0]
    v_fma_mix_f32 v53, v70, v37, v45 op_sel:[1,0,0] op_sel_hi:[1,0,0]
    v_fma_mix_f32 v54, v71, v38, v46 op_sel_hi:[1,0,0]
    v_fma_mix_f32 v55, v71, v39, v47 op_sel:[1,0,0] op_sel_hi:[1,0,0]
    v_cvt_pk_bf16_f32 v68, v48, v49
    v_cvt_pk_bf16_f32 v69, v50, v51
    v_cvt_pk_bf16_f32 v70, v52, v53
    v_cvt_pk_bf16_f32 v71, v54, v55
    s_add_u32 s38, s33, 34816
    buffer_load_dwordx4 v[104:107], v14, s[12:15], s38 offen
    v_fma_mix_f32 v48, v72, v32, v40 op_sel_hi:[1,0,0]
    v_fma_mix_f32 v49, v72, v33, v41 op_sel:[1,0,0] op_sel_hi:[1,0,0]
    v_fma_mix_f32 v50, v73, v34, v42 op_sel_hi:[1,0,0]
    v_fma_mix_f32 v51, v73, v35, v43 op_sel:[1,0,0] op_sel_hi:[1,0,0]
    v_fma_mix_f32 v52, v74, v36, v44 op_sel_hi:[1,0,0]
    v_fma_mix_f32 v53, v74, v37, v45 op_sel:[1,0,0] op_sel_hi:[1,0,0]
    v_fma_mix_f32 v54, v75, v38, v46 op_sel_hi:[1,0,0]
    v_fma_mix_f32 v55, v75, v39, v47 op_sel:[1,0,0] op_sel_hi:[1,0,0]
    v_cvt_pk_bf16_f32 v72, v48, v49
    v_cvt_pk_bf16_f32 v73, v50, v51
    v_cvt_pk_bf16_f32 v74, v52, v53
    v_cvt_pk_bf16_f32 v75, v54, v55
    s_add_u32 s38, s33, 35840
    buffer_load_dwordx4 v[108:111], v14, s[12:15], s38 offen
    v_fma_mix_f32 v48, v76, v32, v40 op_sel_hi:[1,0,0]
    v_fma_mix_f32 v49, v76, v33, v41 op_sel:[1,0,0] op_sel_hi:[1,0,0]
    v_fma_mix_f32 v50, v77, v34, v42 op_sel_hi:[1,0,0]
    v_fma_mix_f32 v51, v77, v35, v43 op_sel:[1,0,0] op_sel_hi:[1,0,0]
    v_fma_mix_f32 v52, v78, v36, v44 op_sel_hi:[1,0,0]
    v_fma_mix_f32 v53, v78, v37, v45 op_sel:[1,0,0] op_sel_hi:[1,0,0]
    v_fma_mix_f32 v54, v79, v38, v46 op_sel_hi:[1,0,0]
    v_fma_mix_f32 v55, v79, v39, v47 op_sel:[1,0,0] op_sel_hi:[1,0,0]
    v_cvt_pk_bf16_f32 v76, v48, v49
    v_cvt_pk_bf16_f32 v77, v50, v51
    v_cvt_pk_bf16_f32 v78, v52, v53
    v_cvt_pk_bf16_f32 v79, v54, v55
    ds_write_b128 v15, v[64:67] offset:0
    ds_write_b128 v16, v[68:71] offset:1024
    ds_write_b128 v15, v[72:75] offset:2048
    ds_write_b128 v16, v[76:79] offset:3072
    ds_read_b128 v[32:35], v18 offset:512
    ds_read_b128 v[36:39], v18 offset:528
    ds_read_b128 v[40:43], v18 offset:544
    ds_read_b128 v[44:47], v18 offset:560
    s_waitcnt vmcnt(11) lgkmcnt(4)
    s_barrier
    s_waitcnt vmcnt(7) lgkmcnt(0)
    s_add_u32 m0, s36, 81920
    s_add_u32 s38, s34, 786432
    buffer_load_dwordx4 v17, s[16:19], s38 offen lds
    v_fma_mix_f32 v48, v80, v32, v40 op_sel_hi:[1,0,0]
    v_fma_mix_f32 v49, v80, v33, v41 op_sel:[1,0,0] op_sel_hi:[1,0,0]
    v_fma_mix_f32 v50, v81, v34, v42 op_sel_hi:[1,0,0]
    v_fma_mix_f32 v51, v81, v35, v43 op_sel:[1,0,0] op_sel_hi:[1,0,0]
    v_fma_mix_f32 v52, v82, v36, v44 op_sel_hi:[1,0,0]
    v_fma_mix_f32 v53, v82, v37, v45 op_sel:[1,0,0] op_sel_hi:[1,0,0]
    v_fma_mix_f32 v54, v83, v38, v46 op_sel_hi:[1,0,0]
    v_fma_mix_f32 v55, v83, v39, v47 op_sel:[1,0,0] op_sel_hi:[1,0,0]
    v_cvt_pk_bf16_f32 v80, v48, v49
    v_cvt_pk_bf16_f32 v81, v50, v51
    v_cvt_pk_bf16_f32 v82, v52, v53
    v_cvt_pk_bf16_f32 v83, v54, v55
    v_fma_mix_f32 v48, v84, v32, v40 op_sel_hi:[1,0,0]
    v_fma_mix_f32 v49, v84, v33, v41 op_sel:[1,0,0] op_sel_hi:[1,0,0]
    v_fma_mix_f32 v50, v85, v34, v42 op_sel_hi:[1,0,0]
    v_fma_mix_f32 v51, v85, v35, v43 op_sel:[1,0,0] op_sel_hi:[1,0,0]
    s_add_u32 m0, s36, 82944
    s_add_u32 s38, s34, 835584
    buffer_load_dwordx4 v17, s[16:19], s38 offen lds
    v_fma_mix_f32 v52, v86, v36, v44 op_sel_hi:[1,0,0]
    v_fma_mix_f32 v53, v86, v37, v45 op_sel:[1,0,0] op_sel_hi:[1,0,0]
    v_fma_mix_f32 v54, v87, v38, v46 op_sel_hi:[1,0,0]
    v_fma_mix_f32 v55, v87, v39, v47 op_sel:[1,0,0] op_sel_hi:[1,0,0]
    v_cvt_pk_bf16_f32 v84, v48, v49
    v_cvt_pk_bf16_f32 v85, v50, v51
    v_cvt_pk_bf16_f32 v86, v52, v53
    v_cvt_pk_bf16_f32 v87, v54, v55
    v_fma_mix_f32 v48, v88, v32, v40 op_sel_hi:[1,0,0]
    v_fma_mix_f32 v49, v88, v33, v41 op_sel:[1,0,0] op_sel_hi:[1,0,0]
    v_fma_mix_f32 v50, v89, v34, v42 op_sel_hi:[1,0,0]
    v_fma_mix_f32 v51, v89, v35, v43 op_sel:[1,0,0] op_sel_hi:[1,0,0]
    v_fma_mix_f32 v52, v90, v36, v44 op_sel_hi:[1,0,0]
    v_fma_mix_f32 v53, v90, v37, v45 op_sel:[1,0,0] op_sel_hi:[1,0,0]
    v_fma_mix_f32 v54, v91, v38, v46 op_sel_hi:[1,0,0]
    v_fma_mix_f32 v55, v91, v39, v47 op_sel:[1,0,0] op_sel_hi:[1,0,0]
    s_add_u32 m0, s36, 90112
    s_add_u32 s38, s34, 788480
    buffer_load_dwordx4 v17, s[16:19], s38 offen lds
    v_cvt_pk_bf16_f32 v88, v48, v49
    v_cvt_pk_bf16_f32 v89, v50, v51
    v_cvt_pk_bf16_f32 v90, v52, v53
    v_cvt_pk_bf16_f32 v91, v54, v55
    v_fma_mix_f32 v48, v92, v32, v40 op_sel_hi:[1,0,0]
    v_fma_mix_f32 v49, v92, v33, v41 op_sel:[1,0,0] op_sel_hi:[1,0,0]
    v_fma_mix_f32 v50, v93, v34, v42 op_sel_hi:[1,0,0]
    v_fma_mix_f32 v51, v93, v35, v43 op_sel:[1,0,0] op_sel_hi:[1,0,0]
    v_fma_mix_f32 v52, v94, v36, v44 op_sel_hi:[1,0,0]
    v_fma_mix_f32 v53, v94, v37, v45 op_sel:[1,0,0] op_sel_hi:[1,0,0]
    v_fma_mix_f32 v54, v95, v38, v46 op_sel_hi:[1,0,0]
    v_fma_mix_f32 v55, v95, v39, v47 op_sel:[1,0,0] op_sel_hi:[1,0,0]
    v_cvt_pk_bf16_f32 v92, v48, v49
    v_cvt_pk_bf16_f32 v93, v50, v51
    v_cvt_pk_bf16_f32 v94, v52, v53
    v_cvt_pk_bf16_f32 v95, v54, v55
    ds_read_b128 v[32:35], v18 offset:1024
    ds_read_b128 v[36:39], v18 offset:1040
    ds_read_b128 v[40:43], v18 offset:1056
    ds_read_b128 v[44:47], v18 offset:1072
    ds_write_b128 v15, v[80:83] offset:16384
    ds_write_b128 v16, v[84:87] offset:17408
    ds_write_b128 v15, v[88:91] offset:18432
    ds_write_b128 v16, v[92:95] offset:19456
    s_waitcnt vmcnt(3) lgkmcnt(0)
    s_add_u32 s38, s33, 49152
    buffer_load_dwordx4 v[112:115], v14, s[12:15], s38 offen
    v_fma_mix_f32 v48, v96, v32, v40 op_sel_hi:[1,0,0]
    v_fma_mix_f32 v49, v96, v33, v41 op_sel:[1,0,0] op_sel_hi:[1,0,0]
    v_fma_mix_f32 v50, v97, v34, v42 op_sel_hi:[1,0,0]
    v_fma_mix_f32 v51, v97, v35, v43 op_sel:[1,0,0] op_sel_hi:[1,0,0]
    v_fma_mix_f32 v52, v98, v36, v44 op_sel_hi:[1,0,0]
    v_fma_mix_f32 v53, v98, v37, v45 op_sel:[1,0,0] op_sel_hi:[1,0,0]
    v_fma_mix_f32 v54, v99, v38, v46 op_sel_hi:[1,0,0]
    v_fma_mix_f32 v55, v99, v39, v47 op_sel:[1,0,0] op_sel_hi:[1,0,0]
    v_cvt_pk_bf16_f32 v96, v48, v49
    v_cvt_pk_bf16_f32 v97, v50, v51
    v_cvt_pk_bf16_f32 v98, v52, v53
    v_cvt_pk_bf16_f32 v99, v54, v55
    s_add_u32 s38, s33, 50176
    buffer_load_dwordx4 v[116:119], v14, s[12:15], s38 offen
    v_fma_mix_f32 v48, v100, v32, v40 op_sel_hi:[1,0,0]
    v_fma_mix_f32 v49, v100, v33, v41 op_sel:[1,0,0] op_sel_hi:[1,0,0]
    v_fma_mix_f32 v50, v101, v34, v42 op_sel_hi:[1,0,0]
    v_fma_mix_f32 v51, v101, v35, v43 op_sel:[1,0,0] op_sel_hi:[1,0,0]
    v_fma_mix_f32 v52, v102, v36, v44 op_sel_hi:[1,0,0]
    v_fma_mix_f32 v53, v102, v37, v45 op_sel:[1,0,0] op_sel_hi:[1,0,0]
    v_fma_mix_f32 v54, v103, v38, v46 op_sel_hi:[1,0,0]
    v_fma_mix_f32 v55, v103, v39, v47 op_sel:[1,0,0] op_sel_hi:[1,0,0]
    v_cvt_pk_bf16_f32 v100, v48, v49
    v_cvt_pk_bf16_f32 v101, v50, v51
    v_cvt_pk_bf16_f32 v102, v52, v53
    v_cvt_pk_bf16_f32 v103, v54, v55
    s_add_u32 s38, s33, 51200
    buffer_load_dwordx4 v[120:123], v14, s[12:15], s38 offen
    v_fma_mix_f32 v48, v104, v32, v40 op_sel_hi:[1,0,0]
    v_fma_mix_f32 v49, v104, v33, v41 op_sel:[1,0,0] op_sel_hi:[1,0,0]
    v_fma_mix_f32 v50, v105, v34, v42 op_sel_hi:[1,0,0]
    v_fma_mix_f32 v51, v105, v35, v43 op_sel:[1,0,0] op_sel_hi:[1,0,0]
    v_fma_mix_f32 v52, v106, v36, v44 op_sel_hi:[1,0,0]
    v_fma_mix_f32 v53, v106, v37, v45 op_sel:[1,0,0] op_sel_hi:[1,0,0]
    v_fma_mix_f32 v54, v107, v38, v46 op_sel_hi:[1,0,0]
    v_fma_mix_f32 v55, v107, v39, v47 op_sel:[1,0,0] op_sel_hi:[1,0,0]
    v_cvt_pk_bf16_f32 v104, v48, v49
    v_cvt_pk_bf16_f32 v105, v50, v51
    v_cvt_pk_bf16_f32 v106, v52, v53
    v_cvt_pk_bf16_f32 v107, v54, v55
    s_add_u32 s38, s33, 52224
    buffer_load_dwordx4 v[124:127], v14, s[12:15], s38 offen
    v_fma_mix_f32 v48, v108, v32, v40 op_sel_hi:[1,0,0]
    v_fma_mix_f32 v49, v108, v33, v41 op_sel:[1,0,0] op_sel_hi:[1,0,0]
    v_fma_mix_f32 v50, v109, v34, v42 op_sel_hi:[1,0,0]
    v_fma_mix_f32 v51, v109, v35, v43 op_sel:[1,0,0] op_sel_hi:[1,0,0]
    v_fma_mix_f32 v52, v110, v36, v44 op_sel_hi:[1,0,0]
    v_fma_mix_f32 v53, v110, v37, v45 op_sel:[1,0,0] op_sel_hi:[1,0,0]
    v_fma_mix_f32 v54, v111, v38, v46 op_sel_hi:[1,0,0]
    v_fma_mix_f32 v55, v111, v39, v47 op_sel:[1,0,0] op_sel_hi:[1,0,0]
    v_cvt_pk_bf16_f32 v108, v48, v49
    v_cvt_pk_bf16_f32 v109, v50, v51
    v_cvt_pk_bf16_f32 v110, v52, v53
    v_cvt_pk_bf16_f32 v111, v54, v55
    ds_read_b128 v[32:35], v18 offset:1536
    ds_read_b128 v[36:39], v18 offset:1552
    ds_read_b128 v[40:43], v18 offset:1568
    ds_read_b128 v[44:47], v18 offset:1584
    s_barrier
    s_add_u32 s38, s33, 65536
    buffer_load_dwordx4 v[128:131], v14, s[12:15], s38 offen
    s_add_u32 s38, s33, 66560
    buffer_load_dwordx4 v[132:135], v14, s[12:15], s38 offen
    s_waitcnt vmcnt(2) lgkmcnt(0)
    ds_write_b128 v15, v[96:99] offset:0
    v_fma_mix_f32 v48, v112, v32, v40 op_sel_hi:[1,0,0]
    v_fma_mix_f32 v49, v112, v33, v41 op_sel:[1,0,0] op_sel_hi:[1,0,0]
    v_fma_mix_f32 v50, v113, v34, v42 op_sel_hi:[1,0,0]
    v_fma_mix_f32 v51, v113, v35, v43 op_sel:[1,0,0] op_sel_hi:[1,0,0]
    v_fma_mix_f32 v52, v114, v36, v44 op_sel_hi:[1,0,0]
    v_fma_mix_f32 v53, v114, v37, v45 op_sel:[1,0,0] op_sel_hi:[1,0,0]
    v_fma_mix_f32 v54, v115, v38, v46 op_sel_hi:[1,0,0]
    v_fma_mix_f32 v55, v115, v39, v47 op_sel:[1,0,0] op_sel_hi:[1,0,0]
    s_add_u32 s38, s33, 67584
    buffer_load_dwordx4 v[136:139], v14, s[12:15], s38 offen
    s_add_u32 s38, s33, 68608
    buffer_load_dwordx4 v[140:143], v14, s[12:15], s38 offen
    ds_write_b128 v16, v[100:103] offset:1024
    v_cvt_pk_bf16_f32 v112, v48, v49
    v_cvt_pk_bf16_f32 v113, v50, v51
    v_cvt_pk_bf16_f32 v114, v52, v53
    v_cvt_pk_bf16_f32 v115, v54, v55
    v_fma_mix_f32 v48, v116, v32, v40 op_sel_hi:[1,0,0]
    v_fma_mix_f32 v49, v116, v33, v41 op_sel:[1,0,0] op_sel_hi:[1,0,0]
    v_fma_mix_f32 v50, v117, v34, v42 op_sel_hi:[1,0,0]
    v_fma_mix_f32 v51, v117, v35, v43 op_sel:[1,0,0] op_sel_hi:[1,0,0]
    s_add_u32 m0, s36, 106496
    s_add_u32 s38, s34, 1179648
    buffer_load_dwordx4 v17, s[16:19], s38 offen lds
    s_add_u32 m0, s36, 107520
    s_add_u32 s38, s34, 1228800
    buffer_load_dwordx4 v17, s[16:19], s38 offen lds
    ds_write_b128 v15, v[104:107] offset:2048
    v_fma_mix_f32 v52, v118, v36, v44 op_sel_hi:[1,0,0]
    v_fma_mix_f32 v53, v118, v37, v45 op_sel:[1,0,0] op_sel_hi:[1,0,0]
    v_fma_mix_f32 v54, v119, v38, v46 op_sel_hi:[1,0,0]
    v_fma_mix_f32 v55, v119, v39, v47 op_sel:[1,0,0] op_sel_hi:[1,0,0]
    v_cvt_pk_bf16_f32 v116, v48, v49
    v_cvt_pk_bf16_f32 v117, v50, v51
    v_cvt_pk_bf16_f32 v118, v52, v53
    v_cvt_pk_bf16_f32 v119, v54, v55
    s_add_u32 m0, s36, 114688
    s_add_u32 s38, s34, 1181696
    buffer_load_dwordx4 v17, s[16:19], s38 offen lds
    s_add_u32 s38, s33, 81920
    buffer_load_dwordx4 v[64:67], v14, s[12:15], s38 offen
    ds_write_b128 v16, v[108:111] offset:3072
    v_fma_mix_f32 v48, v120, v32, v40 op_sel_hi:[1,0,0]
    v_fma_mix_f32 v49, v120, v33, v41 op_sel:[1,0,0] op_sel_hi:[1,0,0]
    v_fma_mix_f32 v50, v121, v34, v42 op_sel_hi:[1,0,0]
    v_fma_mix_f32 v51, v121, v35, v43 op_sel:[1,0,0] op_sel_hi:[1,0,0]
    v_fma_mix_f32 v52, v122, v36, v44 op_sel_hi:[1,0,0]
    v_fma_mix_f32 v53, v122, v37, v45 op_sel:[1,0,0] op_sel_hi:[1,0,0]
    v_fma_mix_f32 v54, v123, v38, v46 op_sel_hi:[1,0,0]
    v_fma_mix_f32 v55, v123, v39, v47 op_sel:[1,0,0] op_sel_hi:[1,0,0]
    s_add_u32 s38, s33, 82944
    buffer_load_dwordx4 v[68:71], v14, s[12:15], s38 offen
    s_add_u32 s38, s33, 83968
    buffer_load_dwordx4 v[72:75], v14, s[12:15], s38 offen
    v_cvt_pk_bf16_f32 v120, v48, v49
    v_cvt_pk_bf16_f32 v121, v50, v51
    v_cvt_pk_bf16_f32 v122, v52, v53
    v_cvt_pk_bf16_f32 v123, v54, v55
    v_fma_mix_f32 v48, v124, v32, v40 op_sel_hi:[1,0,0]
    v_fma_mix_f32 v49, v124, v33, v41 op_sel:[1,0,0] op_sel_hi:[1,0,0]
    v_fma_mix_f32 v50, v125, v34, v42 op_sel_hi:[1,0,0]
    v_fma_mix_f32 v51, v125, v35, v43 op_sel:[1,0,0] op_sel_hi:[1,0,0]
    s_add_u32 s38, s33, 84992
    buffer_load_dwordx4 v[76:79], v14, s[12:15], s38 offen
    v_fma_mix_f32 v52, v126, v36, v44 op_sel_hi:[1,0,0]
    v_fma_mix_f32 v53, v126, v37, v45 op_sel:[1,0,0] op_sel_hi:[1,0,0]
    v_fma_mix_f32 v54, v127, v38, v46 op_sel_hi:[1,0,0]
    v_fma_mix_f32 v55, v127, v39, v47 op_sel:[1,0,0] op_sel_hi:[1,0,0]
    v_cvt_pk_bf16_f32 v124, v48, v49
    v_cvt_pk_bf16_f32 v125, v50, v51
    v_cvt_pk_bf16_f32 v126, v52, v53
    v_cvt_pk_bf16_f32 v127, v54, v55
    ds_read_b128 v[32:35], v18 offset:2048
    ds_read_b128 v[36:39], v18 offset:2064
    ds_read_b128 v[40:43], v18 offset:2080
    ds_read_b128 v[44:47], v18 offset:2096
    s_waitcnt lgkmcnt(4)
    s_barrier
    s_add_u32 m0, s36, 32768
    s_add_u32 s38, s34, 1572864
    buffer_load_dwordx4 v17, s[16:19], s38 offen lds
    s_add_u32 m0, s36, 33792
    s_add_u32 s38, s34, 1622016
    buffer_load_dwordx4 v17, s[16:19], s38 offen lds
    s_waitcnt vmcnt(9) lgkmcnt(0)
    ds_write_b128 v15, v[112:115] offset:16384
    v_fma_mix_f32 v48, v128, v32, v40 op_sel_hi:[1,0,0]
    v_fma_mix_f32 v49, v128, v33, v41 op_sel:[1,0,0] op_sel_hi:[1,0,0]
    v_fma_mix_f32 v50, v129, v34, v42 op_sel_hi:[1,0,0]
    v_fma_mix_f32 v51, v129, v35, v43 op_sel:[1,0,0] op_sel_hi:[1,0,0]
    v_fma_mix_f32 v52, v130, v36, v44 op_sel_hi:[1,0,0]
    v_fma_mix_f32 v53, v130, v37, v45 op_sel:[1,0,0] op_sel_hi:[1,0,0]
    v_fma_mix_f32 v54, v131, v38, v46 op_sel_hi:[1,0,0]
    v_fma_mix_f32 v55, v131, v39, v47 op_sel:[1,0,0] op_sel_hi:[1,0,0]
    v_cvt_pk_bf16_f32 v128, v48, v49
    v_cvt_pk_bf16_f32 v129, v50, v51
    s_add_u32 m0, s36, 40960
    s_add_u32 s38, s34, 1574912
    buffer_load_dwordx4 v17, s[16:19], s38 offen lds
    s_add_u32 s38, s33, 98304
    buffer_load_dwordx4 v[80:83], v14, s[12:15], s38 offen
    ds_write_b128 v16, v[116:119] offset:17408
    v_cvt_pk_bf16_f32 v130, v52, v53
    v_cvt_pk_bf16_f32 v131, v54, v55
    v_fma_mix_f32 v48, v132, v32, v40 op_sel_hi:[1,0,0]
    v_fma_mix_f32 v49, v132, v33, v41 op_sel:[1,0,0] op_sel_hi:[1,0,0]
    v_fma_mix_f32 v50, v133, v34, v42 op_sel_hi:[1,0,0]
    v_fma_mix_f32 v51, v133, v35, v43 op_sel:[1,0,0] op_sel_hi:[1,0,0]
    v_fma_mix_f32 v52, v134, v36, v44 op_sel_hi:[1,0,0]
    v_fma_mix_f32 v53, v134, v37, v45 op_sel:[1,0,0] op_sel_hi:[1,0,0]
    v_fma_mix_f32 v54, v135, v38, v46 op_sel_hi:[1,0,0]
    v_fma_mix_f32 v55, v135, v39, v47 op_sel:[1,0,0] op_sel_hi:[1,0,0]
    s_add_u32 s38, s33, 99328
    buffer_load_dwordx4 v[84:87], v14, s[12:15], s38 offen
    s_add_u32 s38, s33, 100352
    buffer_load_dwordx4 v[88:91], v14, s[12:15], s38 offen
    ds_write_b128 v15, v[120:123] offset:18432
    v_cvt_pk_bf16_f32 v132, v48, v49
    v_cvt_pk_bf16_f32 v133, v50, v51
    v_cvt_pk_bf16_f32 v134, v52, v53
    v_cvt_pk_bf16_f32 v135, v54, v55
    v_fma_mix_f32 v48, v136, v32, v40 op_sel_hi:[1,0,0]
    v_fma_mix_f32 v49, v136, v33, v41 op_sel:[1,0,0] op_sel_hi:[1,0,0]
    v_fma_mix_f32 v50, v137, v34, v42 op_sel_hi:[1,0,0]
    v_fma_mix_f32 v51, v137, v35, v43 op_sel:[1,0,0] op_sel_hi:[1,0,0]
    v_fma_mix_f32 v52, v138, v36, v44 op_sel_hi:[1,0,0]
    v_fma_mix_f32 v53, v138, v37, v45 op_sel:[1,0,0] op_sel_hi:[1,0,0]
    s_add_u32 s38, s33, 101376
    buffer_load_dwordx4 v[92:95], v14, s[12:15], s38 offen
    s_add_u32 m0, s36, 57344
    s_add_u32 s38, s34, 1966080
    buffer_load_dwordx4 v17, s[16:19], s38 offen lds
    ds_write_b128 v16, v[124:127] offset:19456
    v_fma_mix_f32 v54, v139, v38, v46 op_sel_hi:[1,0,0]
    v_fma_mix_f32 v55, v139, v39, v47 op_sel:[1,0,0] op_sel_hi:[1,0,0]
    v_cvt_pk_bf16_f32 v136, v48, v49
    v_cvt_pk_bf16_f32 v137, v50, v51
    v_cvt_pk_bf16_f32 v138, v52, v53
    v_cvt_pk_bf16_f32 v139, v54, v55
    v_fma_mix_f32 v48, v140, v32, v40 op_sel_hi:[1,0,0]
    v_fma_mix_f32 v49, v140, v33, v41 op_sel:[1,0,0] op_sel_hi:[1,0,0]
    v_fma_mix_f32 v50, v141, v34, v42 op_sel_hi:[1,0,0]
    v_fma_mix_f32 v51, v141, v35, v43 op_sel:[1,0,0] op_sel_hi:[1,0,0]
    s_add_u32 m0, s36, 58368
    s_add_u32 s38, s34, 2015232
    buffer_load_dwordx4 v17, s[16:19], s38 offen lds
    s_add_u32 m0, s36, 65536
    s_add_u32 s38, s34, 1968128
    buffer_load_dwordx4 v17, s[16:19], s38 offen lds
    v_fma_mix_f32 v52, v142, v36, v44 op_sel_hi:[1,0,0]
    v_fma_mix_f32 v53, v142, v37, v45 op_sel:[1,0,0] op_sel_hi:[1,0,0]
    v_fma_mix_f32 v54, v143, v38, v46 op_sel_hi:[1,0,0]
    v_fma_mix_f32 v55, v143, v39, v47 op_sel:[1,0,0] op_sel_hi:[1,0,0]
    v_cvt_pk_bf16_f32 v140, v48, v49
    v_cvt_pk_bf16_f32 v141, v50, v51
    v_cvt_pk_bf16_f32 v142, v52, v53
    v_cvt_pk_bf16_f32 v143, v54, v55
    ds_read_b128 v[32:35], v18 offset:2560
    ds_read_b128 v[36:39], v18 offset:2576
    ds_read_b128 v[40:43], v18 offset:2592
    ds_read_b128 v[44:47], v18 offset:2608
    s_waitcnt vmcnt(14) lgkmcnt(4)
    s_barrier
    s_add_u32 s38, s33, 114688
    buffer_load_dwordx4 v[96:99], v14, s[12:15], s38 offen
    s_add_u32 s38, s33, 115712
    buffer_load_dwordx4 v[100:103], v14, s[12:15], s38 offen
    s_waitcnt vmcnt(12) lgkmcnt(0)
    ds_write_b128 v15, v[128:131] offset:0
    v_fma_mix_f32 v48, v64, v32, v40 op_sel_hi:[1,0,0]
    v_fma_mix_f32 v49, v64, v33, v41 op_sel:[1,0,0] op_sel_hi:[1,0,0]
    v_fma_mix_f32 v50, v65, v34, v42 op_sel_hi:[1,0,0]
    v_fma_mix_f32 v51, v65, v35, v43 op_sel:[1,0,0] op_sel_hi:[1,0,0]
    v_fma_mix_f32 v52, v66, v36, v44 op_sel_hi:[1,0,0]
    v_fma_mix_f32 v53, v66, v37, v45 op_sel:[1,0,0] op_sel_hi:[1,0,0]
    v_fma_mix_f32 v54, v67, v38, v46 op_sel_hi:[1,0,0]
    v_fma_mix_f32 v55, v67, v39, v47 op_sel:[1,0,0] op_sel_hi:[1,0,0]
    s_add_u32 s38, s33, 116736
    buffer_load_dwordx4 v[104:107], v14, s[12:15], s38 offen
    s_add_u32 s38, s33, 117760
    buffer_load_dwordx4 v[108:111], v14, s[12:15], s38 offen
    ds_write_b128 v16, v[132:135] offset:1024
    v_cvt_pk_bf16_f32 v64, v48, v49
    v_cvt_pk_bf16_f32 v65, v50, v51
    v_cvt_pk_bf16_f32 v66, v52, v53
    v_cvt_pk_bf16_f32 v67, v54, v55
    v_fma_mix_f32 v48, v68, v32, v40 op_sel_hi:[1,0,0]
    v_fma_mix_f32 v49, v68, v33, v41 op_sel:[1,0,0] op_sel_hi:[1,0,0]
    v_fma_mix_f32 v50, v69, v34, v42 op_sel_hi:[1,0,0]
    v_fma_mix_f32 v51, v69, v35, v43 op_sel:[1,0,0] op_sel_hi:[1,0,0]
    s_add_u32 m0, s36, 81920
    s_add_u32 s38, s34, 2359296
    buffer_load_dwordx4 v17, s[16:19], s38 offen lds
    s_add_u32 m0, s36, 82944
    s_add_u32 s38, s34, 2408448
    buffer_load_dwordx4 v17, s[16:19], s38 offen lds
    ds_write_b128 v15, v[136:139] offset:2048
    v_fma_mix_f32 v52, v70, v36, v44 op_sel_hi:[1,0,0]
    v_fma_mix_f32 v53, v70, v37, v45 op_sel:[1,0,0] op_sel_hi:[1,0,0]
    v_fma_mix_f32 v54, v71, v38, v46 op_sel_hi:[1,0,0]
    v_fma_mix_f32 v55, v71, v39, v47 op_sel:[1,0,0] op_sel_hi:[1,0,0]
    v_cvt_pk_bf16_f32 v68, v48, v49
    v_cvt_pk_bf16_f32 v69, v50, v51
    v_cvt_pk_bf16_f32 v70, v52, v53
    v_cvt_pk_bf16_f32 v71, v54, v55
    s_add_u32 m0, s36, 90112
    s_add_u32 s38, s34, 2361344
    buffer_load_dwordx4 v17, s[16:19], s38 offen lds
    s_add_u32 s38, s33, 131072
    buffer_load_dwordx4 v[112:115], v14, s[12:15], s38 offen
    ds_write_b128 v16, v[140:143] offset:3072
    v_fma_mix_f32 v48, v72, v32, v40 op_sel_hi:[1,0,0]
    v_fma_mix_f32 v49, v72, v33, v41 op_sel:[1,0,0] op_sel_hi:[1,0,0]
    v_fma_mix_f32 v50, v73, v34, v42 op_sel_hi:[1,0,0]
    v_fma_mix_f32 v51, v73, v35, v43 op_sel:[1,0,0] op_sel_hi:[1,0,0]
    v_fma_mix_f32 v52, v74, v36, v44 op_sel_hi:[1,0,0]
    v_fma_mix_f32 v53, v74, v37, v45 op_sel:[1,0,0] op_sel_hi:[1,0,0]
    v_fma_mix_f32 v54, v75, v38, v46 op_sel_hi:[1,0,0]
    v_fma_mix_f32 v55, v75, v39, v47 op_sel:[1,0,0] op_sel_hi:[1,0,0]
    s_add_u32 s38, s33, 132096
    buffer_load_dwordx4 v[116:119], v14, s[12:15], s38 offen
    s_add_u32 s38, s33, 133120
    buffer_load_dwordx4 v[120:123], v14, s[12:15], s38 offen
    v_cvt_pk_bf16_f32 v72, v48, v49
    v_cvt_pk_bf16_f32 v73, v50, v51
    v_cvt_pk_bf16_f32 v74, v52, v53
    v_cvt_pk_bf16_f32 v75, v54, v55
    v_fma_mix_f32 v48, v76, v32, v40 op_sel_hi:[1,0,0]
    v_fma_mix_f32 v49, v76, v33, v41 op_sel:[1,0,0] op_sel_hi:[1,0,0]
    v_fma_mix_f32 v50, v77, v34, v42 op_sel_hi:[1,0,0]
    v_fma_mix_f32 v51, v77, v35, v43 op_sel:[1,0,0] op_sel_hi:[1,0,0]
    s_add_u32 s38, s33, 134144
    buffer_load_dwordx4 v[124:127], v14, s[12:15], s38 offen
    v_fma_mix_f32 v52, v78, v36, v44 op_sel_hi:[1,0,0]
    v_fma_mix_f32 v53, v78, v37, v45 op_sel:[1,0,0] op_sel_hi:[1,0,0]
    v_fma_mix_f32 v54, v79, v38, v46 op_sel_hi:[1,0,0]
    v_fma_mix_f32 v55, v79, v39, v47 op_sel:[1,0,0] op_sel_hi:[1,0,0]
    v_cvt_pk_bf16_f32 v76, v48, v49
    v_cvt_pk_bf16_f32 v77, v50, v51
    v_cvt_pk_bf16_f32 v78, v52, v53
    v_cvt_pk_bf16_f32 v79, v54, v55
    ds_read_b128 v[32:35], v18 offset:3072
    ds_read_b128 v[36:39], v18 offset:3088
    ds_read_b128 v[40:43], v18 offset:3104
    ds_read_b128 v[44:47], v18 offset:3120
    s_waitcnt vmcnt(18) lgkmcnt(4)
    s_barrier
    s_add_u32 m0, s36, 106496
    s_add_u32 s38, s34, 2752512
    buffer_load_dwordx4 v17, s[16:19], s38 offen lds
    s_add_u32 m0, s36, 107520
    s_add_u32 s38, s34, 2801664
    buffer_load_dwordx4 v17, s[16:19], s38 offen lds
    s_waitcnt vmcnt(16) lgkmcnt(0)
    ds_write_b128 v15, v[64:67] offset:16384
    v_fma_mix_f32 v48, v80, v32, v40 op_sel_hi:[1,0,0]
    v_fma_mix_f32 v49, v80, v33, v41 op_sel:[1,0,0] op_sel_hi:[1,0,0]
    v_fma_mix_f32 v50, v81, v34, v42 op_sel_hi:[1,0,0]
    v_fma_mix_f32 v51, v81, v35, v43 op_sel:[1,0,0] op_sel_hi:[1,0,0]
    v_fma_mix_f32 v52, v82, v36, v44 op_sel_hi:[1,0,0]
    v_fma_mix_f32 v53, v82, v37, v45 op_sel:[1,0,0] op_sel_hi:[1,0,0]
    v_fma_mix_f32 v54, v83, v38, v46 op_sel_hi:[1,0,0]
    v_fma_mix_f32 v55, v83, v39, v47 op_sel:[1,0,0] op_sel_hi:[1,0,0]
    v_cvt_pk_bf16_f32 v80, v48, v49
    v_cvt_pk_bf16_f32 v81, v50, v51
    v_cvt_pk_bf16_f32 v82, v52, v53
    v_cvt_pk_bf16_f32 v83, v54, v55
    s_add_u32 m0, s36, 114688
    s_add_u32 s38, s34, 2754560
    buffer_load_dwordx4 v17, s[16:19], s38 offen lds
    s_add_u32 s38, s33, 147456
    buffer_load_dwordx4 v[128:131], v14, s[12:15], s38 offen
    ds_write_b128 v16, v[68:71] offset:17408
    v_fma_mix_f32 v48, v84, v32, v40 op_sel_hi:[1,0,0]
    v_fma_mix_f32 v49, v84, v33, v41 op_sel:[1,0,0] op_sel_hi:[1,0,0]
    v_fma_mix_f32 v50, v85, v34, v42 op_sel_hi:[1,0,0]
    v_fma_mix_f32 v51, v85, v35, v43 op_sel:[1,0,0] op_sel_hi:[1,0,0]
    v_fma_mix_f32 v52, v86, v36, v44 op_sel_hi:[1,0,0]
    v_fma_mix_f32 v53, v86, v37, v45 op_sel:[1,0,0] op_sel_hi:[1,0,0]
    v_fma_mix_f32 v54, v87, v38, v46 op_sel_hi:[1,0,0]
    v_fma_mix_f32 v55, v87, v39, v47 op_sel:[1,0,0] op_sel_hi:[1,0,0]
    v_cvt_pk_bf16_f32 v84, v48, v49
    v_cvt_pk_bf16_f32 v85, v50, v51
    v_cvt_pk_bf16_f32 v86, v52, v53
    v_cvt_pk_bf16_f32 v87, v54, v55
    s_add_u32 s38, s33, 148480
    buffer_load_dwordx4 v[132:135], v14, s[12:15], s38 offen
    s_add_u32 s38, s33, 149504
    buffer_load_dwordx4 v[136:139], v14, s[12:15], s38 offen
    ds_write_b128 v15, v[72:75] offset:18432
    v_fma_mix_f32 v48, v88, v32, v40 op_sel_hi:[1,0,0]
    v_fma_mix_f32 v49, v88, v33, v41 op_sel:[1,0,0] op_sel_hi:[1,0,0]
    v_fma_mix_f32 v50, v89, v34, v42 op_sel_hi:[1,0,0]
    v_fma_mix_f32 v51, v89, v35, v43 op_sel:[1,0,0] op_sel_hi:[1,0,0]
    v_fma_mix_f32 v52, v90, v36, v44 op_sel_hi:[1,0,0]
    v_fma_mix_f32 v53, v90, v37, v45 op_sel:[1,0,0] op_sel_hi:[1,0,0]
    v_fma_mix_f32 v54, v91, v38, v46 op_sel_hi:[1,0,0]
    v_fma_mix_f32 v55, v91, v39, v47 op_sel:[1,0,0] op_sel_hi:[1,0,0]
    v_cvt_pk_bf16_f32 v88, v48, v49
    v_cvt_pk_bf16_f32 v89, v50, v51
    v_cvt_pk_bf16_f32 v90, v52, v53
    v_cvt_pk_bf16_f32 v91, v54, v55
    s_add_u32 s38, s33, 150528
    buffer_load_dwordx4 v[140:143], v14, s[12:15], s38 offen
    ds_write_b128 v16, v[76:79] offset:19456
    v_fma_mix_f32 v48, v92, v32, v40 op_sel_hi:[1,0,0]
    v_fma_mix_f32 v49, v92, v33, v41 op_sel:[1,0,0] op_sel_hi:[1,0,0]
    v_fma_mix_f32 v50, v93, v34, v42 op_sel_hi:[1,0,0]
    v_fma_mix_f32 v51, v93, v35, v43 op_sel:[1,0,0] op_sel_hi:[1,0,0]
    v_fma_mix_f32 v52, v94, v36, v44 op_sel_hi:[1,0,0]
    v_fma_mix_f32 v53, v94, v37, v45 op_sel:[1,0,0] op_sel_hi:[1,0,0]
    v_fma_mix_f32 v54, v95, v38, v46 op_sel_hi:[1,0,0]
    v_fma_mix_f32 v55, v95, v39, v47 op_sel:[1,0,0] op_sel_hi:[1,0,0]
    v_cvt_pk_bf16_f32 v92, v48, v49
    v_cvt_pk_bf16_f32 v93, v50, v51
    v_cvt_pk_bf16_f32 v94, v52, v53
    v_cvt_pk_bf16_f32 v95, v54, v55
    ds_read_b128 v[32:35], v18 offset:3584
    ds_read_b128 v[36:39], v18 offset:3600
    ds_read_b128 v[40:43], v18 offset:3616
    ds_read_b128 v[44:47], v18 offset:3632
    s_waitcnt vmcnt(18) lgkmcnt(4)
    s_barrier
    s_add_u32 m0, s36, 32768
    s_add_u32 s38, s34, 3145728
    buffer_load_dwordx4 v17, s[16:19], s38 offen lds
    s_add_u32 m0, s36, 33792
    s_add_u32 s38, s34, 3194880
    buffer_load_dwordx4 v17, s[16:19], s38 offen lds
    s_waitcnt vmcnt(16) lgkmcnt(0)
    ds_write_b128 v15, v[80:83] offset:0
    v_fma_mix_f32 v48, v96, v32, v40 op_sel_hi:[1,0,0]
    v_fma_mix_f32 v49, v96, v33, v41 op_sel:[1,0,0] op_sel_hi:[1,0,0]
    v_fma_mix_f32 v50, v97, v34, v42 op_sel_hi:[1,0,0]
    v_fma_mix_f32 v51, v97, v35, v43 op_sel:[1,0,0] op_sel_hi:[1,0,0]
    v_fma_mix_f32 v52, v98, v36, v44 op_sel_hi:[1,0,0]
    v_fma_mix_f32 v53, v98, v37, v45 op_sel:[1,0,0] op_sel_hi:[1,0,0]
    v_fma_mix_f32 v54, v99, v38, v46 op_sel_hi:[1,0,0]
    v_fma_mix_f32 v55, v99, v39, v47 op_sel:[1,0,0] op_sel_hi:[1,0,0]
    v_cvt_pk_bf16_f32 v96, v48, v49
    v_cvt_pk_bf16_f32 v97, v50, v51
    v_cvt_pk_bf16_f32 v98, v52, v53
    v_cvt_pk_bf16_f32 v99, v54, v55
    s_add_u32 m0, s36, 40960
    s_add_u32 s38, s34, 3147776
    buffer_load_dwordx4 v17, s[16:19], s38 offen lds
    s_add_u32 s38, s33, 163840
    buffer_load_dwordx4 v[64:67], v14, s[12:15], s38 offen
    ds_write_b128 v16, v[84:87] offset:1024
    v_fma_mix_f32 v48, v100, v32, v40 op_sel_hi:[1,0,0]
    v_fma_mix_f32 v49, v100, v33, v41 op_sel:[1,0,0] op_sel_hi:[1,0,0]
    v_fma_mix_f32 v50, v101, v34, v42 op_sel_hi:[1,0,0]
    v_fma_mix_f32 v51, v101, v35, v43 op_sel:[1,0,0] op_sel_hi:[1,0,0]
    v_fma_mix_f32 v52, v102, v36, v44 op_sel_hi:[1,0,0]
    v_fma_mix_f32 v53, v102, v37, v45 op_sel:[1,0,0] op_sel_hi:[1,0,0]
    v_fma_mix_f32 v54, v103, v38, v46 op_sel_hi:[1,0,0]
    v_fma_mix_f32 v55, v103, v39, v47 op_sel:[1,0,0] op_sel_hi:[1,0,0]
    v_cvt_pk_bf16_f32 v100, v48, v49
    v_cvt_pk_bf16_f32 v101, v50, v51
    v_cvt_pk_bf16_f32 v102, v52, v53
    v_cvt_pk_bf16_f32 v103, v54, v55
    s_add_u32 s38, s33, 164864
    buffer_load_dwordx4 v[68:71], v14, s[12:15], s38 offen
    s_add_u32 s38, s33, 165888
    buffer_load_dwordx4 v[72:75], v14, s[12:15], s38 offen
    ds_write_b128 v15, v[88:91] offset:2048
    v_fma_mix_f32 v48, v104, v32, v40 op_sel_hi:[1,0,0]
    v_fma_mix_f32 v49, v104, v33, v41 op_sel:[1,0,0] op_sel_hi:[1,0,0]
    v_fma_mix_f32 v50, v105, v34, v42 op_sel_hi:[1,0,0]
    v_fma_mix_f32 v51, v105, v35, v43 op_sel:[1,0,0] op_sel_hi:[1,0,0]
    v_fma_mix_f32 v52, v106, v36, v44 op_sel_hi:[1,0,0]
    v_fma_mix_f32 v53, v106, v37, v45 op_sel:[1,0,0] op_sel_hi:[1,0,0]
    v_fma_mix_f32 v54, v107, v38, v46 op_sel_hi:[1,0,0]
    v_fma_mix_f32 v55, v107, v39, v47 op_sel:[1,0,0] op_sel_hi:[1,0,0]
    v_cvt_pk_bf16_f32 v104, v48, v49
    v_cvt_pk_bf16_f32 v105, v50, v51
    v_cvt_pk_bf16_f32 v106, v52, v53
    v_cvt_pk_bf16_f32 v107, v54, v55
    s_add_u32 s38, s33, 166912
    buffer_load_dwordx4 v[76:79], v14, s[12:15], s38 offen
    ds_write_b128 v16, v[92:95] offset:3072
    v_fma_mix_f32 v48, v108, v32, v40 op_sel_hi:[1,0,0]
    v_fma_mix_f32 v49, v108, v33, v41 op_sel:[1,0,0] op_sel_hi:[1,0,0]
    v_fma_mix_f32 v50, v109, v34, v42 op_sel_hi:[1,0,0]
    v_fma_mix_f32 v51, v109, v35, v43 op_sel:[1,0,0] op_sel_hi:[1,0,0]
    v_fma_mix_f32 v52, v110, v36, v44 op_sel_hi:[1,0,0]
    v_fma_mix_f32 v53, v110, v37, v45 op_sel:[1,0,0] op_sel_hi:[1,0,0]
    v_fma_mix_f32 v54, v111, v38, v46 op_sel_hi:[1,0,0]
    v_fma_mix_f32 v55, v111, v39, v47 op_sel:[1,0,0] op_sel_hi:[1,0,0]
    v_cvt_pk_bf16_f32 v108, v48, v49
    v_cvt_pk_bf16_f32 v109, v50, v51
    v_cvt_pk_bf16_f32 v110, v52, v53
    v_cvt_pk_bf16_f32 v111, v54, v55
    ds_read_b128 v[32:35], v18 offset:4096
    ds_read_b128 v[36:39], v18 offset:4112
    ds_read_b128 v[40:43], v18 offset:4128
    ds_read_b128 v[44:47], v18 offset:4144
    s_waitcnt vmcnt(18) lgkmcnt(4)
    s_barrier
    s_add_u32 m0, s36, 57344
    s_add_u32 s38, s34, 3538944
    buffer_load_dwordx4 v17, s[16:19], s38 offen lds
    s_add_u32 m0, s36, 58368
    s_add_u32 s38, s34, 3588096
    buffer_load_dwordx4 v17, s[16:19], s38 offen lds
    s_waitcnt vmcnt(16) lgkmcnt(0)
    ds_write_b128 v15, v[96:99] offset:16384
    v_fma_mix_f32 v48, v112, v32, v40 op_sel_hi:[1,0,0]
    v_fma_mix_f32 v49, v112, v33, v41 op_sel:[1,0,0] op_sel_hi:[1,0,0]
    v_fma_mix_f32 v50, v113, v34, v42 op_sel_hi:[1,0,0]
    v_fma_mix_f32 v51, v113, v35, v43 op_sel:[1,0,0] op_sel_hi:[1,0,0]
    v_fma_mix_f32 v52, v114, v36, v44 op_sel_hi:[1,0,0]
    v_fma_mix_f32 v53, v114, v37, v45 op_sel:[1,0,0] op_sel_hi:[1,0,0]
    v_fma_mix_f32 v54, v115, v38, v46 op_sel_hi:[1,0,0]
    v_fma_mix_f32 v55, v115, v39, v47 op_sel:[1,0,0] op_sel_hi:[1,0,0]
    v_cvt_pk_bf16_f32 v112, v48, v49
    v_cvt_pk_bf16_f32 v113, v50, v51
    v_cvt_pk_bf16_f32 v114, v52, v53
    v_cvt_pk_bf16_f32 v115, v54, v55
    s_add_u32 m0, s36, 65536
    s_add_u32 s38, s34, 3540992
    buffer_load_dwordx4 v17, s[16:19], s38 offen lds
    s_add_u32 s38, s33, 180224
    buffer_load_dwordx4 v[80:83], v14, s[12:15], s38 offen
    ds_write_b128 v16, v[100:103] offset:17408
    v_fma_mix_f32 v48, v116, v32, v40 op_sel_hi:[1,0,0]
    v_fma_mix_f32 v49, v116, v33, v41 op_sel:[1,0,0] op_sel_hi:[1,0,0]
    v_fma_mix_f32 v50, v117, v34, v42 op_sel_hi:[1,0,0]
    v_fma_mix_f32 v51, v117, v35, v43 op_sel:[1,0,0] op_sel_hi:[1,0,0]
    v_fma_mix_f32 v52, v118, v36, v44 op_sel_hi:[1,0,0]
    v_fma_mix_f32 v53, v118, v37, v45 op_sel:[1,0,0] op_sel_hi:[1,0,0]
    v_fma_mix_f32 v54, v119, v38, v46 op_sel_hi:[1,0,0]
    v_fma_mix_f32 v55, v119, v39, v47 op_sel:[1,0,0] op_sel_hi:[1,0,0]
    v_cvt_pk_bf16_f32 v116, v48, v49
    v_cvt_pk_bf16_f32 v117, v50, v51
    v_cvt_pk_bf16_f32 v118, v52, v53
    v_cvt_pk_bf16_f32 v119, v54, v55
    s_add_u32 s38, s33, 181248
    buffer_load_dwordx4 v[84:87], v14, s[12:15], s38 offen
    s_add_u32 s38, s33, 182272
    buffer_load_dwordx4 v[88:91], v14, s[12:15], s38 offen
    ds_write_b128 v15, v[104:107] offset:18432
    v_fma_mix_f32 v48, v120, v32, v40 op_sel_hi:[1,0,0]
    v_fma_mix_f32 v49, v120, v33, v41 op_sel:[1,0,0] op_sel_hi:[1,0,0]
    v_fma_mix_f32 v50, v121, v34, v42 op_sel_hi:[1,0,0]
    v_fma_mix_f32 v51, v121, v35, v43 op_sel:[1,0,0] op_sel_hi:[1,0,0]
    v_fma_mix_f32 v52, v122, v36, v44 op_sel_hi:[1,0,0]
    v_fma_mix_f32 v53, v122, v37, v45 op_sel:[1,0,0] op_sel_hi:[1,0,0]
    v_fma_mix_f32 v54, v123, v38, v46 op_sel_hi:[1,0,0]
    v_fma_mix_f32 v55, v123, v39, v47 op_sel:[1,0,0] op_sel_hi:[1,0,0]
    v_cvt_pk_bf16_f32 v120, v48, v49
    v_cvt_pk_bf16_f32 v121, v50, v51
    v_cvt_pk_bf16_f32 v122, v52, v53
    v_cvt_pk_bf16_f32 v123, v54, v55
    s_add_u32 s38, s33, 183296
    buffer_load_dwordx4 v[92:95], v14, s[12:15], s38 offen
    ds_write_b128 v16, v[108:111] offset:19456
    v_fma_mix_f32 v48, v124, v32, v40 op_sel_hi:[1,0,0]
    v_fma_mix_f32 v49, v124, v33, v41 op_sel:[1,0,0] op_sel_hi:[1,0,0]
    v_fma_mix_f32 v50, v125, v34, v42 op_sel_hi:[1,0,0]
    v_fma_mix_f32 v51, v125, v35, v43 op_sel:[1,0,0] op_sel_hi:[1,0,0]
    v_fma_mix_f32 v52, v126, v36, v44 op_sel_hi:[1,0,0]
    v_fma_mix_f32 v53, v126, v37, v45 op_sel:[1,0,0] op_sel_hi:[1,0,0]
    v_fma_mix_f32 v54, v127, v38, v46 op_sel_hi:[1,0,0]
    v_fma_mix_f32 v55, v127, v39, v47 op_sel:[1,0,0] op_sel_hi:[1,0,0]
    v_cvt_pk_bf16_f32 v124, v48, v49
    v_cvt_pk_bf16_f32 v125, v50, v51
    v_cvt_pk_bf16_f32 v126, v52, v53
    v_cvt_pk_bf16_f32 v127, v54, v55
    ds_read_b128 v[32:35], v18 offset:4608
    ds_read_b128 v[36:39], v18 offset:4624
    ds_read_b128 v[40:43], v18 offset:4640
    ds_read_b128 v[44:47], v18 offset:4656
    s_waitcnt vmcnt(18) lgkmcnt(4)
    s_barrier
    s_add_u32 m0, s36, 81920
    s_add_u32 s38, s34, 3932160
    buffer_load_dwordx4 v17, s[16:19], s38 offen lds
    s_add_u32 m0, s36, 82944
    s_add_u32 s38, s34, 3981312
    buffer_load_dwordx4 v17, s[16:19], s38 offen lds
    s_waitcnt vmcnt(16) lgkmcnt(0)
    ds_write_b128 v15, v[112:115] offset:0
    v_fma_mix_f32 v48, v128, v32, v40 op_sel_hi:[1,0,0]
    v_fma_mix_f32 v49, v128, v33, v41 op_sel:[1,0,0] op_sel_hi:[1,0,0]
    v_fma_mix_f32 v50, v129, v34, v42 op_sel_hi:[1,0,0]
    v_fma_mix_f32 v51, v129, v35, v43 op_sel:[1,0,0] op_sel_hi:[1,0,0]
    v_fma_mix_f32 v52, v130, v36, v44 op_sel_hi:[1,0,0]
    v_fma_mix_f32 v53, v130, v37, v45 op_sel:[1,0,0] op_sel_hi:[1,0,0]
    v_fma_mix_f32 v54, v131, v38, v46 op_sel_hi:[1,0,0]
    v_fma_mix_f32 v55, v131, v39, v47 op_sel:[1,0,0] op_sel_hi:[1,0,0]
    v_cvt_pk_bf16_f32 v128, v48, v49
    v_cvt_pk_bf16_f32 v129, v50, v51
    v_cvt_pk_bf16_f32 v130, v52, v53
    v_cvt_pk_bf16_f32 v131, v54, v55
    s_add_u32 m0, s36, 90112
    s_add_u32 s38, s34, 3934208
    buffer_load_dwordx4 v17, s[16:19], s38 offen lds
    s_add_u32 s38, s33, 196608
    buffer_load_dwordx4 v[96:99], v14, s[12:15], s38 offen
    ds_write_b128 v16, v[116:119] offset:1024
    v_fma_mix_f32 v48, v132, v32, v40 op_sel_hi:[1,0,0]
    v_fma_mix_f32 v49, v132, v33, v41 op_sel:[1,0,0] op_sel_hi:[1,0,0]
    v_fma_mix_f32 v50, v133, v34, v42 op_sel_hi:[1,0,0]
    v_fma_mix_f32 v51, v133, v35, v43 op_sel:[1,0,0] op_sel_hi:[1,0,0]
    v_fma_mix_f32 v52, v134, v36, v44 op_sel_hi:[1,0,0]
    v_fma_mix_f32 v53, v134, v37, v45 op_sel:[1,0,0] op_sel_hi:[1,0,0]
    v_fma_mix_f32 v54, v135, v38, v46 op_sel_hi:[1,0,0]
    v_fma_mix_f32 v55, v135, v39, v47 op_sel:[1,0,0] op_sel_hi:[1,0,0]
    v_cvt_pk_bf16_f32 v132, v48, v49
    v_cvt_pk_bf16_f32 v133, v50, v51
    v_cvt_pk_bf16_f32 v134, v52, v53
    v_cvt_pk_bf16_f32 v135, v54, v55
    s_add_u32 s38, s33, 197632
    buffer_load_dwordx4 v[100:103], v14, s[12:15], s38 offen
    s_add_u32 s38, s33, 198656
    buffer_load_dwordx4 v[104:107], v14, s[12:15], s38 offen
    ds_write_b128 v15, v[120:123] offset:2048
    v_fma_mix_f32 v48, v136, v32, v40 op_sel_hi:[1,0,0]
    v_fma_mix_f32 v49, v136, v33, v41 op_sel:[1,0,0] op_sel_hi:[1,0,0]
    v_fma_mix_f32 v50, v137, v34, v42 op_sel_hi:[1,0,0]
    v_fma_mix_f32 v51, v137, v35, v43 op_sel:[1,0,0] op_sel_hi:[1,0,0]
    v_fma_mix_f32 v52, v138, v36, v44 op_sel_hi:[1,0,0]
    v_fma_mix_f32 v53, v138, v37, v45 op_sel:[1,0,0] op_sel_hi:[1,0,0]
    v_fma_mix_f32 v54, v139, v38, v46 op_sel_hi:[1,0,0]
    v_fma_mix_f32 v55, v139, v39, v47 op_sel:[1,0,0] op_sel_hi:[1,0,0]
    v_cvt_pk_bf16_f32 v136, v48, v49
    v_cvt_pk_bf16_f32 v137, v50, v51
    v_cvt_pk_bf16_f32 v138, v52, v53
    v_cvt_pk_bf16_f32 v139, v54, v55
    s_add_u32 s38, s33, 199680
    buffer_load_dwordx4 v[108:111], v14, s[12:15], s38 offen
    ds_write_b128 v16, v[124:127] offset:3072
    v_fma_mix_f32 v48, v140, v32, v40 op_sel_hi:[1,0,0]
    v_fma_mix_f32 v49, v140, v33, v41 op_sel:[1,0,0] op_sel_hi:[1,0,0]
    v_fma_mix_f32 v50, v141, v34, v42 op_sel_hi:[1,0,0]
    v_fma_mix_f32 v51, v141, v35, v43 op_sel:[1,0,0] op_sel_hi:[1,0,0]
    v_fma_mix_f32 v52, v142, v36, v44 op_sel_hi:[1,0,0]
    v_fma_mix_f32 v53, v142, v37, v45 op_sel:[1,0,0] op_sel_hi:[1,0,0]
    v_fma_mix_f32 v54, v143, v38, v46 op_sel_hi:[1,0,0]
    v_fma_mix_f32 v55, v143, v39, v47 op_sel:[1,0,0] op_sel_hi:[1,0,0]
    v_cvt_pk_bf16_f32 v140, v48, v49
    v_cvt_pk_bf16_f32 v141, v50, v51
    v_cvt_pk_bf16_f32 v142, v52, v53
    v_cvt_pk_bf16_f32 v143, v54, v55
    ds_read_b128 v[32:35], v18 offset:5120
    ds_read_b128 v[36:39], v18 offset:5136
    ds_read_b128 v[40:43], v18 offset:5152
    ds_read_b128 v[44:47], v18 offset:5168
    s_waitcnt vmcnt(18) lgkmcnt(4)
    s_barrier
    s_add_u32 m0, s36, 106496
    s_add_u32 s38, s34, 4325376
    buffer_load_dwordx4 v17, s[16:19], s38 offen lds
    s_add_u32 m0, s36, 107520
    s_add_u32 s38, s34, 4374528
    buffer_load_dwordx4 v17, s[16:19], s38 offen lds
    s_waitcnt vmcnt(16) lgkmcnt(0)
    ds_write_b128 v15, v[128:131] offset:16384
    v_fma_mix_f32 v48, v64, v32, v40 op_sel_hi:[1,0,0]
    v_fma_mix_f32 v49, v64, v33, v41 op_sel:[1,0,0] op_sel_hi:[1,0,0]
    v_fma_mix_f32 v50, v65, v34, v42 op_sel_hi:[1,0,0]
    v_fma_mix_f32 v51, v65, v35, v43 op_sel:[1,0,0] op_sel_hi:[1,0,0]
    v_fma_mix_f32 v52, v66, v36, v44 op_sel_hi:[1,0,0]
    v_fma_mix_f32 v53, v66, v37, v45 op_sel:[1,0,0] op_sel_hi:[1,0,0]
    v_fma_mix_f32 v54, v67, v38, v46 op_sel_hi:[1,0,0]
    v_fma_mix_f32 v55, v67, v39, v47 op_sel:[1,0,0] op_sel_hi:[1,0,0]
    v_cvt_pk_bf16_f32 v64, v48, v49
    v_cvt_pk_bf16_f32 v65, v50, v51
    v_cvt_pk_bf16_f32 v66, v52, v53
    v_cvt_pk_bf16_f32 v67, v54, v55
    s_add_u32 m0, s36, 114688
    s_add_u32 s38, s34, 4327424
    buffer_load_dwordx4 v17, s[16:19], s38 offen lds
    s_add_u32 s38, s33, 212992
    buffer_load_dwordx4 v[112:115], v14, s[12:15], s38 offen
    ds_write_b128 v16, v[132:135] offset:17408
    v_fma_mix_f32 v48, v68, v32, v40 op_sel_hi:[1,0,0]
    v_fma_mix_f32 v49, v68, v33, v41 op_sel:[1,0,0] op_sel_hi:[1,0,0]
    v_fma_mix_f32 v50, v69, v34, v42 op_sel_hi:[1,0,0]
    v_fma_mix_f32 v51, v69, v35, v43 op_sel:[1,0,0] op_sel_hi:[1,0,0]
    v_fma_mix_f32 v52, v70, v36, v44 op_sel_hi:[1,0,0]
    v_fma_mix_f32 v53, v70, v37, v45 op_sel:[1,0,0] op_sel_hi:[1,0,0]
    v_fma_mix_f32 v54, v71, v38, v46 op_sel_hi:[1,0,0]
    v_fma_mix_f32 v55, v71, v39, v47 op_sel:[1,0,0] op_sel_hi:[1,0,0]
    v_cvt_pk_bf16_f32 v68, v48, v49
    v_cvt_pk_bf16_f32 v69, v50, v51
    v_cvt_pk_bf16_f32 v70, v52, v53
    v_cvt_pk_bf16_f32 v71, v54, v55
    s_add_u32 s38, s33, 214016
    buffer_load_dwordx4 v[116:119], v14, s[12:15], s38 offen
    s_add_u32 s38, s33, 215040
    buffer_load_dwordx4 v[120:123], v14, s[12:15], s38 offen
    ds_write_b128 v15, v[136:139] offset:18432
    v_fma_mix_f32 v48, v72, v32, v40 op_sel_hi:[1,0,0]
    v_fma_mix_f32 v49, v72, v33, v41 op_sel:[1,0,0] op_sel_hi:[1,0,0]
    v_fma_mix_f32 v50, v73, v34, v42 op_sel_hi:[1,0,0]
    v_fma_mix_f32 v51, v73, v35, v43 op_sel:[1,0,0] op_sel_hi:[1,0,0]
    v_fma_mix_f32 v52, v74, v36, v44 op_sel_hi:[1,0,0]
    v_fma_mix_f32 v53, v74, v37, v45 op_sel:[1,0,0] op_sel_hi:[1,0,0]
    v_fma_mix_f32 v54, v75, v38, v46 op_sel_hi:[1,0,0]
    v_fma_mix_f32 v55, v75, v39, v47 op_sel:[1,0,0] op_sel_hi:[1,0,0]
    v_cvt_pk_bf16_f32 v72, v48, v49
    v_cvt_pk_bf16_f32 v73, v50, v51
    v_cvt_pk_bf16_f32 v74, v52, v53
    v_cvt_pk_bf16_f32 v75, v54, v55
    s_add_u32 s38, s33, 216064
    buffer_load_dwordx4 v[124:127], v14, s[12:15], s38 offen
    ds_write_b128 v16, v[140:143] offset:19456
    v_fma_mix_f32 v48, v76, v32, v40 op_sel_hi:[1,0,0]
    v_fma_mix_f32 v49, v76, v33, v41 op_sel:[1,0,0] op_sel_hi:[1,0,0]
    v_fma_mix_f32 v50, v77, v34, v42 op_sel_hi:[1,0,0]
    v_fma_mix_f32 v51, v77, v35, v43 op_sel:[1,0,0] op_sel_hi:[1,0,0]
    v_fma_mix_f32 v52, v78, v36, v44 op_sel_hi:[1,0,0]
    v_fma_mix_f32 v53, v78, v37, v45 op_sel:[1,0,0] op_sel_hi:[1,0,0]
    v_fma_mix_f32 v54, v79, v38, v46 op_sel_hi:[1,0,0]
    v_fma_mix_f32 v55, v79, v39, v47 op_sel:[1,0,0] op_sel_hi:[1,0,0]
    v_cvt_pk_bf16_f32 v76, v48, v49
    v_cvt_pk_bf16_f32 v77, v50, v51
    v_cvt_pk_bf16_f32 v78, v52, v53
    v_cvt_pk_bf16_f32 v79, v54, v55
    ds_read_b128 v[32:35], v18 offset:5632
    ds_read_b128 v[36:39], v18 offset:5648
    ds_read_b128 v[40:43], v18 offset:5664
    ds_read_b128 v[44:47], v18 offset:5680
    s_waitcnt vmcnt(18) lgkmcnt(4)
    s_barrier
    s_add_u32 m0, s36, 32768
    s_add_u32 s38, s34, 4718592
    buffer_load_dwordx4 v17, s[16:19], s38 offen lds
    s_add_u32 m0, s36, 33792
    s_add_u32 s38, s34, 4767744
    buffer_load_dwordx4 v17, s[16:19], s38 offen lds
    s_waitcnt vmcnt(16) lgkmcnt(0)
    ds_write_b128 v15, v[64:67] offset:0
    v_fma_mix_f32 v48, v80, v32, v40 op_sel_hi:[1,0,0]
    v_fma_mix_f32 v49, v80, v33, v41 op_sel:[1,0,0] op_sel_hi:[1,0,0]
    v_fma_mix_f32 v50, v81, v34, v42 op_sel_hi:[1,0,0]
    v_fma_mix_f32 v51, v81, v35, v43 op_sel:[1,0,0] op_sel_hi:[1,0,0]
    v_fma_mix_f32 v52, v82, v36, v44 op_sel_hi:[1,0,0]
    v_fma_mix_f32 v53, v82, v37, v45 op_sel:[1,0,0] op_sel_hi:[1,0,0]
    v_fma_mix_f32 v54, v83, v38, v46 op_sel_hi:[1,0,0]
    v_fma_mix_f32 v55, v83, v39, v47 op_sel:[1,0,0] op_sel_hi:[1,0,0]
    v_cvt_pk_bf16_f32 v80, v48, v49
    v_cvt_pk_bf16_f32 v81, v50, v51
    v_cvt_pk_bf16_f32 v82, v52, v53
    v_cvt_pk_bf16_f32 v83, v54, v55
    s_add_u32 m0, s36, 40960
    s_add_u32 s38, s34, 4720640
    buffer_load_dwordx4 v17, s[16:19], s38 offen lds
    s_add_u32 s38, s33, 229376
    buffer_load_dwordx4 v[128:131], v14, s[12:15], s38 offen
    ds_write_b128 v16, v[68:71] offset:1024
    v_fma_mix_f32 v48, v84, v32, v40 op_sel_hi:[1,0,0]
    v_fma_mix_f32 v49, v84, v33, v41 op_sel:[1,0,0] op_sel_hi:[1,0,0]
    v_fma_mix_f32 v50, v85, v34, v42 op_sel_hi:[1,0,0]
    v_fma_mix_f32 v51, v85, v35, v43 op_sel:[1,0,0] op_sel_hi:[1,0,0]
    v_fma_mix_f32 v52, v86, v36, v44 op_sel_hi:[1,0,0]
    v_fma_mix_f32 v53, v86, v37, v45 op_sel:[1,0,0] op_sel_hi:[1,0,0]
    v_fma_mix_f32 v54, v87, v38, v46 op_sel_hi:[1,0,0]
    v_fma_mix_f32 v55, v87, v39, v47 op_sel:[1,0,0] op_sel_hi:[1,0,0]
    v_cvt_pk_bf16_f32 v84, v48, v49
    v_cvt_pk_bf16_f32 v85, v50, v51
    v_cvt_pk_bf16_f32 v86, v52, v53
    v_cvt_pk_bf16_f32 v87, v54, v55
    s_add_u32 s38, s33, 230400
    buffer_load_dwordx4 v[132:135], v14, s[12:15], s38 offen
    s_add_u32 s38, s33, 231424
    buffer_load_dwordx4 v[136:139], v14, s[12:15], s38 offen
    ds_write_b128 v15, v[72:75] offset:2048
    v_fma_mix_f32 v48, v88, v32, v40 op_sel_hi:[1,0,0]
    v_fma_mix_f32 v49, v88, v33, v41 op_sel:[1,0,0] op_sel_hi:[1,0,0]
    v_fma_mix_f32 v50, v89, v34, v42 op_sel_hi:[1,0,0]
    v_fma_mix_f32 v51, v89, v35, v43 op_sel:[1,0,0] op_sel_hi:[1,0,0]
    v_fma_mix_f32 v52, v90, v36, v44 op_sel_hi:[1,0,0]
    v_fma_mix_f32 v53, v90, v37, v45 op_sel:[1,0,0] op_sel_hi:[1,0,0]
    v_fma_mix_f32 v54, v91, v38, v46 op_sel_hi:[1,0,0]
    v_fma_mix_f32 v55, v91, v39, v47 op_sel:[1,0,0] op_sel_hi:[1,0,0]
    v_cvt_pk_bf16_f32 v88, v48, v49
    v_cvt_pk_bf16_f32 v89, v50, v51
    v_cvt_pk_bf16_f32 v90, v52, v53
    v_cvt_pk_bf16_f32 v91, v54, v55
    s_add_u32 s38, s33, 232448
    buffer_load_dwordx4 v[140:143], v14, s[12:15], s38 offen
    ds_write_b128 v16, v[76:79] offset:3072
    v_fma_mix_f32 v48, v92, v32, v40 op_sel_hi:[1,0,0]
    v_fma_mix_f32 v49, v92, v33, v41 op_sel:[1,0,0] op_sel_hi:[1,0,0]
    v_fma_mix_f32 v50, v93, v34, v42 op_sel_hi:[1,0,0]
    v_fma_mix_f32 v51, v93, v35, v43 op_sel:[1,0,0] op_sel_hi:[1,0,0]
    v_fma_mix_f32 v52, v94, v36, v44 op_sel_hi:[1,0,0]
    v_fma_mix_f32 v53, v94, v37, v45 op_sel:[1,0,0] op_sel_hi:[1,0,0]
    v_fma_mix_f32 v54, v95, v38, v46 op_sel_hi:[1,0,0]
    v_fma_mix_f32 v55, v95, v39, v47 op_sel:[1,0,0] op_sel_hi:[1,0,0]
    v_cvt_pk_bf16_f32 v92, v48, v49
    v_cvt_pk_bf16_f32 v93, v50, v51
    v_cvt_pk_bf16_f32 v94, v52, v53
    v_cvt_pk_bf16_f32 v95, v54, v55
    ds_read_b128 v[32:35], v18 offset:6144
    ds_read_b128 v[36:39], v18 offset:6160
    ds_read_b128 v[40:43], v18 offset:6176
    ds_read_b128 v[44:47], v18 offset:6192
    s_waitcnt vmcnt(18) lgkmcnt(4)
    s_barrier
    s_mov_b32 s52, s6
    s_mov_b32 s53, s7
    s_mov_b32 s54, 0xc00000
    s_mov_b32 s55, 0x00020000
    s_mov_b32 s56, s8
    s_mov_b32 s57, s9
    s_mov_b32 s58, 0x60000
    s_mov_b32 s59, 0x00020000
    s_lshr_b32 s60, s25, 2
    s_lshl_b32 s60, s60, 4
    s_lshl_b32 s61, s24, 1
    s_add_u32 s60, s60, s61
    s_and_b32 s61, s25, 1
    s_add_u32 s60, s60, s61
    s_bfe_u32 s61, s25, 0x10001
    s_lshl_b32 s62, s60, 6
    s_add_u32 s62, s62, 4096
    s_mul_i32 s63, s61, 6291456
    s_add_u32 s62, s62, s63
    s_lshl_b32 s63, s61, 2
    s_add_u32 s63, s63, s30
    s_lshl_b32 s63, s63, 14
    s_lshl_b32 s60, s60, 7
    s_add_u32 s63, s63, s60
    s_add_u32 s63, s63, 262144
    s_lshl_b32 s61, s61, 10
    s_add_u32 s61, s61, 196608
    v_bfe_u32 v6, v0, 2, 6
    v_and_b32 v7, 3, v0
    s_mov_b32 s60, 98304
    v_mul_lo_u32 v188, v6, s60
    v_lshl_add_u32 v188, v7, 4, v188
    v_lshlrev_b32 v6, 4, v6
    buffer_load_dwordx4 v[176:179], v6, s[56:59], s61 offen
    v_lshrrev_b32 v6, 4, v2
    v_lshlrev_b32 v6, 3, v6
    v_lshl_add_u32 v189, v7, 5, v6
    s_mov_b32 s60, 0x05040100
    s_mov_b32 s61, 0x07060302
    v_mov_b32 v180, 0
    v_mov_b32 v181, 0
    v_mov_b32 v182, 0
    v_mov_b32 v183, 0
    v_mov_b32 v184, 0
    v_mov_b32 v185, 0
    v_mov_b32 v186, 0
    v_mov_b32 v187, 0
    s_add_u32 m0, s36, 57344
    s_add_u32 s38, s34, 5111808
    buffer_load_dwordx4 v17, s[16:19], s38 offen lds
    s_add_u32 m0, s36, 58368
    s_add_u32 s38, s34, 5160960
    buffer_load_dwordx4 v17, s[16:19], s38 offen lds
    s_waitcnt vmcnt(17) lgkmcnt(0)
    ds_write_b128 v15, v[80:83] offset:16384
    v_fma_mix_f32 v48, v96, v32, v40 op_sel_hi:[1,0,0]
    v_fma_mix_f32 v49, v96, v33, v41 op_sel:[1,0,0] op_sel_hi:[1,0,0]
    v_fma_mix_f32 v50, v97, v34, v42 op_sel_hi:[1,0,0]
    v_fma_mix_f32 v51, v97, v35, v43 op_sel:[1,0,0] op_sel_hi:[1,0,0]
    v_fma_mix_f32 v52, v98, v36, v44 op_sel_hi:[1,0,0]
    v_fma_mix_f32 v53, v98, v37, v45 op_sel:[1,0,0] op_sel_hi:[1,0,0]
    v_fma_mix_f32 v54, v99, v38, v46 op_sel_hi:[1,0,0]
    v_fma_mix_f32 v55, v99, v39, v47 op_sel:[1,0,0] op_sel_hi:[1,0,0]
    v_cvt_pk_bf16_f32 v96, v48, v49
    v_cvt_pk_bf16_f32 v97, v50, v51
    v_cvt_pk_bf16_f32 v98, v52, v53
    v_cvt_pk_bf16_f32 v99, v54, v55
    s_add_u32 m0, s36, 65536
    s_add_u32 s38, s34, 5113856
    buffer_load_dwordx4 v17, s[16:19], s38 offen lds
    s_add_u32 s38, s33, 245760
    buffer_load_dwordx4 v[64:67], v14, s[12:15], s38 offen
    ds_write_b128 v16, v[84:87] offset:17408
    v_fma_mix_f32 v48, v100, v32, v40 op_sel_hi:[1,0,0]
    v_fma_mix_f32 v49, v100, v33, v41 op_sel:[1,0,0] op_sel_hi:[1,0,0]
    v_fma_mix_f32 v50, v101, v34, v42 op_sel_hi:[1,0,0]
    v_fma_mix_f32 v51, v101, v35, v43 op_sel:[1,0,0] op_sel_hi:[1,0,0]
    v_fma_mix_f32 v52, v102, v36, v44 op_sel_hi:[1,0,0]
    v_fma_mix_f32 v53, v102, v37, v45 op_sel:[1,0,0] op_sel_hi:[1,0,0]
    v_fma_mix_f32 v54, v103, v38, v46 op_sel_hi:[1,0,0]
    v_fma_mix_f32 v55, v103, v39, v47 op_sel:[1,0,0] op_sel_hi:[1,0,0]
    v_cvt_pk_bf16_f32 v100, v48, v49
    v_cvt_pk_bf16_f32 v101, v50, v51
    v_cvt_pk_bf16_f32 v102, v52, v53
    v_cvt_pk_bf16_f32 v103, v54, v55
    s_add_u32 s38, s33, 246784
    buffer_load_dwordx4 v[68:71], v14, s[12:15], s38 offen
    s_add_u32 s38, s33, 247808
    buffer_load_dwordx4 v[72:75], v14, s[12:15], s38 offen
    ds_write_b128 v15, v[88:91] offset:18432
    v_fma_mix_f32 v48, v104, v32, v40 op_sel_hi:[1,0,0]
    v_fma_mix_f32 v49, v104, v33, v41 op_sel:[1,0,0] op_sel_hi:[1,0,0]
    v_fma_mix_f32 v50, v105, v34, v42 op_sel_hi:[1,0,0]
    v_fma_mix_f32 v51, v105, v35, v43 op_sel:[1,0,0] op_sel_hi:[1,0,0]
    v_fma_mix_f32 v52, v106, v36, v44 op_sel_hi:[1,0,0]
    v_fma_mix_f32 v53, v106, v37, v45 op_sel:[1,0,0] op_sel_hi:[1,0,0]
    v_fma_mix_f32 v54, v107, v38, v46 op_sel_hi:[1,0,0]
    v_fma_mix_f32 v55, v107, v39, v47 op_sel:[1,0,0] op_sel_hi:[1,0,0]
    v_cvt_pk_bf16_f32 v104, v48, v49
    v_cvt_pk_bf16_f32 v105, v50, v51
    v_cvt_pk_bf16_f32 v106, v52, v53
    v_cvt_pk_bf16_f32 v107, v54, v55
    s_add_u32 s38, s33, 248832
    buffer_load_dwordx4 v[76:79], v14, s[12:15], s38 offen
    ds_write_b128 v16, v[92:95] offset:19456
    v_fma_mix_f32 v48, v108, v32, v40 op_sel_hi:[1,0,0]
    v_fma_mix_f32 v49, v108, v33, v41 op_sel:[1,0,0] op_sel_hi:[1,0,0]
    v_fma_mix_f32 v50, v109, v34, v42 op_sel_hi:[1,0,0]
    v_fma_mix_f32 v51, v109, v35, v43 op_sel:[1,0,0] op_sel_hi:[1,0,0]
    v_fma_mix_f32 v52, v110, v36, v44 op_sel_hi:[1,0,0]
    v_fma_mix_f32 v53, v110, v37, v45 op_sel:[1,0,0] op_sel_hi:[1,0,0]
    v_fma_mix_f32 v54, v111, v38, v46 op_sel_hi:[1,0,0]
    v_fma_mix_f32 v55, v111, v39, v47 op_sel:[1,0,0] op_sel_hi:[1,0,0]
    v_cvt_pk_bf16_f32 v108, v48, v49
    v_cvt_pk_bf16_f32 v109, v50, v51
    v_cvt_pk_bf16_f32 v110, v52, v53
    v_cvt_pk_bf16_f32 v111, v54, v55
    ds_read_b128 v[32:35], v18 offset:6656
    ds_read_b128 v[36:39], v18 offset:6672
    ds_read_b128 v[40:43], v18 offset:6688
    ds_read_b128 v[44:47], v18 offset:6704
    s_waitcnt vmcnt(19) lgkmcnt(4)
    s_barrier
    s_add_u32 m0, s36, 81920
    s_add_u32 s38, s34, 5505024
    buffer_load_dwordx4 v17, s[16:19], s38 offen lds
    s_add_u32 m0, s36, 82944
    s_add_u32 s38, s34, 5554176
    buffer_load_dwordx4 v17, s[16:19], s38 offen lds
    s_waitcnt vmcnt(17) lgkmcnt(0)
    ds_write_b128 v15, v[96:99] offset:0
    v_fma_mix_f32 v48, v112, v32, v40 op_sel_hi:[1,0,0]
    v_fma_mix_f32 v49, v112, v33, v41 op_sel:[1,0,0] op_sel_hi:[1,0,0]
    v_fma_mix_f32 v50, v113, v34, v42 op_sel_hi:[1,0,0]
    v_fma_mix_f32 v51, v113, v35, v43 op_sel:[1,0,0] op_sel_hi:[1,0,0]
    v_fma_mix_f32 v52, v114, v36, v44 op_sel_hi:[1,0,0]
    v_fma_mix_f32 v53, v114, v37, v45 op_sel:[1,0,0] op_sel_hi:[1,0,0]
    v_fma_mix_f32 v54, v115, v38, v46 op_sel_hi:[1,0,0]
    v_fma_mix_f32 v55, v115, v39, v47 op_sel:[1,0,0] op_sel_hi:[1,0,0]
    v_cvt_pk_bf16_f32 v112, v48, v49
    v_cvt_pk_bf16_f32 v113, v50, v51
    v_cvt_pk_bf16_f32 v114, v52, v53
    v_cvt_pk_bf16_f32 v115, v54, v55
    s_add_u32 m0, s36, 90112
    s_add_u32 s38, s34, 5507072
    buffer_load_dwordx4 v17, s[16:19], s38 offen lds
    buffer_load_dwordx4 v[144:147], v188, s[52:55], s62 offen nt
    s_add_u32 s62, s62, 12288
    ds_write_b128 v16, v[100:103] offset:1024
    v_fma_mix_f32 v48, v116, v32, v40 op_sel_hi:[1,0,0]
    v_fma_mix_f32 v49, v116, v33, v41 op_sel:[1,0,0] op_sel_hi:[1,0,0]
    v_fma_mix_f32 v50, v117, v34, v42 op_sel_hi:[1,0,0]
    v_fma_mix_f32 v51, v117, v35, v43 op_sel:[1,0,0] op_sel_hi:[1,0,0]
    v_fma_mix_f32 v52, v118, v36, v44 op_sel_hi:[1,0,0]
    v_fma_mix_f32 v53, v118, v37, v45 op_sel:[1,0,0] op_sel_hi:[1,0,0]
    v_fma_mix_f32 v54, v119, v38, v46 op_sel_hi:[1,0,0]
    v_fma_mix_f32 v55, v119, v39, v47 op_sel:[1,0,0] op_sel_hi:[1,0,0]
    v_cvt_pk_bf16_f32 v116, v48, v49
    v_cvt_pk_bf16_f32 v117, v50, v51
    v_cvt_pk_bf16_f32 v118, v52, v53
    v_cvt_pk_bf16_f32 v119, v54, v55
    buffer_load_dwordx4 v[148:151], v188, s[52:55], s62 offen nt
    s_add_u32 s62, s62, 12288
    buffer_load_dwordx4 v[152:155], v188, s[52:55], s62 offen nt
    s_add_u32 s62, s62, 12288
    ds_write_b128 v15, v[104:107] offset:2048
    v_fma_mix_f32 v48, v120, v32, v40 op_sel_hi:[1,0,0]
    v_fma_mix_f32 v49, v120, v33, v41 op_sel:[1,0,0] op_sel_hi:[1,0,0]
    v_fma_mix_f32 v50, v121, v34, v42 op_sel_hi:[1,0,0]
    v_fma_mix_f32 v51, v121, v35, v43 op_sel:[1,0,0] op_sel_hi:[1,0,0]
    v_fma_mix_f32 v52, v122, v36, v44 op_sel_hi:[1,0,0]
    v_fma_mix_f32 v53, v122, v37, v45 op_sel:[1,0,0] op_sel_hi:[1,0,0]
    v_fma_mix_f32 v54, v123, v38, v46 op_sel_hi:[1,0,0]
    v_fma_mix_f32 v55, v123, v39, v47 op_sel:[1,0,0] op_sel_hi:[1,0,0]
    v_cvt_pk_bf16_f32 v120, v48, v49
    v_cvt_pk_bf16_f32 v121, v50, v51
    v_cvt_pk_bf16_f32 v122, v52, v53
    v_cvt_pk_bf16_f32 v123, v54, v55
    buffer_load_dwordx4 v[156:159], v188, s[52:55], s62 offen nt
    s_add_u32 s62, s62, 12288
    ds_write_b128 v16, v[108:111] offset:3072
    v_fma_mix_f32 v48, v124, v32, v40 op_sel_hi:[1,0,0]
    v_fma_mix_f32 v49, v124, v33, v41 op_sel:[1,0,0] op_sel_hi:[1,0,0]
    v_fma_mix_f32 v50, v125, v34, v42 op_sel_hi:[1,0,0]
    v_fma_mix_f32 v51, v125, v35, v43 op_sel:[1,0,0] op_sel_hi:[1,0,0]
    v_fma_mix_f32 v52, v126, v36, v44 op_sel_hi:[1,0,0]
    v_fma_mix_f32 v53, v126, v37, v45 op_sel:[1,0,0] op_sel_hi:[1,0,0]
    v_fma_mix_f32 v54, v127, v38, v46 op_sel_hi:[1,0,0]
    v_fma_mix_f32 v55, v127, v39, v47 op_sel:[1,0,0] op_sel_hi:[1,0,0]
    v_cvt_pk_bf16_f32 v124, v48, v49
    v_cvt_pk_bf16_f32 v125, v50, v51
    v_cvt_pk_bf16_f32 v126, v52, v53
    v_cvt_pk_bf16_f32 v127, v54, v55
    ds_read_b128 v[32:35], v18 offset:7168
    ds_read_b128 v[36:39], v18 offset:7184
    ds_read_b128 v[40:43], v18 offset:7200
    ds_read_b128 v[44:47], v18 offset:7216
    s_waitcnt vmcnt(19) lgkmcnt(4)
    s_barrier
    s_add_u32 m0, s36, 106496
    s_add_u32 s38, s34, 5898240
    buffer_load_dwordx4 v17, s[16:19], s38 offen lds
    s_add_u32 m0, s36, 107520
    s_add_u32 s38, s34, 5947392
    buffer_load_dwordx4 v17, s[16:19], s38 offen lds
    s_waitcnt vmcnt(17) lgkmcnt(0)
    ds_write_b128 v15, v[112:115] offset:16384
    v_fma_mix_f32 v48, v128, v32, v40 op_sel_hi:[1,0,0]
    v_fma_mix_f32 v49, v128, v33, v41 op_sel:[1,0,0] op_sel_hi:[1,0,0]
    v_fma_mix_f32 v50, v129, v34, v42 op_sel_hi:[1,0,0]
    v_fma_mix_f32 v51, v129, v35, v43 op_sel:[1,0,0] op_sel_hi:[1,0,0]
    v_fma_mix_f32 v52, v130, v36, v44 op_sel_hi:[1,0,0]
    v_fma_mix_f32 v53, v130, v37, v45 op_sel:[1,0,0] op_sel_hi:[1,0,0]
    v_fma_mix_f32 v54, v131, v38, v46 op_sel_hi:[1,0,0]
    v_fma_mix_f32 v55, v131, v39, v47 op_sel:[1,0,0] op_sel_hi:[1,0,0]
    v_cvt_pk_bf16_f32 v128, v48, v49
    v_cvt_pk_bf16_f32 v129, v50, v51
    v_cvt_pk_bf16_f32 v130, v52, v53
    v_cvt_pk_bf16_f32 v131, v54, v55
    s_add_u32 m0, s36, 114688
    s_add_u32 s38, s34, 5900288
    buffer_load_dwordx4 v17, s[16:19], s38 offen lds
    buffer_load_dwordx4 v[160:163], v188, s[52:55], s62 offen nt
    s_add_u32 s62, s62, 12288
    ds_write_b128 v16, v[116:119] offset:17408
    v_fma_mix_f32 v48, v132, v32, v40 op_sel_hi:[1,0,0]
    v_fma_mix_f32 v49, v132, v33, v41 op_sel:[1,0,0] op_sel_hi:[1,0,0]
    v_fma_mix_f32 v50, v133, v34, v42 op_sel_hi:[1,0,0]
    v_fma_mix_f32 v51, v133, v35, v43 op_sel:[1,0,0] op_sel_hi:[1,0,0]
    v_fma_mix_f32 v52, v134, v36, v44 op_sel_hi:[1,0,0]
    v_fma_mix_f32 v53, v134, v37, v45 op_sel:[1,0,0] op_sel_hi:[1,0,0]
    v_fma_mix_f32 v54, v135, v38, v46 op_sel_hi:[1,0,0]
    v_fma_mix_f32 v55, v135, v39, v47 op_sel:[1,0,0] op_sel_hi:[1,0,0]
    v_cvt_pk_bf16_f32 v132, v48, v49
    v_cvt_pk_bf16_f32 v133, v50, v51
    v_cvt_pk_bf16_f32 v134, v52, v53
    v_cvt_pk_bf16_f32 v135, v54, v55
    buffer_load_dwordx4 v[164:167], v188, s[52:55], s62 offen nt
    s_add_u32 s62, s62, 12288
    buffer_load_dwordx4 v[168:171], v188, s[52:55], s62 offen nt
    s_add_u32 s62, s62, 12288
    ds_write_b128 v15, v[120:123] offset:18432
    v_fma_mix_f32 v48, v136, v32, v40 op_sel_hi:[1,0,0]
    v_fma_mix_f32 v49, v136, v33, v41 op_sel:[1,0,0] op_sel_hi:[1,0,0]
    v_fma_mix_f32 v50, v137, v34, v42 op_sel_hi:[1,0,0]
    v_fma_mix_f32 v51, v137, v35, v43 op_sel:[1,0,0] op_sel_hi:[1,0,0]
    v_fma_mix_f32 v52, v138, v36, v44 op_sel_hi:[1,0,0]
    v_fma_mix_f32 v53, v138, v37, v45 op_sel:[1,0,0] op_sel_hi:[1,0,0]
    v_fma_mix_f32 v54, v139, v38, v46 op_sel_hi:[1,0,0]
    v_fma_mix_f32 v55, v139, v39, v47 op_sel:[1,0,0] op_sel_hi:[1,0,0]
    v_cvt_pk_bf16_f32 v136, v48, v49
    v_cvt_pk_bf16_f32 v137, v50, v51
    v_cvt_pk_bf16_f32 v138, v52, v53
    v_cvt_pk_bf16_f32 v139, v54, v55
    buffer_load_dwordx4 v[172:175], v188, s[52:55], s62 offen nt
    s_add_u32 s62, s62, 12288
    ds_write_b128 v16, v[124:127] offset:19456
    v_fma_mix_f32 v48, v140, v32, v40 op_sel_hi:[1,0,0]
    v_fma_mix_f32 v49, v140, v33, v41 op_sel:[1,0,0] op_sel_hi:[1,0,0]
    v_fma_mix_f32 v50, v141, v34, v42 op_sel_hi:[1,0,0]
    v_fma_mix_f32 v51, v141, v35, v43 op_sel:[1,0,0] op_sel_hi:[1,0,0]
    v_fma_mix_f32 v52, v142, v36, v44 op_sel_hi:[1,0,0]
    v_fma_mix_f32 v53, v142, v37, v45 op_sel:[1,0,0] op_sel_hi:[1,0,0]
    v_fma_mix_f32 v54, v143, v38, v46 op_sel_hi:[1,0,0]
    v_fma_mix_f32 v55, v143, v39, v47 op_sel:[1,0,0] op_sel_hi:[1,0,0]
    v_cvt_pk_bf16_f32 v140, v48, v49
    v_cvt_pk_bf16_f32 v141, v50, v51
    v_cvt_pk_bf16_f32 v142, v52, v53
    v_cvt_pk_bf16_f32 v143, v54, v55
    ds_read_b128 v[32:35], v18 offset:7680
    ds_read_b128 v[36:39], v18 offset:7696
    ds_read_b128 v[40:43], v18 offset:7712
    ds_read_b128 v[44:47], v18 offset:7728
    s_waitcnt vmcnt(18) lgkmcnt(4)
    s_barrier
    s_waitcnt vmcnt(14) lgkmcnt(0)
    ds_write_b128 v15, v[128:131] offset:0
    v_fma_mix_f32 v48, v64, v32, v40 op_sel_hi:[1,0,0]
    v_fma_mix_f32 v49, v64, v33, v41 op_sel:[1,0,0] op_sel_hi:[1,0,0]
    v_fma_mix_f32 v50, v65, v34, v42 op_sel_hi:[1,0,0]
    v_fma_mix_f32 v51, v65, v35, v43 op_sel:[1,0,0] op_sel_hi:[1,0,0]
    v_fma_mix_f32 v52, v66, v36, v44 op_sel_hi:[1,0,0]
    v_fma_mix_f32 v53, v66, v37, v45 op_sel:[1,0,0] op_sel_hi:[1,0,0]
    v_fma_mix_f32 v54, v67, v38, v46 op_sel_hi:[1,0,0]
    v_fma_mix_f32 v55, v67, v39, v47 op_sel:[1,0,0] op_sel_hi:[1,0,0]
    v_cvt_pk_bf16_f32 v64, v48, v49
    v_cvt_pk_bf16_f32 v65, v50, v51
    v_cvt_pk_bf16_f32 v66, v52, v53
    v_cvt_pk_bf16_f32 v67, v54, v55
    ds_write_b128 v16, v[132:135] offset:1024
    v_fma_mix_f32 v48, v68, v32, v40 op_sel_hi:[1,0,0]
    v_fma_mix_f32 v49, v68, v33, v41 op_sel:[1,0,0] op_sel_hi:[1,0,0]
    v_fma_mix_f32 v50, v69, v34, v42 op_sel_hi:[1,0,0]
    v_fma_mix_f32 v51, v69, v35, v43 op_sel:[1,0,0] op_sel_hi:[1,0,0]
    v_fma_mix_f32 v52, v70, v36, v44 op_sel_hi:[1,0,0]
    v_fma_mix_f32 v53, v70, v37, v45 op_sel:[1,0,0] op_sel_hi:[1,0,0]
    v_fma_mix_f32 v54, v71, v38, v46 op_sel_hi:[1,0,0]
    v_fma_mix_f32 v55, v71, v39, v47 op_sel:[1,0,0] op_sel_hi:[1,0,0]
    v_cvt_pk_bf16_f32 v68, v48, v49
    v_cvt_pk_bf16_f32 v69, v50, v51
    v_cvt_pk_bf16_f32 v70, v52, v53
    v_cvt_pk_bf16_f32 v71, v54, v55
    ds_write_b128 v15, v[136:139] offset:2048
    v_fma_mix_f32 v48, v72, v32, v40 op_sel_hi:[1,0,0]
    v_fma_mix_f32 v49, v72, v33, v41 op_sel:[1,0,0] op_sel_hi:[1,0,0]
    v_fma_mix_f32 v50, v73, v34, v42 op_sel_hi:[1,0,0]
    v_fma_mix_f32 v51, v73, v35, v43 op_sel:[1,0,0] op_sel_hi:[1,0,0]
    v_fma_mix_f32 v52, v74, v36, v44 op_sel_hi:[1,0,0]
    v_fma_mix_f32 v53, v74, v37, v45 op_sel:[1,0,0] op_sel_hi:[1,0,0]
    v_fma_mix_f32 v54, v75, v38, v46 op_sel_hi:[1,0,0]
    v_fma_mix_f32 v55, v75, v39, v47 op_sel:[1,0,0] op_sel_hi:[1,0,0]
    v_cvt_pk_bf16_f32 v72, v48, v49
    v_cvt_pk_bf16_f32 v73, v50, v51
    v_cvt_pk_bf16_f32 v74, v52, v53
    v_cvt_pk_bf16_f32 v75, v54, v55
    ds_write_b128 v16, v[140:143] offset:3072
    v_fma_mix_f32 v48, v76, v32, v40 op_sel_hi:[1,0,0]
    v_fma_mix_f32 v49, v76, v33, v41 op_sel:[1,0,0] op_sel_hi:[1,0,0]
    v_fma_mix_f32 v50, v77, v34, v42 op_sel_hi:[1,0,0]
    v_fma_mix_f32 v51, v77, v35, v43 op_sel:[1,0,0] op_sel_hi:[1,0,0]
    v_fma_mix_f32 v52, v78, v36, v44 op_sel_hi:[1,0,0]
    v_fma_mix_f32 v53, v78, v37, v45 op_sel:[1,0,0] op_sel_hi:[1,0,0]
    v_fma_mix_f32 v54, v79, v38, v46 op_sel_hi:[1,0,0]
    v_fma_mix_f32 v55, v79, v39, v47 op_sel:[1,0,0] op_sel_hi:[1,0,0]
    v_cvt_pk_bf16_f32 v76, v48, v49
    v_cvt_pk_bf16_f32 v77, v50, v51
    v_cvt_pk_bf16_f32 v78, v52, v53
    v_cvt_pk_bf16_f32 v79, v54, v55
    s_waitcnt vmcnt(11) lgkmcnt(0)
    s_barrier
    ds_write_b128 v15, v[64:67] offset:16384
    ds_write_b128 v16, v[68:71] offset:17408
    ds_write_b128 v15, v[72:75] offset:18432
    ds_write_b128 v16, v[76:79] offset:19456
    s_waitcnt vmcnt(4) lgkmcnt(0)
    s_barrier
    v_perm_b32 v24, v148, v144, s60
    v_perm_b32 v25, v148, v144, s61
    v_perm_b32 v26, v149, v145, s60
    v_perm_b32 v27, v149, v145, s61
    v_perm_b32 v28, v150, v146, s60
    v_perm_b32 v29, v150, v146, s61
    v_perm_b32 v30, v151, v147, s60
    v_perm_b32 v31, v151, v147, s61
    v_dot2c_f32_bf16 v180, v24, v176
    v_dot2c_f32_bf16 v181, v25, v176
    v_dot2c_f32_bf16 v182, v26, v176
    v_dot2c_f32_bf16 v183, v27, v176
    v_dot2c_f32_bf16 v184, v28, v176
    v_dot2c_f32_bf16 v185, v29, v176
    v_dot2c_f32_bf16 v186, v30, v176
    v_dot2c_f32_bf16 v187, v31, v176
    v_perm_b32 v24, v156, v152, s60
    v_perm_b32 v25, v156, v152, s61
    v_perm_b32 v26, v157, v153, s60
    v_perm_b32 v27, v157, v153, s61
    v_perm_b32 v28, v158, v154, s60
    v_perm_b32 v29, v158, v154, s61
    v_perm_b32 v30, v159, v155, s60
    v_perm_b32 v31, v159, v155, s61
    v_dot2c_f32_bf16 v180, v24, v177
    v_dot2c_f32_bf16 v181, v25, v177
    v_dot2c_f32_bf16 v182, v26, v177
    v_dot2c_f32_bf16 v183, v27, v177
    v_dot2c_f32_bf16 v184, v28, v177
    v_dot2c_f32_bf16 v185, v29, v177
    v_dot2c_f32_bf16 v186, v30, v177
    v_dot2c_f32_bf16 v187, v31, v177
    s_waitcnt vmcnt(2)
    v_perm_b32 v24, v164, v160, s60
    v_perm_b32 v25, v164, v160, s61
    v_perm_b32 v26, v165, v161, s60
    v_perm_b32 v27, v165, v161, s61
    v_perm_b32 v28, v166, v162, s60
    v_perm_b32 v29, v166, v162, s61
    v_perm_b32 v30, v167, v163, s60
    v_perm_b32 v31, v167, v163, s61
    v_dot2c_f32_bf16 v180, v24, v178
    v_dot2c_f32_bf16 v181, v25, v178
    v_dot2c_f32_bf16 v182, v26, v178
    v_dot2c_f32_bf16 v183, v27, v178
    v_dot2c_f32_bf16 v184, v28, v178
    v_dot2c_f32_bf16 v185, v29, v178
    v_dot2c_f32_bf16 v186, v30, v178
    v_dot2c_f32_bf16 v187, v31, v178
    s_waitcnt vmcnt(0)
    v_perm_b32 v24, v172, v168, s60
    v_perm_b32 v25, v172, v168, s61
    v_perm_b32 v26, v173, v169, s60
    v_perm_b32 v27, v173, v169, s61
    v_perm_b32 v28, v174, v170, s60
    v_perm_b32 v29, v174, v170, s61
    v_perm_b32 v30, v175, v171, s60
    v_perm_b32 v31, v175, v171, s61
    v_dot2c_f32_bf16 v180, v24, v179
    v_dot2c_f32_bf16 v181, v25, v179
    v_dot2c_f32_bf16 v182, v26, v179
    v_dot2c_f32_bf16 v183, v27, v179
    v_dot2c_f32_bf16 v184, v28, v179
    v_dot2c_f32_bf16 v185, v29, v179
    v_dot2c_f32_bf16 v186, v30, v179
    v_dot2c_f32_bf16 v187, v31, v179
    s_nop 3
    v_permlane32_swap_b32 v180, v184
    v_permlane32_swap_b32 v181, v185
    v_permlane32_swap_b32 v182, v186
    v_permlane32_swap_b32 v183, v187
    v_add_f32 v180, v180, v184
    v_add_f32 v181, v181, v185
    v_add_f32 v182, v182, v186
    v_add_f32 v183, v183, v187
    s_nop 0
    v_permlane16_swap_b32 v180, v182
    v_permlane16_swap_b32 v181, v183
    s_nop 0
    v_add_f32 v180, v180, v182
    v_add_f32 v181, v181, v183
    s_nop 0
    v_add_f32_dpp v180, v180, v180 row_ror:4 row_mask:0xf bank_mask:0xf
    v_add_f32_dpp v181, v181, v181 row_ror:4 row_mask:0xf bank_mask:0xf
    s_nop 0
    v_add_f32_dpp v180, v180, v180 row_ror:8 row_mask:0xf bank_mask:0xf
    v_add_f32_dpp v181, v181, v181 row_ror:8 row_mask:0xf bank_mask:0xf
    buffer_store_dwordx2 v[180:181], v189, s[56:59], s63 offen
    s_endpgm
L_kb_compute:
    v_bfe_u32 v3, v2, 2, 3
    v_lshl_add_u32 v3, v1, 4, v3
    s_movk_i32 s37, 6144
    v_mul_lo_u32 v3, v3, s37
    v_lshrrev_b32 v4, 5, v2
    v_lshl_add_u32 v3, v4, 6, v3
    v_and_b32 v4, 3, v2
    v_lshl_add_u32 v21, v4, 4, v3
    v_lshlrev_b32 v23, 5, v0
    s_mov_b32 s58, 0x60000
    s_mov_b32 s59, 0x00020000
    s_waitcnt lgkmcnt(0)
    s_mov_b32 s56, s8
    s_mov_b32 s57, s9
    s_mov_b32 s37, 32768
    buffer_load_dwordx4 v[64:67], v23, s[56:59], s37 offen offset:0
    buffer_load_dwordx4 v[68:71], v23, s[56:59], s37 offen offset:16
    s_mov_b32 s37, 40960
    buffer_load_dwordx4 v[72:75], v23, s[56:59], s37 offen offset:0
    buffer_load_dwordx4 v[76:79], v23, s[56:59], s37 offen offset:16
    s_mov_b32 s37, 49152
    buffer_load_dwordx4 v[80:83], v23, s[56:59], s37 offen offset:0
    buffer_load_dwordx4 v[84:87], v23, s[56:59], s37 offen offset:16
    s_mov_b32 s37, 57344
    buffer_load_dwordx4 v[88:91], v23, s[56:59], s37 offen offset:0
    buffer_load_dwordx4 v[92:95], v23, s[56:59], s37 offen offset:16
    s_mov_b32 s16, s4
    s_mov_b32 s17, s5
    s_add_u32 m0, s36, 41984
    s_add_u32 s38, s34, 51200
    buffer_load_dwordx4 v21, s[16:19], s38 offen lds
    s_add_u32 m0, s36, 49152
    s_add_u32 s38, s34, 4096
    buffer_load_dwordx4 v21, s[16:19], s38 offen lds
    s_add_u32 m0, s36, 50176
    s_add_u32 s38, s34, 53248
    buffer_load_dwordx4 v21, s[16:19], s38 offen lds
    s_add_u32 m0, s36, 66560
    s_add_u32 s38, s34, 444416
    buffer_load_dwordx4 v21, s[16:19], s38 offen lds
    s_add_u32 m0, s36, 73728
    s_add_u32 s38, s34, 397312
    buffer_load_dwordx4 v21, s[16:19], s38 offen lds
    s_add_u32 m0, s36, 74752
    s_add_u32 s38, s34, 446464
    buffer_load_dwordx4 v21, s[16:19], s38 offen lds
    s_add_u32 s20, s8, 0x500000
    s_addc_u32 s21, s9, 0
    s_mov_b32 s22, 0xc00000
    s_mov_b32 s23, 0x00020000
    s_add_u32 s48, s8, 0x1c00000
    s_addc_u32 s49, s9, 0
    s_mov_b32 s50, 0x118000
    s_mov_b32 s51, 0x00020000
    v_lshlrev_b32 v3, 4, v0
    v_mov_b32 v24, -1
    v_mov_b32 v25, -1
    v_mov_b32 v26, -1
    v_mov_b32 v27, -1
    s_lshl_b32 s37, s2, 12
    buffer_store_dwordx4 v[24:27], v3, s[48:51], s37 offen sc1
    s_add_u32 s37, s37, 0x100000
    buffer_store_dwordx4 v[24:27], v3, s[48:51], s37 offen sc1
    v_and_b32 v3, 31, v2
    v_lshrrev_b32 v4, 5, v2
    v_bfe_u32 v5, v2, 1, 3
    s_lshl_b32 s37, s31, 13
    v_lshlrev_b32 v6, 7, v3
    v_add_u32 v6, s37, v6
    v_add_u32 v7, 0, v4
    v_xor_b32 v7, v7, v5
    v_lshl_add_u32 v8, v7, 4, v6
    v_add_u32 v7, 2, v4
    v_xor_b32 v7, v7, v5
    v_lshl_add_u32 v9, v7, 4, v6
    v_add_u32 v7, 4, v4
    v_xor_b32 v7, v7, v5
    v_lshl_add_u32 v10, v7, 4, v6
    v_add_u32 v7, 6, v4
    v_xor_b32 v7, v7, v5
    v_lshl_add_u32 v11, v7, 4, v6
    v_lshlrev_b32 v6, 10, v4
    v_bfe_u32 v7, v2, 2, 2
    v_lshl_add_u32 v6, v7, 6, v6
    v_bfe_u32 v7, v2, 4, 1
    v_lshl_add_u32 v6, v7, 5, v6
    v_and_b32 v7, 3, v2
    v_lshl_add_u32 v6, v7, 3, v6
    s_lshl_b32 s37, s32, 9
    s_add_u32 s37, s37, 32768
    v_add_u32 v12, s37, v6
    v_add_u32 v13, 49152, v12
    v_bfe_u32 v7, v2, 2, 2
    v_lshrrev_b32 v6, 4, v2
    v_xor_b32 v6, v6, v7
    v_lshlrev_b32 v6, 4, v6
    v_and_b32 v7, 15, v2
    v_lshl_add_u32 v6, v7, 6, v6
    s_lshl_b32 s37, s32, 17
    s_lshl_b32 s39, s31, 12
    s_add_u32 s37, s37, s39
    v_add_u32 v17, s37, v6
    v_xor_b32 v18, 16, v17
    s_lshl_b32 s40, s27, 18
    s_lshl_b32 s39, s26, 13
    s_add_u32 s40, s40, s39
    v_lshrrev_b32 v56, 4, v2
    v_bfe_u32 v57, v2, 2, 2
    v_cmp_gt_u32 vcc, 1, v56
    s_movk_i32 s37, 6144
    v_mul_lo_u32 v56, v56, s37
    v_lshl_add_u32 v56, v57, 11, v56
    v_and_b32 v58, 3, v2
    v_lshl_add_u32 v56, v58, 7, v56
    v_mov_b32 v58, 0x7fffffff
    v_cndmask_b32 v56, v58, v56, vcc
    v_cmp_gt_u32 vcc, 3, v57
    v_cndmask_b32 v56, v58, v56, vcc
    s_lshr_b32 s64, s2, 3
    s_lshl_b32 s64, s64, 2
    s_add_u32 s64, s64, s30
    s_mul_i32 s64, s64, 6144
    s_bfe_u32 s65, s2, 0x20001
    s_lshl_b32 s65, s65, 9
    s_add_u32 s64, s64, s65
    v_add_u32 v58, s64, v56
    v_cmp_gt_i32 vcc, 0, v58
    v_cndmask_b32 v56, v58, v56, vcc
    v_and_b32 v22, 1, v0
    v_cvt_f32_u32 v22, v22
    v_sub_f32 v22, 1.0, v22
    v_add_u32 v23, 131072, v23
    s_waitcnt vmcnt(12)
    v_add_f32 v64, v64, v72
    v_add_f32 v65, v65, v73
    v_add_f32 v66, v66, v74
    v_add_f32 v67, v67, v75
    v_add_f32 v68, v68, v76
    v_add_f32 v69, v69, v77
    v_add_f32 v70, v70, v78
    v_add_f32 v71, v71, v79
    s_waitcnt vmcnt(8)
    v_add_f32 v80, v80, v88
    v_add_f32 v81, v81, v89
    v_add_f32 v82, v82, v90
    v_add_f32 v83, v83, v91
    v_add_f32 v84, v84, v92
    v_add_f32 v85, v85, v93
    v_add_f32 v86, v86, v94
    v_add_f32 v87, v87, v95
    v_add_f32 v64, v64, v80
    v_add_f32 v65, v65, v81
    v_add_f32 v66, v66, v82
    v_add_f32 v67, v67, v83
    v_add_f32 v68, v68, v84
    v_add_f32 v69, v69, v85
    v_add_f32 v70, v70, v86
    v_add_f32 v71, v71, v87
    v_cvt_pk_bf16_f32 v72, v64, v65
    v_cvt_pk_bf16_f32 v73, v66, v67
    v_cvt_pk_bf16_f32 v74, v68, v69
    v_cvt_pk_bf16_f32 v75, v70, v71
    v_lshlrev_b32 v64, 16, v72
    v_and_b32 v65, 0xffff0000, v72
    v_lshlrev_b32 v66, 16, v73
    v_and_b32 v67, 0xffff0000, v73
    v_lshlrev_b32 v68, 16, v74
    v_and_b32 v69, 0xffff0000, v74
    v_lshlrev_b32 v70, 16, v75
    v_and_b32 v71, 0xffff0000, v75
    v_add_f32 v64, v64, v22
    v_add_f32 v65, v65, v22
    v_add_f32 v66, v66, v22
    v_add_f32 v67, v67, v22
    v_add_f32 v68, v68, v22
    v_add_f32 v69, v69, v22
    v_add_f32 v70, v70, v22
    v_add_f32 v71, v71, v22
    v_cvt_pk_bf16_f32 v72, v64, v65
    v_cvt_pk_bf16_f32 v73, v66, v67
    v_cvt_pk_bf16_f32 v74, v68, v69
    v_cvt_pk_bf16_f32 v75, v70, v71
    v_lshlrev_b32 v64, 16, v72
    v_and_b32 v65, 0xffff0000, v72
    v_lshlrev_b32 v66, 16, v73
    v_and_b32 v67, 0xffff0000, v73
    v_lshlrev_b32 v68, 16, v74
    v_and_b32 v69, 0xffff0000, v74
    v_lshlrev_b32 v70, 16, v75
    v_and_b32 v71, 0xffff0000, v75
    ds_write_b128 v23, v[64:67]
    ds_write_b128 v23, v[68:71] offset:16
    s_waitcnt lgkmcnt(0)
    s_barrier
    s_waitcnt vmcnt(5)
    s_barrier
    ds_read_b128 v[160:163], v8 offset:0
    ds_read_b64_tr_b16 v[168:169], v12 offset:0
    ds_read_b64_tr_b16 v[170:171], v12 offset:256
    ds_read_b128 v[164:167], v8 offset:4096
    ds_read_b64_tr_b16 v[172:173], v12 offset:8192
    ds_read_b64_tr_b16 v[174:175], v12 offset:8448
    ds_read_b64_tr_b16 v[176:177], v12 offset:16384
    ds_read_b64_tr_b16 v[178:179], v12 offset:16640
    s_waitcnt lgkmcnt(5)
    v_mfma_f32_32x32x16_bf16 v[64:79], v[168:171], v[160:163], 0
    s_waitcnt lgkmcnt(4)
    ds_read_b128 v[180:183], v9 offset:0
    ds_read_b64_tr_b16 v[188:189], v12 offset:2048
    ds_read_b64_tr_b16 v[190:191], v12 offset:2304
    v_mfma_f32_32x32x16_bf16 v[80:95], v[168:171], v[164:167], 0
    s_waitcnt lgkmcnt(5)
    ds_read_b128 v[184:187], v9 offset:4096
    ds_read_b64_tr_b16 v[192:193], v12 offset:10240
    ds_read_b64_tr_b16 v[194:195], v12 offset:10496
    v_mfma_f32_32x32x16_bf16 v[96:111], v[172:175], v[160:163], 0
    s_add_u32 m0, s36, 91136
    s_add_u32 s38, s34, 837632
    buffer_load_dwordx4 v21, s[16:19], s38 offen lds
    ds_read_b64_tr_b16 v[196:197], v12 offset:18432
    ds_read_b64_tr_b16 v[198:199], v12 offset:18688
    v_mfma_f32_32x32x16_bf16 v[112:127], v[172:175], v[164:167], 0
    s_waitcnt lgkmcnt(8)
    v_mfma_f32_32x32x16_bf16 v[128:143], v[160:163], v[176:179], 0
    v_mfma_f32_32x32x16_bf16 v[144:159], v[164:167], v[176:179], 0
    s_waitcnt lgkmcnt(5)
    v_mfma_f32_32x32x16_bf16 v[64:79], v[188:191], v[180:183], v[64:79]
    s_waitcnt lgkmcnt(4)
    ds_read_b128 v[160:163], v10 offset:0
    ds_read_b64_tr_b16 v[168:169], v12 offset:4096
    ds_read_b64_tr_b16 v[170:171], v12 offset:4352
    v_mfma_f32_32x32x16_bf16 v[80:95], v[188:191], v[184:187], v[80:95]
    s_waitcnt lgkmcnt(5)
    ds_read_b128 v[164:167], v10 offset:4096
    ds_read_b64_tr_b16 v[172:173], v12 offset:12288
    ds_read_b64_tr_b16 v[174:175], v12 offset:12544
    v_mfma_f32_32x32x16_bf16 v[96:111], v[192:195], v[180:183], v[96:111]
    s_add_u32 m0, s36, 98304
    s_add_u32 s38, s34, 790528
    buffer_load_dwordx4 v21, s[16:19], s38 offen lds
    ds_read_b64_tr_b16 v[176:177], v12 offset:20480
    ds_read_b64_tr_b16 v[178:179], v12 offset:20736
    v_mfma_f32_32x32x16_bf16 v[112:127], v[192:195], v[184:187], v[112:127]
    s_waitcnt lgkmcnt(8)
    v_mfma_f32_32x32x16_bf16 v[128:143], v[180:183], v[196:199], v[128:143]
    v_mfma_f32_32x32x16_bf16 v[144:159], v[184:187], v[196:199], v[144:159]
    s_waitcnt lgkmcnt(5)
    v_mfma_f32_32x32x16_bf16 v[64:79], v[168:171], v[160:163], v[64:79]
    s_waitcnt lgkmcnt(4)
    ds_read_b128 v[180:183], v11 offset:0
    ds_read_b64_tr_b16 v[188:189], v12 offset:6144
    ds_read_b64_tr_b16 v[190:191], v12 offset:6400
    v_mfma_f32_32x32x16_bf16 v[80:95], v[168:171], v[164:167], v[80:95]
    s_waitcnt lgkmcnt(5)
    ds_read_b128 v[184:187], v11 offset:4096
    ds_read_b64_tr_b16 v[192:193], v12 offset:14336
    ds_read_b64_tr_b16 v[194:195], v12 offset:14592
    v_mfma_f32_32x32x16_bf16 v[96:111], v[172:175], v[160:163], v[96:111]
    s_add_u32 m0, s36, 99328
    s_add_u32 s38, s34, 839680
    buffer_load_dwordx4 v21, s[16:19], s38 offen lds
    ds_read_b64_tr_b16 v[196:197], v12 offset:22528
    ds_read_b64_tr_b16 v[198:199], v12 offset:22784
    v_mfma_f32_32x32x16_bf16 v[112:127], v[172:175], v[164:167], v[112:127]
    s_waitcnt lgkmcnt(8)
    v_mfma_f32_32x32x16_bf16 v[128:143], v[160:163], v[176:179], v[128:143]
    v_mfma_f32_32x32x16_bf16 v[144:159], v[164:167], v[176:179], v[144:159]
    s_waitcnt lgkmcnt(5)
    v_mfma_f32_32x32x16_bf16 v[64:79], v[188:191], v[180:183], v[64:79]
    s_waitcnt lgkmcnt(4)
    v_mfma_f32_32x32x16_bf16 v[80:95], v[188:191], v[184:187], v[80:95]
    s_waitcnt vmcnt(5) lgkmcnt(0)
    s_barrier
    ds_read_b128 v[160:163], v8 offset:16384
    ds_read_b64_tr_b16 v[168:169], v12 offset:24576
    ds_read_b64_tr_b16 v[170:171], v12 offset:24832
    v_mfma_f32_32x32x16_bf16 v[96:111], v[192:195], v[180:183], v[96:111]
    ds_read_b128 v[164:167], v8 offset:20480
    ds_read_b64_tr_b16 v[172:173], v12 offset:32768
    ds_read_b64_tr_b16 v[174:175], v12 offset:33024
    v_mfma_f32_32x32x16_bf16 v[112:127], v[192:195], v[184:187], v[112:127]
    ds_read_b64_tr_b16 v[176:177], v12 offset:40960
    ds_read_b64_tr_b16 v[178:179], v12 offset:41216
    v_mfma_f32_32x32x16_bf16 v[128:143], v[180:183], v[196:199], v[128:143]
    v_mfma_f32_32x32x16_bf16 v[144:159], v[184:187], v[196:199], v[144:159]
    s_waitcnt lgkmcnt(5)
    v_mfma_f32_32x32x16_bf16 v[64:79], v[168:171], v[160:163], v[64:79]
    s_waitcnt lgkmcnt(4)
    ds_read_b128 v[180:183], v9 offset:16384
    ds_read_b64_tr_b16 v[188:189], v12 offset:26624
    ds_read_b64_tr_b16 v[190:191], v12 offset:26880
    v_mfma_f32_32x32x16_bf16 v[80:95], v[168:171], v[164:167], v[80:95]
    s_waitcnt lgkmcnt(5)
    ds_read_b128 v[184:187], v9 offset:20480
    ds_read_b64_tr_b16 v[192:193], v12 offset:34816
    ds_read_b64_tr_b16 v[194:195], v12 offset:35072
    v_mfma_f32_32x32x16_bf16 v[96:111], v[172:175], v[160:163], v[96:111]
    s_add_u32 m0, s36, 115712
    s_add_u32 s38, s34, 1230848
    buffer_load_dwordx4 v21, s[16:19], s38 offen lds
    ds_read_b64_tr_b16 v[196:197], v12 offset:43008
    ds_read_b64_tr_b16 v[198:199], v12 offset:43264
    v_mfma_f32_32x32x16_bf16 v[112:127], v[172:175], v[164:167], v[112:127]
    s_waitcnt lgkmcnt(8)
    v_mfma_f32_32x32x16_bf16 v[128:143], v[160:163], v[176:179], v[128:143]
    s_add_u32 m0, s36, 122880
    s_add_u32 s38, s34, 1183744
    buffer_load_dwordx4 v21, s[16:19], s38 offen lds
    v_mfma_f32_32x32x16_bf16 v[144:159], v[164:167], v[176:179], v[144:159]
    s_waitcnt lgkmcnt(5)
    v_mfma_f32_32x32x16_bf16 v[64:79], v[188:191], v[180:183], v[64:79]
    s_waitcnt lgkmcnt(4)
    ds_read_b128 v[160:163], v10 offset:16384
    ds_read_b64_tr_b16 v[168:169], v12 offset:28672
    ds_read_b64_tr_b16 v[170:171], v12 offset:28928
    v_mfma_f32_32x32x16_bf16 v[80:95], v[188:191], v[184:187], v[80:95]
    s_waitcnt lgkmcnt(5)
    ds_read_b128 v[164:167], v10 offset:20480
    ds_read_b64_tr_b16 v[172:173], v12 offset:36864
    ds_read_b64_tr_b16 v[174:175], v12 offset:37120
    v_mfma_f32_32x32x16_bf16 v[96:111], v[192:195], v[180:183], v[96:111]
    s_add_u32 m0, s36, 123904
    s_add_u32 s38, s34, 1232896
    buffer_load_dwordx4 v21, s[16:19], s38 offen lds
    ds_read_b64_tr_b16 v[176:177], v12 offset:45056
    ds_read_b64_tr_b16 v[178:179], v12 offset:45312
    v_mfma_f32_32x32x16_bf16 v[112:127], v[192:195], v[184:187], v[112:127]
    s_waitcnt lgkmcnt(8)
    v_mfma_f32_32x32x16_bf16 v[128:143], v[180:183], v[196:199], v[128:143]
    s_add_u32 m0, s36, 41984
    s_add_u32 s38, s34, 1624064
    buffer_load_dwordx4 v21, s[16:19], s38 offen lds
    v_mfma_f32_32x32x16_bf16 v[144:159], v[184:187], v[196:199], v[144:159]
    s_waitcnt lgkmcnt(5)
    v_mfma_f32_32x32x16_bf16 v[64:79], v[168:171], v[160:163], v[64:79]
    s_waitcnt lgkmcnt(4)
    ds_read_b128 v[180:183], v11 offset:16384
    ds_read_b64_tr_b16 v[188:189], v12 offset:30720
    ds_read_b64_tr_b16 v[190:191], v12 offset:30976
    v_mfma_f32_32x32x16_bf16 v[80:95], v[168:171], v[164:167], v[80:95]
    s_waitcnt lgkmcnt(5)
    ds_read_b128 v[184:187], v11 offset:20480
    ds_read_b64_tr_b16 v[192:193], v12 offset:38912
    ds_read_b64_tr_b16 v[194:195], v12 offset:39168
    v_mfma_f32_32x32x16_bf16 v[96:111], v[172:175], v[160:163], v[96:111]
    s_add_u32 m0, s36, 49152
    s_add_u32 s38, s34, 1576960
    buffer_load_dwordx4 v21, s[16:19], s38 offen lds
    ds_read_b64_tr_b16 v[196:197], v12 offset:47104
    ds_read_b64_tr_b16 v[198:199], v12 offset:47360
    v_mfma_f32_32x32x16_bf16 v[112:127], v[172:175], v[164:167], v[112:127]
    s_waitcnt lgkmcnt(8)
    v_mfma_f32_32x32x16_bf16 v[128:143], v[160:163], v[176:179], v[128:143]
    s_add_u32 m0, s36, 50176
    s_add_u32 s38, s34, 1626112
    buffer_load_dwordx4 v21, s[16:19], s38 offen lds
    v_mfma_f32_32x32x16_bf16 v[144:159], v[164:167], v[176:179], v[144:159]
    s_waitcnt lgkmcnt(5)
    v_mfma_f32_32x32x16_bf16 v[64:79], v[188:191], v[180:183], v[64:79]
    s_waitcnt lgkmcnt(4)
    v_mfma_f32_32x32x16_bf16 v[80:95], v[188:191], v[184:187], v[80:95]
    s_waitcnt vmcnt(6) lgkmcnt(0)
    s_barrier
    ds_read_b128 v[160:163], v8 offset:0
    ds_read_b64_tr_b16 v[168:169], v13 offset:0
    ds_read_b64_tr_b16 v[170:171], v13 offset:256
    v_mfma_f32_32x32x16_bf16 v[96:111], v[192:195], v[180:183], v[96:111]
    ds_read_b128 v[164:167], v8 offset:4096
    ds_read_b64_tr_b16 v[172:173], v13 offset:8192
    ds_read_b64_tr_b16 v[174:175], v13 offset:8448
    v_mfma_f32_32x32x16_bf16 v[112:127], v[192:195], v[184:187], v[112:127]
    ds_read_b64_tr_b16 v[176:177], v13 offset:16384
    ds_read_b64_tr_b16 v[178:179], v13 offset:16640
    v_mfma_f32_32x32x16_bf16 v[128:143], v[180:183], v[196:199], v[128:143]
    v_mfma_f32_32x32x16_bf16 v[144:159], v[184:187], v[196:199], v[144:159]
    s_waitcnt lgkmcnt(5)
    v_mfma_f32_32x32x16_bf16 v[64:79], v[168:171], v[160:163], v[64:79]
    s_waitcnt lgkmcnt(4)
    ds_read_b128 v[180:183], v9 offset:0
    ds_read_b64_tr_b16 v[188:189], v13 offset:2048
    ds_read_b64_tr_b16 v[190:191], v13 offset:2304
    v_mfma_f32_32x32x16_bf16 v[80:95], v[168:171], v[164:167], v[80:95]
    s_waitcnt lgkmcnt(5)
    ds_read_b128 v[184:187], v9 offset:4096
    ds_read_b64_tr_b16 v[192:193], v13 offset:10240
    ds_read_b64_tr_b16 v[194:195], v13 offset:10496
    v_mfma_f32_32x32x16_bf16 v[96:111], v[172:175], v[160:163], v[96:111]
    s_add_u32 m0, s36, 66560
    s_add_u32 s38, s34, 2017280
    buffer_load_dwordx4 v21, s[16:19], s38 offen lds
    ds_read_b64_tr_b16 v[196:197], v13 offset:18432
    ds_read_b64_tr_b16 v[198:199], v13 offset:18688
    v_mfma_f32_32x32x16_bf16 v[112:127], v[172:175], v[164:167], v[112:127]
    s_waitcnt lgkmcnt(8)
    v_mfma_f32_32x32x16_bf16 v[128:143], v[160:163], v[176:179], v[128:143]
    v_mfma_f32_32x32x16_bf16 v[144:159], v[164:167], v[176:179], v[144:159]
    s_waitcnt lgkmcnt(5)
    v_mfma_f32_32x32x16_bf16 v[64:79], v[188:191], v[180:183], v[64:79]
    s_waitcnt lgkmcnt(4)
    ds_read_b128 v[160:163], v10 offset:0
    ds_read_b64_tr_b16 v[168:169], v13 offset:4096
    ds_read_b64_tr_b16 v[170:171], v13 offset:4352
    v_mfma_f32_32x32x16_bf16 v[80:95], v[188:191], v[184:187], v[80:95]
    s_waitcnt lgkmcnt(5)
    ds_read_b128 v[164:167], v10 offset:4096
    ds_read_b64_tr_b16 v[172:173], v13 offset:12288
    ds_read_b64_tr_b16 v[174:175], v13 offset:12544
    v_mfma_f32_32x32x16_bf16 v[96:111], v[192:195], v[180:183], v[96:111]
    s_add_u32 m0, s36, 73728
    s_add_u32 s38, s34, 1970176
    buffer_load_dwordx4 v21, s[16:19], s38 offen lds
    ds_read_b64_tr_b16 v[176:177], v13 offset:20480
    ds_read_b64_tr_b16 v[178:179], v13 offset:20736
    v_mfma_f32_32x32x16_bf16 v[112:127], v[192:195], v[184:187], v[112:127]
    s_waitcnt lgkmcnt(8)
    v_mfma_f32_32x32x16_bf16 v[128:143], v[180:183], v[196:199], v[128:143]
    v_mfma_f32_32x32x16_bf16 v[144:159], v[184:187], v[196:199], v[144:159]
    s_waitcnt lgkmcnt(5)
    v_mfma_f32_32x32x16_bf16 v[64:79], v[168:171], v[160:163], v[64:79]
    s_waitcnt lgkmcnt(4)
    ds_read_b128 v[180:183], v11 offset:0
    ds_read_b64_tr_b16 v[188:189], v13 offset:6144
    ds_read_b64_tr_b16 v[190:191], v13 offset:6400
    v_mfma_f32_32x32x16_bf16 v[80:95], v[168:171], v[164:167], v[80:95]
    s_waitcnt lgkmcnt(5)
    ds_read_b128 v[184:187], v11 offset:4096
    ds_read_b64_tr_b16 v[192:193], v13 offset:14336
    ds_read_b64_tr_b16 v[194:195], v13 offset:14592
    v_mfma_f32_32x32x16_bf16 v[96:111], v[172:175], v[160:163], v[96:111]
    s_add_u32 m0, s36, 74752
    s_add_u32 s38, s34, 2019328
    buffer_load_dwordx4 v21, s[16:19], s38 offen lds
    ds_read_b64_tr_b16 v[196:197], v13 offset:22528
    ds_read_b64_tr_b16 v[198:199], v13 offset:22784
    v_mfma_f32_32x32x16_bf16 v[112:127], v[172:175], v[164:167], v[112:127]
    s_waitcnt lgkmcnt(8)
    v_mfma_f32_32x32x16_bf16 v[128:143], v[160:163], v[176:179], v[128:143]
    v_mfma_f32_32x32x16_bf16 v[144:159], v[164:167], v[176:179], v[144:159]
    s_waitcnt lgkmcnt(5)
    v_mfma_f32_32x32x16_bf16 v[64:79], v[188:191], v[180:183], v[64:79]
    s_waitcnt lgkmcnt(4)
    v_mfma_f32_32x32x16_bf16 v[80:95], v[188:191], v[184:187], v[80:95]
    s_waitcnt vmcnt(6) lgkmcnt(0)
    s_barrier
    ds_read_b128 v[160:163], v8 offset:16384
    ds_read_b64_tr_b16 v[168:169], v13 offset:24576
    ds_read_b64_tr_b16 v[170:171], v13 offset:24832
    v_mfma_f32_32x32x16_bf16 v[96:111], v[192:195], v[180:183], v[96:111]
    ds_read_b128 v[164:167], v8 offset:20480
    ds_read_b64_tr_b16 v[172:173], v13 offset:32768
    ds_read_b64_tr_b16 v[174:175], v13 offset:33024
    v_mfma_f32_32x32x16_bf16 v[112:127], v[192:195], v[184:187], v[112:127]
    ds_read_b64_tr_b16 v[176:177], v13 offset:40960
    ds_read_b64_tr_b16 v[178:179], v13 offset:41216
    v_mfma_f32_32x32x16_bf16 v[128:143], v[180:183], v[196:199], v[128:143]
    v_mfma_f32_32x32x16_bf16 v[144:159], v[184:187], v[196:199], v[144:159]
    s_waitcnt lgkmcnt(5)
    v_mfma_f32_32x32x16_bf16 v[64:79], v[168:171], v[160:163], v[64:79]
    s_waitcnt lgkmcnt(4)
    ds_read_b128 v[180:183], v9 offset:16384
    ds_read_b64_tr_b16 v[188:189], v13 offset:26624
    ds_read_b64_tr_b16 v[190:191], v13 offset:26880
    v_mfma_f32_32x32x16_bf16 v[80:95], v[168:171], v[164:167], v[80:95]
    s_waitcnt lgkmcnt(5)
    ds_read_b128 v[184:187], v9 offset:20480
    ds_read_b64_tr_b16 v[192:193], v13 offset:34816
    ds_read_b64_tr_b16 v[194:195], v13 offset:35072
    v_mfma_f32_32x32x16_bf16 v[96:111], v[172:175], v[160:163], v[96:111]
    s_add_u32 m0, s36, 91136
    s_add_u32 s38, s34, 2410496
    buffer_load_dwordx4 v21, s[16:19], s38 offen lds
    ds_read_b64_tr_b16 v[196:197], v13 offset:43008
    ds_read_b64_tr_b16 v[198:199], v13 offset:43264
    v_mfma_f32_32x32x16_bf16 v[112:127], v[172:175], v[164:167], v[112:127]
    s_waitcnt lgkmcnt(8)
    v_mfma_f32_32x32x16_bf16 v[128:143], v[160:163], v[176:179], v[128:143]
    v_mfma_f32_32x32x16_bf16 v[144:159], v[164:167], v[176:179], v[144:159]
    s_waitcnt lgkmcnt(5)
    v_mfma_f32_32x32x16_bf16 v[64:79], v[188:191], v[180:183], v[64:79]
    s_waitcnt lgkmcnt(4)
    ds_read_b128 v[160:163], v10 offset:16384
    ds_read_b64_tr_b16 v[168:169], v13 offset:28672
    ds_read_b64_tr_b16 v[170:171], v13 offset:28928
    v_mfma_f32_32x32x16_bf16 v[80:95], v[188:191], v[184:187], v[80:95]
    s_waitcnt lgkmcnt(5)
    ds_read_b128 v[164:167], v10 offset:20480
    ds_read_b64_tr_b16 v[172:173], v13 offset:36864
    ds_read_b64_tr_b16 v[174:175], v13 offset:37120
    v_mfma_f32_32x32x16_bf16 v[96:111], v[192:195], v[180:183], v[96:111]
    s_add_u32 m0, s36, 98304
    s_add_u32 s38, s34, 2363392
    buffer_load_dwordx4 v21, s[16:19], s38 offen lds
    ds_read_b64_tr_b16 v[176:177], v13 offset:45056
    ds_read_b64_tr_b16 v[178:179], v13 offset:45312
    v_mfma_f32_32x32x16_bf16 v[112:127], v[192:195], v[184:187], v[112:127]
    s_waitcnt lgkmcnt(8)
    v_mfma_f32_32x32x16_bf16 v[128:143], v[180:183], v[196:199], v[128:143]
    v_mfma_f32_32x32x16_bf16 v[144:159], v[184:187], v[196:199], v[144:159]
    s_waitcnt lgkmcnt(5)
    v_mfma_f32_32x32x16_bf16 v[64:79], v[168:171], v[160:163], v[64:79]
    s_waitcnt lgkmcnt(4)
    ds_read_b128 v[180:183], v11 offset:16384
    ds_read_b64_tr_b16 v[188:189], v13 offset:30720
    ds_read_b64_tr_b16 v[190:191], v13 offset:30976
    v_mfma_f32_32x32x16_bf16 v[80:95], v[168:171], v[164:167], v[80:95]
    s_waitcnt lgkmcnt(5)
    ds_read_b128 v[184:187], v11 offset:20480
    ds_read_b64_tr_b16 v[192:193], v13 offset:38912
    ds_read_b64_tr_b16 v[194:195], v13 offset:39168
    v_mfma_f32_32x32x16_bf16 v[96:111], v[172:175], v[160:163], v[96:111]
    s_add_u32 m0, s36, 99328
    s_add_u32 s38, s34, 2412544
    buffer_load_dwordx4 v21, s[16:19], s38 offen lds
    ds_read_b64_tr_b16 v[196:197], v13 offset:47104
    ds_read_b64_tr_b16 v[198:199], v13 offset:47360
    v_mfma_f32_32x32x16_bf16 v[112:127], v[172:175], v[164:167], v[112:127]
    s_waitcnt lgkmcnt(8)
    v_add_u32 v58, 3932160, v56
    buffer_load_dword v57, v58, s[16:19], 0 offen
    v_mfma_f32_32x32x16_bf16 v[128:143], v[160:163], v[176:179], v[128:143]
    v_mfma_f32_32x32x16_bf16 v[144:159], v[164:167], v[176:179], v[144:159]
    s_waitcnt lgkmcnt(5)
    v_mfma_f32_32x32x16_bf16 v[64:79], v[188:191], v[180:183], v[64:79]
    s_waitcnt lgkmcnt(4)
    v_mfma_f32_32x32x16_bf16 v[80:95], v[188:191], v[184:187], v[80:95]
    s_waitcnt vmcnt(7) lgkmcnt(0)
    s_barrier
    ds_read_b128 v[160:163], v8 offset:0
    ds_read_b64_tr_b16 v[168:169], v12 offset:0
    ds_read_b64_tr_b16 v[170:171], v12 offset:256
    v_mfma_f32_32x32x16_bf16 v[96:111], v[192:195], v[180:183], v[96:111]
    ds_read_b128 v[164:167], v8 offset:4096
    ds_read_b64_tr_b16 v[172:173], v12 offset:8192
    ds_read_b64_tr_b16 v[174:175], v12 offset:8448
    v_mfma_f32_32x32x16_bf16 v[112:127], v[192:195], v[184:187], v[112:127]
    ds_read_b64_tr_b16 v[176:177], v12 offset:16384
    ds_read_b64_tr_b16 v[178:179], v12 offset:16640
    v_mfma_f32_32x32x16_bf16 v[128:143], v[180:183], v[196:199], v[128:143]
    v_mfma_f32_32x32x16_bf16 v[144:159], v[184:187], v[196:199], v[144:159]
    s_waitcnt lgkmcnt(5)
    v_mfma_f32_32x32x16_bf16 v[64:79], v[168:171], v[160:163], v[64:79]
    s_waitcnt lgkmcnt(4)
    ds_read_b128 v[180:183], v9 offset:0
    ds_read_b64_tr_b16 v[188:189], v12 offset:2048
    ds_read_b64_tr_b16 v[190:191], v12 offset:2304
    v_mfma_f32_32x32x16_bf16 v[80:95], v[168:171], v[164:167], v[80:95]
    s_waitcnt lgkmcnt(5)
    ds_read_b128 v[184:187], v9 offset:4096
    ds_read_b64_tr_b16 v[192:193], v12 offset:10240
    ds_read_b64_tr_b16 v[194:195], v12 offset:10496
    v_mfma_f32_32x32x16_bf16 v[96:111], v[172:175], v[160:163], v[96:111]
    s_add_u32 m0, s36, 115712
    s_add_u32 s38, s34, 2803712
    buffer_load_dwordx4 v21, s[16:19], s38 offen lds
    ds_read_b64_tr_b16 v[196:197], v12 offset:18432
    ds_read_b64_tr_b16 v[198:199], v12 offset:18688
    v_mfma_f32_32x32x16_bf16 v[112:127], v[172:175], v[164:167], v[112:127]
    s_waitcnt lgkmcnt(8)
    v_mfma_f32_32x32x16_bf16 v[128:143], v[160:163], v[176:179], v[128:143]
    v_mfma_f32_32x32x16_bf16 v[144:159], v[164:167], v[176:179], v[144:159]
    s_waitcnt lgkmcnt(5)
    v_mfma_f32_32x32x16_bf16 v[64:79], v[188:191], v[180:183], v[64:79]
    s_waitcnt lgkmcnt(4)
    ds_read_b128 v[160:163], v10 offset:0
    ds_read_b64_tr_b16 v[168:169], v12 offset:4096
    ds_read_b64_tr_b16 v[170:171], v12 offset:4352
    v_mfma_f32_32x32x16_bf16 v[80:95], v[188:191], v[184:187], v[80:95]
    s_waitcnt lgkmcnt(5)
    ds_read_b128 v[164:167], v10 offset:4096
    ds_read_b64_tr_b16 v[172:173], v12 offset:12288
    ds_read_b64_tr_b16 v[174:175], v12 offset:12544
    v_mfma_f32_32x32x16_bf16 v[96:111], v[192:195], v[180:183], v[96:111]
    s_add_u32 m0, s36, 122880
    s_add_u32 s38, s34, 2756608
    buffer_load_dwordx4 v21, s[16:19], s38 offen lds
    ds_read_b64_tr_b16 v[176:177], v12 offset:20480
    ds_read_b64_tr_b16 v[178:179], v12 offset:20736
    v_mfma_f32_32x32x16_bf16 v[112:127], v[192:195], v[184:187], v[112:127]
    s_waitcnt lgkmcnt(8)
    v_mfma_f32_32x32x16_bf16 v[128:143], v[180:183], v[196:199], v[128:143]
    v_mfma_f32_32x32x16_bf16 v[144:159], v[184:187], v[196:199], v[144:159]
    s_waitcnt lgkmcnt(5)
    v_mfma_f32_32x32x16_bf16 v[64:79], v[168:171], v[160:163], v[64:79]
    s_waitcnt lgkmcnt(4)
    ds_read_b128 v[180:183], v11 offset:0
    ds_read_b64_tr_b16 v[188:189], v12 offset:6144
    ds_read_b64_tr_b16 v[190:191], v12 offset:6400
    v_mfma_f32_32x32x16_bf16 v[80:95], v[168:171], v[164:167], v[80:95]
    s_waitcnt lgkmcnt(5)
    ds_read_b128 v[184:187], v11 offset:4096
    ds_read_b64_tr_b16 v[192:193], v12 offset:14336
    ds_read_b64_tr_b16 v[194:195], v12 offset:14592
    v_mfma_f32_32x32x16_bf16 v[96:111], v[172:175], v[160:163], v[96:111]
    s_add_u32 m0, s36, 123904
    s_add_u32 s38, s34, 2805760
    buffer_load_dwordx4 v21, s[16:19], s38 offen lds
    ds_read_b64_tr_b16 v[196:197], v12 offset:22528
    ds_read_b64_tr_b16 v[198:199], v12 offset:22784
    v_mfma_f32_32x32x16_bf16 v[112:127], v[172:175], v[164:167], v[112:127]
    s_waitcnt lgkmcnt(8)
    v_mfma_f32_32x32x16_bf16 v[128:143], v[160:163], v[176:179], v[128:143]
    v_mfma_f32_32x32x16_bf16 v[144:159], v[164:167], v[176:179], v[144:159]
    s_waitcnt lgkmcnt(5)
    v_mfma_f32_32x32x16_bf16 v[64:79], v[188:191], v[180:183], v[64:79]
    s_waitcnt lgkmcnt(4)
    v_mfma_f32_32x32x16_bf16 v[80:95], v[188:191], v[184:187], v[80:95]
    s_waitcnt vmcnt(7) lgkmcnt(0)
    s_barrier
    ds_read_b128 v[160:163], v8 offset:16384
    ds_read_b64_tr_b16 v[168:169], v12 offset:24576
    ds_read_b64_tr_b16 v[170:171], v12 offset:24832
    v_mfma_f32_32x32x16_bf16 v[96:111], v[192:195], v[180:183], v[96:111]
    ds_read_b128 v[164:167], v8 offset:20480
    ds_read_b64_tr_b16 v[172:173], v12 offset:32768
    ds_read_b64_tr_b16 v[174:175], v12 offset:33024
    v_mfma_f32_32x32x16_bf16 v[112:127], v[192:195], v[184:187], v[112:127]
    ds_read_b64_tr_b16 v[176:177], v12 offset:40960
    ds_read_b64_tr_b16 v[178:179], v12 offset:41216
    v_mfma_f32_32x32x16_bf16 v[128:143], v[180:183], v[196:199], v[128:143]
    v_mfma_f32_32x32x16_bf16 v[144:159], v[184:187], v[196:199], v[144:159]
    s_waitcnt lgkmcnt(5)
    v_mfma_f32_32x32x16_bf16 v[64:79], v[168:171], v[160:163], v[64:79]
    s_waitcnt lgkmcnt(4)
    ds_read_b128 v[180:183], v9 offset:16384
    ds_read_b64_tr_b16 v[188:189], v12 offset:26624
    ds_read_b64_tr_b16 v[190:191], v12 offset:26880
    v_mfma_f32_32x32x16_bf16 v[80:95], v[168:171], v[164:167], v[80:95]
    s_waitcnt lgkmcnt(5)
    ds_read_b128 v[184:187], v9 offset:20480
    ds_read_b64_tr_b16 v[192:193], v12 offset:34816
    ds_read_b64_tr_b16 v[194:195], v12 offset:35072
    v_mfma_f32_32x32x16_bf16 v[96:111], v[172:175], v[160:163], v[96:111]
    s_add_u32 m0, s36, 41984
    s_add_u32 s38, s34, 3196928
    buffer_load_dwordx4 v21, s[16:19], s38 offen lds
    ds_read_b64_tr_b16 v[196:197], v12 offset:43008
    ds_read_b64_tr_b16 v[198:199], v12 offset:43264
    v_mfma_f32_32x32x16_bf16 v[112:127], v[172:175], v[164:167], v[112:127]
    s_waitcnt lgkmcnt(8)
    v_mfma_f32_32x32x16_bf16 v[128:143], v[160:163], v[176:179], v[128:143]
    v_mfma_f32_32x32x16_bf16 v[144:159], v[164:167], v[176:179], v[144:159]
    s_waitcnt lgkmcnt(5)
    v_mfma_f32_32x32x16_bf16 v[64:79], v[188:191], v[180:183], v[64:79]
    s_waitcnt lgkmcnt(4)
    ds_read_b128 v[160:163], v10 offset:16384
    ds_read_b64_tr_b16 v[168:169], v12 offset:28672
    ds_read_b64_tr_b16 v[170:171], v12 offset:28928
    v_mfma_f32_32x32x16_bf16 v[80:95], v[188:191], v[184:187], v[80:95]
    s_waitcnt lgkmcnt(5)
    ds_read_b128 v[164:167], v10 offset:20480
    ds_read_b64_tr_b16 v[172:173], v12 offset:36864
    ds_read_b64_tr_b16 v[174:175], v12 offset:37120
    v_mfma_f32_32x32x16_bf16 v[96:111], v[192:195], v[180:183], v[96:111]
    s_add_u32 m0, s36, 49152
    s_add_u32 s38, s34, 3149824
    buffer_load_dwordx4 v21, s[16:19], s38 offen lds
    ds_read_b64_tr_b16 v[176:177], v12 offset:45056
    ds_read_b64_tr_b16 v[178:179], v12 offset:45312
    v_mfma_f32_32x32x16_bf16 v[112:127], v[192:195], v[184:187], v[112:127]
    s_waitcnt lgkmcnt(8)
    v_mfma_f32_32x32x16_bf16 v[128:143], v[180:183], v[196:199], v[128:143]
    v_mfma_f32_32x32x16_bf16 v[144:159], v[184:187], v[196:199], v[144:159]
    s_waitcnt lgkmcnt(5)
    v_mfma_f32_32x32x16_bf16 v[64:79], v[168:171], v[160:163], v[64:79]
    s_waitcnt lgkmcnt(4)
    ds_read_b128 v[180:183], v11 offset:16384
    ds_read_b64_tr_b16 v[188:189], v12 offset:30720
    ds_read_b64_tr_b16 v[190:191], v12 offset:30976
    v_mfma_f32_32x32x16_bf16 v[80:95], v[168:171], v[164:167], v[80:95]
    s_waitcnt lgkmcnt(5)
    ds_read_b128 v[184:187], v11 offset:20480
    ds_read_b64_tr_b16 v[192:193], v12 offset:38912
    ds_read_b64_tr_b16 v[194:195], v12 offset:39168
    v_mfma_f32_32x32x16_bf16 v[96:111], v[172:175], v[160:163], v[96:111]
    s_add_u32 m0, s36, 50176
    s_add_u32 s38, s34, 3198976
    buffer_load_dwordx4 v21, s[16:19], s38 offen lds
    ds_read_b64_tr_b16 v[196:197], v12 offset:47104
    ds_read_b64_tr_b16 v[198:199], v12 offset:47360
    v_mfma_f32_32x32x16_bf16 v[112:127], v[172:175], v[164:167], v[112:127]
    s_waitcnt lgkmcnt(8)
    v_add_u32 v58, 4718592, v56
    buffer_load_dword v57, v58, s[16:19], 0 offen
    v_mfma_f32_32x32x16_bf16 v[128:143], v[160:163], v[176:179], v[128:143]
    v_mfma_f32_32x32x16_bf16 v[144:159], v[164:167], v[176:179], v[144:159]
    s_waitcnt lgkmcnt(5)
    v_mfma_f32_32x32x16_bf16 v[64:79], v[188:191], v[180:183], v[64:79]
    s_waitcnt lgkmcnt(4)
    v_mfma_f32_32x32x16_bf16 v[80:95], v[188:191], v[184:187], v[80:95]
    s_waitcnt vmcnt(8) lgkmcnt(0)
    s_barrier
    ds_read_b128 v[160:163], v8 offset:0
    ds_read_b64_tr_b16 v[168:169], v13 offset:0
    ds_read_b64_tr_b16 v[170:171], v13 offset:256
    v_mfma_f32_32x32x16_bf16 v[96:111], v[192:195], v[180:183], v[96:111]
    ds_read_b128 v[164:167], v8 offset:4096
    ds_read_b64_tr_b16 v[172:173], v13 offset:8192
    ds_read_b64_tr_b16 v[174:175], v13 offset:8448
    v_mfma_f32_32x32x16_bf16 v[112:127], v[192:195], v[184:187], v[112:127]
    ds_read_b64_tr_b16 v[176:177], v13 offset:16384
    ds_read_b64_tr_b16 v[178:179], v13 offset:16640
    v_mfma_f32_32x32x16_bf16 v[128:143], v[180:183], v[196:199], v[128:143]
    v_mfma_f32_32x32x16_bf16 v[144:159], v[184:187], v[196:199], v[144:159]
    s_waitcnt lgkmcnt(5)
    v_mfma_f32_32x32x16_bf16 v[64:79], v[168:171], v[160:163], v[64:79]
    s_waitcnt lgkmcnt(4)
    ds_read_b128 v[180:183], v9 offset:0
    ds_read_b64_tr_b16 v[188:189], v13 offset:2048
    ds_read_b64_tr_b16 v[190:191], v13 offset:2304
    v_mfma_f32_32x32x16_bf16 v[80:95], v[168:171], v[164:167], v[80:95]
    s_waitcnt lgkmcnt(5)
    ds_read_b128 v[184:187], v9 offset:4096
    ds_read_b64_tr_b16 v[192:193], v13 offset:10240
    ds_read_b64_tr_b16 v[194:195], v13 offset:10496
    v_mfma_f32_32x32x16_bf16 v[96:111], v[172:175], v[160:163], v[96:111]
    s_add_u32 m0, s36, 66560
    s_add_u32 s38, s34, 3590144
    buffer_load_dwordx4 v21, s[16:19], s38 offen lds
    ds_read_b64_tr_b16 v[196:197], v13 offset:18432
    ds_read_b64_tr_b16 v[198:199], v13 offset:18688
    v_mfma_f32_32x32x16_bf16 v[112:127], v[172:175], v[164:167], v[112:127]
    s_waitcnt lgkmcnt(8)
    v_mfma_f32_32x32x16_bf16 v[128:143], v[160:163], v[176:179], v[128:143]
    v_mfma_f32_32x32x16_bf16 v[144:159], v[164:167], v[176:179], v[144:159]
    s_waitcnt lgkmcnt(5)
    v_mfma_f32_32x32x16_bf16 v[64:79], v[188:191], v[180:183], v[64:79]
    s_waitcnt lgkmcnt(4)
    ds_read_b128 v[160:163], v10 offset:0
    ds_read_b64_tr_b16 v[168:169], v13 offset:4096
    ds_read_b64_tr_b16 v[170:171], v13 offset:4352
    v_mfma_f32_32x32x16_bf16 v[80:95], v[188:191], v[184:187], v[80:95]
    s_waitcnt lgkmcnt(5)
    ds_read_b128 v[164:167], v10 offset:4096
    ds_read_b64_tr_b16 v[172:173], v13 offset:12288
    ds_read_b64_tr_b16 v[174:175], v13 offset:12544
    v_mfma_f32_32x32x16_bf16 v[96:111], v[192:195], v[180:183], v[96:111]
    s_add_u32 m0, s36, 73728
    s_add_u32 s38, s34, 3543040
    buffer_load_dwordx4 v21, s[16:19], s38 offen lds
    ds_read_b64_tr_b16 v[176:177], v13 offset:20480
    ds_read_b64_tr_b16 v[178:179], v13 offset:20736
    v_mfma_f32_32x32x16_bf16 v[112:127], v[192:195], v[184:187], v[112:127]
    s_waitcnt lgkmcnt(8)
    v_mfma_f32_32x32x16_bf16 v[128:143], v[180:183], v[196:199], v[128:143]
    v_mfma_f32_32x32x16_bf16 v[144:159], v[184:187], v[196:199], v[144:159]
    s_waitcnt lgkmcnt(5)
    v_mfma_f32_32x32x16_bf16 v[64:79], v[168:171], v[160:163], v[64:79]
    s_waitcnt lgkmcnt(4)
    ds_read_b128 v[180:183], v11 offset:0
    ds_read_b64_tr_b16 v[188:189], v13 offset:6144
    ds_read_b64_tr_b16 v[190:191], v13 offset:6400
    v_mfma_f32_32x32x16_bf16 v[80:95], v[168:171], v[164:167], v[80:95]
    s_waitcnt lgkmcnt(5)
    ds_read_b128 v[184:187], v11 offset:4096
    ds_read_b64_tr_b16 v[192:193], v13 offset:14336
    ds_read_b64_tr_b16 v[194:195], v13 offset:14592
    v_mfma_f32_32x32x16_bf16 v[96:111], v[172:175], v[160:163], v[96:111]
    s_add_u32 m0, s36, 74752
    s_add_u32 s38, s34, 3592192
    buffer_load_dwordx4 v21, s[16:19], s38 offen lds
    ds_read_b64_tr_b16 v[196:197], v13 offset:22528
    ds_read_b64_tr_b16 v[198:199], v13 offset:22784
    v_mfma_f32_32x32x16_bf16 v[112:127], v[172:175], v[164:167], v[112:127]
    s_waitcnt lgkmcnt(8)
    v_mfma_f32_32x32x16_bf16 v[128:143], v[160:163], v[176:179], v[128:143]
    v_mfma_f32_32x32x16_bf16 v[144:159], v[164:167], v[176:179], v[144:159]
    s_waitcnt lgkmcnt(5)
    v_mfma_f32_32x32x16_bf16 v[64:79], v[188:191], v[180:183], v[64:79]
    s_waitcnt lgkmcnt(4)
    v_mfma_f32_32x32x16_bf16 v[80:95], v[188:191], v[184:187], v[80:95]
    s_waitcnt vmcnt(7) lgkmcnt(0)
    s_barrier
    ds_read_b128 v[160:163], v8 offset:16384
    ds_read_b64_tr_b16 v[168:169], v13 offset:24576
    ds_read_b64_tr_b16 v[170:171], v13 offset:24832
    v_mfma_f32_32x32x16_bf16 v[96:111], v[192:195], v[180:183], v[96:111]
    ds_read_b128 v[164:167], v8 offset:20480
    ds_read_b64_tr_b16 v[172:173], v13 offset:32768
    ds_read_b64_tr_b16 v[174:175], v13 offset:33024
    v_mfma_f32_32x32x16_bf16 v[112:127], v[192:195], v[184:187], v[112:127]
    ds_read_b64_tr_b16 v[176:177], v13 offset:40960
    ds_read_b64_tr_b16 v[178:179], v13 offset:41216
    v_mfma_f32_32x32x16_bf16 v[128:143], v[180:183], v[196:199], v[128:143]
    v_mfma_f32_32x32x16_bf16 v[144:159], v[184:187], v[196:199], v[144:159]
    s_waitcnt lgkmcnt(5)
    v_mfma_f32_32x32x16_bf16 v[64:79], v[168:171], v[160:163], v[64:79]
    s_waitcnt lgkmcnt(4)
    ds_read_b128 v[180:183], v9 offset:16384
    ds_read_b64_tr_b16 v[188:189], v13 offset:26624
    ds_read_b64_tr_b16 v[190:191], v13 offset:26880
    v_mfma_f32_32x32x16_bf16 v[80:95], v[168:171], v[164:167], v[80:95]
    s_waitcnt lgkmcnt(5)
    ds_read_b128 v[184:187], v9 offset:20480
    ds_read_b64_tr_b16 v[192:193], v13 offset:34816
    ds_read_b64_tr_b16 v[194:195], v13 offset:35072
    v_mfma_f32_32x32x16_bf16 v[96:111], v[172:175], v[160:163], v[96:111]
    s_add_u32 m0, s36, 91136
    s_add_u32 s38, s34, 3983360
    buffer_load_dwordx4 v21, s[16:19], s38 offen lds
    ds_read_b64_tr_b16 v[196:197], v13 offset:43008
    ds_read_b64_tr_b16 v[198:199], v13 offset:43264
    v_mfma_f32_32x32x16_bf16 v[112:127], v[172:175], v[164:167], v[112:127]
    s_waitcnt lgkmcnt(8)
    v_mfma_f32_32x32x16_bf16 v[128:143], v[160:163], v[176:179], v[128:143]
    v_mfma_f32_32x32x16_bf16 v[144:159], v[164:167], v[176:179], v[144:159]
    s_waitcnt lgkmcnt(5)
    v_mfma_f32_32x32x16_bf16 v[64:79], v[188:191], v[180:183], v[64:79]
    s_waitcnt lgkmcnt(4)
    ds_read_b128 v[160:163], v10 offset:16384
    ds_read_b64_tr_b16 v[168:169], v13 offset:28672
    ds_read_b64_tr_b16 v[170:171], v13 offset:28928
    v_mfma_f32_32x32x16_bf16 v[80:95], v[188:191], v[184:187], v[80:95]
    s_waitcnt lgkmcnt(5)
    ds_read_b128 v[164:167], v10 offset:20480
    ds_read_b64_tr_b16 v[172:173], v13 offset:36864
    ds_read_b64_tr_b16 v[174:175], v13 offset:37120
    v_mfma_f32_32x32x16_bf16 v[96:111], v[192:195], v[180:183], v[96:111]
    s_add_u32 m0, s36, 98304
    s_add_u32 s38, s34, 3936256
    buffer_load_dwordx4 v21, s[16:19], s38 offen lds
    ds_read_b64_tr_b16 v[176:177], v13 offset:45056
    ds_read_b64_tr_b16 v[178:179], v13 offset:45312
    v_mfma_f32_32x32x16_bf16 v[112:127], v[192:195], v[184:187], v[112:127]
    s_waitcnt lgkmcnt(8)
    v_mfma_f32_32x32x16_bf16 v[128:143], v[180:183], v[196:199], v[128:143]
    v_mfma_f32_32x32x16_bf16 v[144:159], v[184:187], v[196:199], v[144:159]
    s_waitcnt lgkmcnt(5)
    v_mfma_f32_32x32x16_bf16 v[64:79], v[168:171], v[160:163], v[64:79]
    s_waitcnt lgkmcnt(4)
    ds_read_b128 v[180:183], v11 offset:16384
    ds_read_b64_tr_b16 v[188:189], v13 offset:30720
    ds_read_b64_tr_b16 v[190:191], v13 offset:30976
    v_mfma_f32_32x32x16_bf16 v[80:95], v[168:171], v[164:167], v[80:95]
    s_waitcnt lgkmcnt(5)
    ds_read_b128 v[184:187], v11 offset:20480
    ds_read_b64_tr_b16 v[192:193], v13 offset:38912
    ds_read_b64_tr_b16 v[194:195], v13 offset:39168
    v_mfma_f32_32x32x16_bf16 v[96:111], v[172:175], v[160:163], v[96:111]
    s_add_u32 m0, s36, 99328
    s_add_u32 s38, s34, 3985408
    buffer_load_dwordx4 v21, s[16:19], s38 offen lds
    ds_read_b64_tr_b16 v[196:197], v13 offset:47104
    ds_read_b64_tr_b16 v[198:199], v13 offset:47360
    v_mfma_f32_32x32x16_bf16 v[112:127], v[172:175], v[164:167], v[112:127]
    s_waitcnt lgkmcnt(8)
    v_add_u32 v58, 5505024, v56
    buffer_load_dword v57, v58, s[16:19], 0 offen
    v_mfma_f32_32x32x16_bf16 v[128:143], v[160:163], v[176:179], v[128:143]
    v_mfma_f32_32x32x16_bf16 v[144:159], v[164:167], v[176:179], v[144:159]
    s_waitcnt lgkmcnt(5)
    v_mfma_f32_32x32x16_bf16 v[64:79], v[188:191], v[180:183], v[64:79]
    s_waitcnt lgkmcnt(4)
    v_mfma_f32_32x32x16_bf16 v[80:95], v[188:191], v[184:187], v[80:95]
    s_waitcnt vmcnt(8) lgkmcnt(0)
    s_barrier
    ds_read_b128 v[160:163], v8 offset:0
    ds_read_b64_tr_b16 v[168:169], v12 offset:0
    ds_read_b64_tr_b16 v[170:171], v12 offset:256
    v_mfma_f32_32x32x16_bf16 v[96:111], v[192:195], v[180:183], v[96:111]
    ds_read_b128 v[164:167], v8 offset:4096
    ds_read_b64_tr_b16 v[172:173], v12 offset:8192
    ds_read_b64_tr_b16 v[174:175], v12 offset:8448
    v_mfma_f32_32x32x16_bf16 v[112:127], v[192:195], v[184:187], v[112:127]
    ds_read_b64_tr_b16 v[176:177], v12 offset:16384
    ds_read_b64_tr_b16 v[178:179], v12 offset:16640
    v_mfma_f32_32x32x16_bf16 v[128:143], v[180:183], v[196:199], v[128:143]
    v_mfma_f32_32x32x16_bf16 v[144:159], v[184:187], v[196:199], v[144:159]
    s_waitcnt lgkmcnt(5)
    v_mfma_f32_32x32x16_bf16 v[64:79], v[168:171], v[160:163], v[64:79]
    s_waitcnt lgkmcnt(4)
    ds_read_b128 v[180:183], v9 offset:0
    ds_read_b64_tr_b16 v[188:189], v12 offset:2048
    ds_read_b64_tr_b16 v[190:191], v12 offset:2304
    v_mfma_f32_32x32x16_bf16 v[80:95], v[168:171], v[164:167], v[80:95]
    s_waitcnt lgkmcnt(5)
    ds_read_b128 v[184:187], v9 offset:4096
    ds_read_b64_tr_b16 v[192:193], v12 offset:10240
    ds_read_b64_tr_b16 v[194:195], v12 offset:10496
    v_mfma_f32_32x32x16_bf16 v[96:111], v[172:175], v[160:163], v[96:111]
    s_add_u32 m0, s36, 115712
    s_add_u32 s38, s34, 4376576
    buffer_load_dwordx4 v21, s[16:19], s38 offen lds
    ds_read_b64_tr_b16 v[196:197], v12 offset:18432
    ds_read_b64_tr_b16 v[198:199], v12 offset:18688
    v_mfma_f32_32x32x16_bf16 v[112:127], v[172:175], v[164:167], v[112:127]
    s_waitcnt lgkmcnt(8)
    v_mfma_f32_32x32x16_bf16 v[128:143], v[160:163], v[176:179], v[128:143]
    v_mfma_f32_32x32x16_bf16 v[144:159], v[164:167], v[176:179], v[144:159]
    s_waitcnt lgkmcnt(5)
    v_mfma_f32_32x32x16_bf16 v[64:79], v[188:191], v[180:183], v[64:79]
    s_waitcnt lgkmcnt(4)
    ds_read_b128 v[160:163], v10 offset:0
    ds_read_b64_tr_b16 v[168:169], v12 offset:4096
    ds_read_b64_tr_b16 v[170:171], v12 offset:4352
    v_mfma_f32_32x32x16_bf16 v[80:95], v[188:191], v[184:187], v[80:95]
    s_waitcnt lgkmcnt(5)
    ds_read_b128 v[164:167], v10 offset:4096
    ds_read_b64_tr_b16 v[172:173], v12 offset:12288
    ds_read_b64_tr_b16 v[174:175], v12 offset:12544
    v_mfma_f32_32x32x16_bf16 v[96:111], v[192:195], v[180:183], v[96:111]
    s_add_u32 m0, s36, 122880
    s_add_u32 s38, s34, 4329472
    buffer_load_dwordx4 v21, s[16:19], s38 offen lds
    ds_read_b64_tr_b16 v[176:177], v12 offset:20480
    ds_read_b64_tr_b16 v[178:179], v12 offset:20736
    v_mfma_f32_32x32x16_bf16 v[112:127], v[192:195], v[184:187], v[112:127]
    s_waitcnt lgkmcnt(8)
    v_mfma_f32_32x32x16_bf16 v[128:143], v[180:183], v[196:199], v[128:143]
    v_mfma_f32_32x32x16_bf16 v[144:159], v[184:187], v[196:199], v[144:159]
    s_waitcnt lgkmcnt(5)
    v_mfma_f32_32x32x16_bf16 v[64:79], v[168:171], v[160:163], v[64:79]
    s_waitcnt lgkmcnt(4)
    ds_read_b128 v[180:183], v11 offset:0
    ds_read_b64_tr_b16 v[188:189], v12 offset:6144
    ds_read_b64_tr_b16 v[190:191], v12 offset:6400
    v_mfma_f32_32x32x16_bf16 v[80:95], v[168:171], v[164:167], v[80:95]
    s_waitcnt lgkmcnt(5)
    ds_read_b128 v[184:187], v11 offset:4096
    ds_read_b64_tr_b16 v[192:193], v12 offset:14336
    ds_read_b64_tr_b16 v[194:195], v12 offset:14592
    v_mfma_f32_32x32x16_bf16 v[96:111], v[172:175], v[160:163], v[96:111]
    s_add_u32 m0, s36, 123904
    s_add_u32 s38, s34, 4378624
    buffer_load_dwordx4 v21, s[16:19], s38 offen lds
    ds_read_b64_tr_b16 v[196:197], v12 offset:22528
    ds_read_b64_tr_b16 v[198:199], v12 offset:22784
    v_mfma_f32_32x32x16_bf16 v[112:127], v[172:175], v[164:167], v[112:127]
    s_waitcnt lgkmcnt(8)
    v_mfma_f32_32x32x16_bf16 v[128:143], v[160:163], v[176:179], v[128:143]
    v_mfma_f32_32x32x16_bf16 v[144:159], v[164:167], v[176:179], v[144:159]
    s_waitcnt lgkmcnt(5)
    v_mfma_f32_32x32x16_bf16 v[64:79], v[188:191], v[180:183], v[64:79]
    s_waitcnt lgkmcnt(4)
    v_mfma_f32_32x32x16_bf16 v[80:95], v[188:191], v[184:187], v[80:95]
    s_waitcnt vmcnt(7) lgkmcnt(0)
    s_barrier
    ds_read_b128 v[160:163], v8 offset:16384
    ds_read_b64_tr_b16 v[168:169], v12 offset:24576
    ds_read_b64_tr_b16 v[170:171], v12 offset:24832
    v_mfma_f32_32x32x16_bf16 v[96:111], v[192:195], v[180:183], v[96:111]
    ds_read_b128 v[164:167], v8 offset:20480
    ds_read_b64_tr_b16 v[172:173], v12 offset:32768
    ds_read_b64_tr_b16 v[174:175], v12 offset:33024
    v_mfma_f32_32x32x16_bf16 v[112:127], v[192:195], v[184:187], v[112:127]
    ds_read_b64_tr_b16 v[176:177], v12 offset:40960
    ds_read_b64_tr_b16 v[178:179], v12 offset:41216
    v_mfma_f32_32x32x16_bf16 v[128:143], v[180:183], v[196:199], v[128:143]
    v_mfma_f32_32x32x16_bf16 v[144:159], v[184:187], v[196:199], v[144:159]
    s_waitcnt lgkmcnt(5)
    v_mfma_f32_32x32x16_bf16 v[64:79], v[168:171], v[160:163], v[64:79]
    s_waitcnt lgkmcnt(4)
    ds_read_b128 v[180:183], v9 offset:16384
    ds_read_b64_tr_b16 v[188:189], v12 offset:26624
    ds_read_b64_tr_b16 v[190:191], v12 offset:26880
    v_mfma_f32_32x32x16_bf16 v[80:95], v[168:171], v[164:167], v[80:95]
    s_waitcnt lgkmcnt(5)
    ds_read_b128 v[184:187], v9 offset:20480
    ds_read_b64_tr_b16 v[192:193], v12 offset:34816
    ds_read_b64_tr_b16 v[194:195], v12 offset:35072
    v_mfma_f32_32x32x16_bf16 v[96:111], v[172:175], v[160:163], v[96:111]
    s_add_u32 m0, s36, 41984
    s_add_u32 s38, s34, 4769792
    buffer_load_dwordx4 v21, s[16:19], s38 offen lds
    ds_read_b64_tr_b16 v[196:197], v12 offset:43008
    ds_read_b64_tr_b16 v[198:199], v12 offset:43264
    v_mfma_f32_32x32x16_bf16 v[112:127], v[172:175], v[164:167], v[112:127]
    s_waitcnt lgkmcnt(8)
    v_mfma_f32_32x32x16_bf16 v[128:143], v[160:163], v[176:179], v[128:143]
    v_mfma_f32_32x32x16_bf16 v[144:159], v[164:167], v[176:179], v[144:159]
    s_waitcnt lgkmcnt(5)
    v_mfma_f32_32x32x16_bf16 v[64:79], v[188:191], v[180:183], v[64:79]
    s_waitcnt lgkmcnt(4)
    ds_read_b128 v[160:163], v10 offset:16384
    ds_read_b64_tr_b16 v[168:169], v12 offset:28672
    ds_read_b64_tr_b16 v[170:171], v12 offset:28928
    v_mfma_f32_32x32x16_bf16 v[80:95], v[188:191], v[184:187], v[80:95]
    s_waitcnt lgkmcnt(5)
    ds_read_b128 v[164:167], v10 offset:20480
    ds_read_b64_tr_b16 v[172:173], v12 offset:36864
    ds_read_b64_tr_b16 v[174:175], v12 offset:37120
    v_mfma_f32_32x32x16_bf16 v[96:111], v[192:195], v[180:183], v[96:111]
    s_add_u32 m0, s36, 49152
    s_add_u32 s38, s34, 4722688
    buffer_load_dwordx4 v21, s[16:19], s38 offen lds
    ds_read_b64_tr_b16 v[176:177], v12 offset:45056
    ds_read_b64_tr_b16 v[178:179], v12 offset:45312
    v_mfma_f32_32x32x16_bf16 v[112:127], v[192:195], v[184:187], v[112:127]
    s_waitcnt lgkmcnt(8)
    v_mfma_f32_32x32x16_bf16 v[128:143], v[180:183], v[196:199], v[128:143]
    v_mfma_f32_32x32x16_bf16 v[144:159], v[184:187], v[196:199], v[144:159]
    s_waitcnt lgkmcnt(5)
    v_mfma_f32_32x32x16_bf16 v[64:79], v[168:171], v[160:163], v[64:79]
    s_waitcnt lgkmcnt(4)
    ds_read_b128 v[180:183], v11 offset:16384
    ds_read_b64_tr_b16 v[188:189], v12 offset:30720
    ds_read_b64_tr_b16 v[190:191], v12 offset:30976
    v_mfma_f32_32x32x16_bf16 v[80:95], v[168:171], v[164:167], v[80:95]
    s_waitcnt lgkmcnt(5)
    ds_read_b128 v[184:187], v11 offset:20480
    ds_read_b64_tr_b16 v[192:193], v12 offset:38912
    ds_read_b64_tr_b16 v[194:195], v12 offset:39168
    v_mfma_f32_32x32x16_bf16 v[96:111], v[172:175], v[160:163], v[96:111]
    s_add_u32 m0, s36, 50176
    s_add_u32 s38, s34, 4771840
    buffer_load_dwordx4 v21, s[16:19], s38 offen lds
    ds_read_b64_tr_b16 v[196:197], v12 offset:47104
    ds_read_b64_tr_b16 v[198:199], v12 offset:47360
    v_mfma_f32_32x32x16_bf16 v[112:127], v[172:175], v[164:167], v[112:127]
    s_waitcnt lgkmcnt(8)
    v_mfma_f32_32x32x16_bf16 v[128:143], v[160:163], v[176:179], v[128:143]
    v_mfma_f32_32x32x16_bf16 v[144:159], v[164:167], v[176:179], v[144:159]
    s_waitcnt lgkmcnt(5)
    v_mfma_f32_32x32x16_bf16 v[64:79], v[188:191], v[180:183], v[64:79]
    s_waitcnt lgkmcnt(4)
    v_mfma_f32_32x32x16_bf16 v[80:95], v[188:191], v[184:187], v[80:95]
    s_waitcnt vmcnt(7) lgkmcnt(0)
    s_barrier
    ds_read_b128 v[160:163], v8 offset:0
    ds_read_b64_tr_b16 v[168:169], v13 offset:0
    ds_read_b64_tr_b16 v[170:171], v13 offset:256
    v_mfma_f32_32x32x16_bf16 v[96:111], v[192:195], v[180:183], v[96:111]
    ds_read_b128 v[164:167], v8 offset:4096
    ds_read_b64_tr_b16 v[172:173], v13 offset:8192
    ds_read_b64_tr_b16 v[174:175], v13 offset:8448
    v_mfma_f32_32x32x16_bf16 v[112:127], v[192:195], v[184:187], v[112:127]
    ds_read_b64_tr_b16 v[176:177], v13 offset:16384
    ds_read_b64_tr_b16 v[178:179], v13 offset:16640
    v_mfma_f32_32x32x16_bf16 v[128:143], v[180:183], v[196:199], v[128:143]
    v_mfma_f32_32x32x16_bf16 v[144:159], v[184:187], v[196:199], v[144:159]
    s_waitcnt lgkmcnt(5)
    v_mfma_f32_32x32x16_bf16 v[64:79], v[168:171], v[160:163], v[64:79]
    s_waitcnt lgkmcnt(4)
    ds_read_b128 v[180:183], v9 offset:0
    ds_read_b64_tr_b16 v[188:189], v13 offset:2048
    ds_read_b64_tr_b16 v[190:191], v13 offset:2304
    v_mfma_f32_32x32x16_bf16 v[80:95], v[168:171], v[164:167], v[80:95]
    s_waitcnt lgkmcnt(5)
    ds_read_b128 v[184:187], v9 offset:4096
    ds_read_b64_tr_b16 v[192:193], v13 offset:10240
    ds_read_b64_tr_b16 v[194:195], v13 offset:10496
    v_mfma_f32_32x32x16_bf16 v[96:111], v[172:175], v[160:163], v[96:111]
    s_add_u32 m0, s36, 66560
    s_add_u32 s38, s34, 5163008
    buffer_load_dwordx4 v21, s[16:19], s38 offen lds
    ds_read_b64_tr_b16 v[196:197], v13 offset:18432
    ds_read_b64_tr_b16 v[198:199], v13 offset:18688
    v_mfma_f32_32x32x16_bf16 v[112:127], v[172:175], v[164:167], v[112:127]
    s_waitcnt lgkmcnt(8)
    v_mfma_f32_32x32x16_bf16 v[128:143], v[160:163], v[176:179], v[128:143]
    v_mfma_f32_32x32x16_bf16 v[144:159], v[164:167], v[176:179], v[144:159]
    s_waitcnt lgkmcnt(5)
    v_mfma_f32_32x32x16_bf16 v[64:79], v[188:191], v[180:183], v[64:79]
    s_waitcnt lgkmcnt(4)
    ds_read_b128 v[160:163], v10 offset:0
    ds_read_b64_tr_b16 v[168:169], v13 offset:4096
    ds_read_b64_tr_b16 v[170:171], v13 offset:4352
    v_mfma_f32_32x32x16_bf16 v[80:95], v[188:191], v[184:187], v[80:95]
    s_waitcnt lgkmcnt(5)
    ds_read_b128 v[164:167], v10 offset:4096
    ds_read_b64_tr_b16 v[172:173], v13 offset:12288
    ds_read_b64_tr_b16 v[174:175], v13 offset:12544
    v_mfma_f32_32x32x16_bf16 v[96:111], v[192:195], v[180:183], v[96:111]
    s_add_u32 m0, s36, 73728
    s_add_u32 s38, s34, 5115904
    buffer_load_dwordx4 v21, s[16:19], s38 offen lds
    ds_read_b64_tr_b16 v[176:177], v13 offset:20480
    ds_read_b64_tr_b16 v[178:179], v13 offset:20736
    v_mfma_f32_32x32x16_bf16 v[112:127], v[192:195], v[184:187], v[112:127]
    s_waitcnt lgkmcnt(8)
    v_mfma_f32_32x32x16_bf16 v[128:143], v[180:183], v[196:199], v[128:143]
    v_mfma_f32_32x32x16_bf16 v[144:159], v[184:187], v[196:199], v[144:159]
    s_waitcnt lgkmcnt(5)
    v_mfma_f32_32x32x16_bf16 v[64:79], v[168:171], v[160:163], v[64:79]
    s_waitcnt lgkmcnt(4)
    ds_read_b128 v[180:183], v11 offset:0
    ds_read_b64_tr_b16 v[188:189], v13 offset:6144
    ds_read_b64_tr_b16 v[190:191], v13 offset:6400
    v_mfma_f32_32x32x16_bf16 v[80:95], v[168:171], v[164:167], v[80:95]
    s_waitcnt lgkmcnt(5)
    ds_read_b128 v[184:187], v11 offset:4096
    ds_read_b64_tr_b16 v[192:193], v13 offset:14336
    ds_read_b64_tr_b16 v[194:195], v13 offset:14592
    v_mfma_f32_32x32x16_bf16 v[96:111], v[172:175], v[160:163], v[96:111]
    s_add_u32 m0, s36, 74752
    s_add_u32 s38, s34, 5165056
    buffer_load_dwordx4 v21, s[16:19], s38 offen lds
    ds_read_b64_tr_b16 v[196:197], v13 offset:22528
    ds_read_b64_tr_b16 v[198:199], v13 offset:22784
    v_mfma_f32_32x32x16_bf16 v[112:127], v[172:175], v[164:167], v[112:127]
    s_waitcnt lgkmcnt(8)
    v_mfma_f32_32x32x16_bf16 v[128:143], v[160:163], v[176:179], v[128:143]
    v_mfma_f32_32x32x16_bf16 v[144:159], v[164:167], v[176:179], v[144:159]
    s_waitcnt lgkmcnt(5)
    v_mfma_f32_32x32x16_bf16 v[64:79], v[188:191], v[180:183], v[64:79]
    s_waitcnt lgkmcnt(4)
    v_mfma_f32_32x32x16_bf16 v[80:95], v[188:191], v[184:187], v[80:95]
    s_waitcnt vmcnt(6) lgkmcnt(0)
    s_barrier
    ds_read_b128 v[160:163], v8 offset:16384
    ds_read_b64_tr_b16 v[168:169], v13 offset:24576
    ds_read_b64_tr_b16 v[170:171], v13 offset:24832
    v_mfma_f32_32x32x16_bf16 v[96:111], v[192:195], v[180:183], v[96:111]
    ds_read_b128 v[164:167], v8 offset:20480
    ds_read_b64_tr_b16 v[172:173], v13 offset:32768
    ds_read_b64_tr_b16 v[174:175], v13 offset:33024
    v_mfma_f32_32x32x16_bf16 v[112:127], v[192:195], v[184:187], v[112:127]
    ds_read_b64_tr_b16 v[176:177], v13 offset:40960
    ds_read_b64_tr_b16 v[178:179], v13 offset:41216
    v_mfma_f32_32x32x16_bf16 v[128:143], v[180:183], v[196:199], v[128:143]
    v_mfma_f32_32x32x16_bf16 v[144:159], v[184:187], v[196:199], v[144:159]
    s_waitcnt lgkmcnt(5)
    v_mfma_f32_32x32x16_bf16 v[64:79], v[168:171], v[160:163], v[64:79]
    s_waitcnt lgkmcnt(4)
    ds_read_b128 v[180:183], v9 offset:16384
    ds_read_b64_tr_b16 v[188:189], v13 offset:26624
    ds_read_b64_tr_b16 v[190:191], v13 offset:26880
    v_mfma_f32_32x32x16_bf16 v[80:95], v[168:171], v[164:167], v[80:95]
    s_waitcnt lgkmcnt(5)
    ds_read_b128 v[184:187], v9 offset:20480
    ds_read_b64_tr_b16 v[192:193], v13 offset:34816
    ds_read_b64_tr_b16 v[194:195], v13 offset:35072
    v_mfma_f32_32x32x16_bf16 v[96:111], v[172:175], v[160:163], v[96:111]
    s_add_u32 m0, s36, 91136
    s_add_u32 s38, s34, 5556224
    buffer_load_dwordx4 v21, s[16:19], s38 offen lds
    ds_read_b64_tr_b16 v[196:197], v13 offset:43008
    ds_read_b64_tr_b16 v[198:199], v13 offset:43264
    v_mfma_f32_32x32x16_bf16 v[112:127], v[172:175], v[164:167], v[112:127]
    s_waitcnt lgkmcnt(8)
    v_mfma_f32_32x32x16_bf16 v[128:143], v[160:163], v[176:179], v[128:143]
    v_mfma_f32_32x32x16_bf16 v[144:159], v[164:167], v[176:179], v[144:159]
    s_waitcnt lgkmcnt(5)
    v_mfma_f32_32x32x16_bf16 v[64:79], v[188:191], v[180:183], v[64:79]
    s_waitcnt lgkmcnt(4)
    ds_read_b128 v[160:163], v10 offset:16384
    ds_read_b64_tr_b16 v[168:169], v13 offset:28672
    ds_read_b64_tr_b16 v[170:171], v13 offset:28928
    v_mfma_f32_32x32x16_bf16 v[80:95], v[188:191], v[184:187], v[80:95]
    s_waitcnt lgkmcnt(5)
    ds_read_b128 v[164:167], v10 offset:20480
    ds_read_b64_tr_b16 v[172:173], v13 offset:36864
    ds_read_b64_tr_b16 v[174:175], v13 offset:37120
    v_mfma_f32_32x32x16_bf16 v[96:111], v[192:195], v[180:183], v[96:111]
    s_add_u32 m0, s36, 98304
    s_add_u32 s38, s34, 5509120
    buffer_load_dwordx4 v21, s[16:19], s38 offen lds
    ds_read_b64_tr_b16 v[176:177], v13 offset:45056
    ds_read_b64_tr_b16 v[178:179], v13 offset:45312
    v_mfma_f32_32x32x16_bf16 v[112:127], v[192:195], v[184:187], v[112:127]
    s_waitcnt lgkmcnt(8)
    v_mfma_f32_32x32x16_bf16 v[128:143], v[180:183], v[196:199], v[128:143]
    v_mfma_f32_32x32x16_bf16 v[144:159], v[184:187], v[196:199], v[144:159]
    s_waitcnt lgkmcnt(5)
    v_mfma_f32_32x32x16_bf16 v[64:79], v[168:171], v[160:163], v[64:79]
    s_waitcnt lgkmcnt(4)
    ds_read_b128 v[180:183], v11 offset:16384
    ds_read_b64_tr_b16 v[188:189], v13 offset:30720
    ds_read_b64_tr_b16 v[190:191], v13 offset:30976
    v_mfma_f32_32x32x16_bf16 v[80:95], v[168:171], v[164:167], v[80:95]
    s_waitcnt lgkmcnt(5)
    ds_read_b128 v[184:187], v11 offset:20480
    ds_read_b64_tr_b16 v[192:193], v13 offset:38912
    ds_read_b64_tr_b16 v[194:195], v13 offset:39168
    v_mfma_f32_32x32x16_bf16 v[96:111], v[172:175], v[160:163], v[96:111]
    s_add_u32 m0, s36, 99328
    s_add_u32 s38, s34, 5558272
    buffer_load_dwordx4 v21, s[16:19], s38 offen lds
    ds_read_b64_tr_b16 v[196:197], v13 offset:47104
    ds_read_b64_tr_b16 v[198:199], v13 offset:47360
    v_mfma_f32_32x32x16_bf16 v[112:127], v[172:175], v[164:167], v[112:127]
    s_waitcnt lgkmcnt(8)
    v_mfma_f32_32x32x16_bf16 v[128:143], v[160:163], v[176:179], v[128:143]
    v_mfma_f32_32x32x16_bf16 v[144:159], v[164:167], v[176:179], v[144:159]
    s_waitcnt lgkmcnt(5)
    v_mfma_f32_32x32x16_bf16 v[64:79], v[188:191], v[180:183], v[64:79]
    s_waitcnt lgkmcnt(4)
    v_mfma_f32_32x32x16_bf16 v[80:95], v[188:191], v[184:187], v[80:95]
    s_waitcnt vmcnt(6) lgkmcnt(0)
    s_barrier
    ds_read_b128 v[160:163], v8 offset:0
    ds_read_b64_tr_b16 v[168:169], v12 offset:0
    ds_read_b64_tr_b16 v[170:171], v12 offset:256
    v_mfma_f32_32x32x16_bf16 v[96:111], v[192:195], v[180:183], v[96:111]
    ds_read_b128 v[164:167], v8 offset:4096
    ds_read_b64_tr_b16 v[172:173], v12 offset:8192
    ds_read_b64_tr_b16 v[174:175], v12 offset:8448
    v_mfma_f32_32x32x16_bf16 v[112:127], v[192:195], v[184:187], v[112:127]
    ds_read_b64_tr_b16 v[176:177], v12 offset:16384
    ds_read_b64_tr_b16 v[178:179], v12 offset:16640
    v_mfma_f32_32x32x16_bf16 v[128:143], v[180:183], v[196:199], v[128:143]
    v_mfma_f32_32x32x16_bf16 v[144:159], v[184:187], v[196:199], v[144:159]
    s_waitcnt lgkmcnt(5)
    v_mfma_f32_32x32x16_bf16 v[64:79], v[168:171], v[160:163], v[64:79]
    s_waitcnt lgkmcnt(4)
    ds_read_b128 v[180:183], v9 offset:0
    ds_read_b64_tr_b16 v[188:189], v12 offset:2048
    ds_read_b64_tr_b16 v[190:191], v12 offset:2304
    v_mfma_f32_32x32x16_bf16 v[80:95], v[168:171], v[164:167], v[80:95]
    s_waitcnt lgkmcnt(5)
    ds_read_b128 v[184:187], v9 offset:4096
    ds_read_b64_tr_b16 v[192:193], v12 offset:10240
    ds_read_b64_tr_b16 v[194:195], v12 offset:10496
    v_mfma_f32_32x32x16_bf16 v[96:111], v[172:175], v[160:163], v[96:111]
    s_add_u32 m0, s36, 115712
    s_add_u32 s38, s34, 5949440
    buffer_load_dwordx4 v21, s[16:19], s38 offen lds
    ds_read_b64_tr_b16 v[196:197], v12 offset:18432
    ds_read_b64_tr_b16 v[198:199], v12 offset:18688
    v_mfma_f32_32x32x16_bf16 v[112:127], v[172:175], v[164:167], v[112:127]
    s_waitcnt lgkmcnt(8)
    v_mfma_f32_32x32x16_bf16 v[128:143], v[160:163], v[176:179], v[128:143]
    v_mfma_f32_32x32x16_bf16 v[144:159], v[164:167], v[176:179], v[144:159]
    s_waitcnt lgkmcnt(5)
    v_mfma_f32_32x32x16_bf16 v[64:79], v[188:191], v[180:183], v[64:79]
    s_waitcnt lgkmcnt(4)
    ds_read_b128 v[160:163], v10 offset:0
    ds_read_b64_tr_b16 v[168:169], v12 offset:4096
    ds_read_b64_tr_b16 v[170:171], v12 offset:4352
    v_mfma_f32_32x32x16_bf16 v[80:95], v[188:191], v[184:187], v[80:95]
    s_waitcnt lgkmcnt(5)
    ds_read_b128 v[164:167], v10 offset:4096
    ds_read_b64_tr_b16 v[172:173], v12 offset:12288
    ds_read_b64_tr_b16 v[174:175], v12 offset:12544
    v_mfma_f32_32x32x16_bf16 v[96:111], v[192:195], v[180:183], v[96:111]
    s_add_u32 m0, s36, 122880
    s_add_u32 s38, s34, 5902336
    buffer_load_dwordx4 v21, s[16:19], s38 offen lds
    ds_read_b64_tr_b16 v[176:177], v12 offset:20480
    ds_read_b64_tr_b16 v[178:179], v12 offset:20736
    v_mfma_f32_32x32x16_bf16 v[112:127], v[192:195], v[184:187], v[112:127]
    s_waitcnt lgkmcnt(8)
    v_mfma_f32_32x32x16_bf16 v[128:143], v[180:183], v[196:199], v[128:143]
    v_mfma_f32_32x32x16_bf16 v[144:159], v[184:187], v[196:199], v[144:159]
    s_waitcnt lgkmcnt(5)
    v_mfma_f32_32x32x16_bf16 v[64:79], v[168:171], v[160:163], v[64:79]
    s_waitcnt lgkmcnt(4)
    ds_read_b128 v[180:183], v11 offset:0
    ds_read_b64_tr_b16 v[188:189], v12 offset:6144
    ds_read_b64_tr_b16 v[190:191], v12 offset:6400
    v_mfma_f32_32x32x16_bf16 v[80:95], v[168:171], v[164:167], v[80:95]
    s_waitcnt lgkmcnt(5)
    ds_read_b128 v[184:187], v11 offset:4096
    ds_read_b64_tr_b16 v[192:193], v12 offset:14336
    ds_read_b64_tr_b16 v[194:195], v12 offset:14592
    v_mfma_f32_32x32x16_bf16 v[96:111], v[172:175], v[160:163], v[96:111]
    s_add_u32 m0, s36, 123904
    s_add_u32 s38, s34, 5951488
    buffer_load_dwordx4 v21, s[16:19], s38 offen lds
    ds_read_b64_tr_b16 v[196:197], v12 offset:22528
    ds_read_b64_tr_b16 v[198:199], v12 offset:22784
    v_mfma_f32_32x32x16_bf16 v[112:127], v[172:175], v[164:167], v[112:127]
    s_waitcnt lgkmcnt(8)
    v_mfma_f32_32x32x16_bf16 v[128:143], v[160:163], v[176:179], v[128:143]
    v_mfma_f32_32x32x16_bf16 v[144:159], v[164:167], v[176:179], v[144:159]
    s_waitcnt lgkmcnt(5)
    v_mfma_f32_32x32x16_bf16 v[64:79], v[188:191], v[180:183], v[64:79]
    s_waitcnt lgkmcnt(4)
    v_mfma_f32_32x32x16_bf16 v[80:95], v[188:191], v[184:187], v[80:95]
    s_waitcnt vmcnt(6) lgkmcnt(0)
    s_barrier
    ds_read_b128 v[160:163], v8 offset:16384
    ds_read_b64_tr_b16 v[168:169], v12 offset:24576
    ds_read_b64_tr_b16 v[170:171], v12 offset:24832
    v_mfma_f32_32x32x16_bf16 v[96:111], v[192:195], v[180:183], v[96:111]
    ds_read_b128 v[164:167], v8 offset:20480
    ds_read_b64_tr_b16 v[172:173], v12 offset:32768
    ds_read_b64_tr_b16 v[174:175], v12 offset:33024
    v_mfma_f32_32x32x16_bf16 v[112:127], v[192:195], v[184:187], v[112:127]
    ds_read_b64_tr_b16 v[176:177], v12 offset:40960
    ds_read_b64_tr_b16 v[178:179], v12 offset:41216
    v_mfma_f32_32x32x16_bf16 v[128:143], v[180:183], v[196:199], v[128:143]
    v_mfma_f32_32x32x16_bf16 v[144:159], v[184:187], v[196:199], v[144:159]
    s_waitcnt lgkmcnt(5)
    v_mfma_f32_32x32x16_bf16 v[64:79], v[168:171], v[160:163], v[64:79]
    s_waitcnt lgkmcnt(4)
    ds_read_b128 v[180:183], v9 offset:16384
    ds_read_b64_tr_b16 v[188:189], v12 offset:26624
    ds_read_b64_tr_b16 v[190:191], v12 offset:26880
    v_mfma_f32_32x32x16_bf16 v[80:95], v[168:171], v[164:167], v[80:95]
    s_waitcnt lgkmcnt(5)
    ds_read_b128 v[184:187], v9 offset:20480
    ds_read_b64_tr_b16 v[192:193], v12 offset:34816
    ds_read_b64_tr_b16 v[194:195], v12 offset:35072
    v_mfma_f32_32x32x16_bf16 v[96:111], v[172:175], v[160:163], v[96:111]
    ds_read_b64_tr_b16 v[196:197], v12 offset:43008
    ds_read_b64_tr_b16 v[198:199], v12 offset:43264
    v_mfma_f32_32x32x16_bf16 v[112:127], v[172:175], v[164:167], v[112:127]
    s_waitcnt lgkmcnt(8)
    v_mfma_f32_32x32x16_bf16 v[128:143], v[160:163], v[176:179], v[128:143]
    v_mfma_f32_32x32x16_bf16 v[144:159], v[164:167], v[176:179], v[144:159]
    s_waitcnt lgkmcnt(5)
    v_mfma_f32_32x32x16_bf16 v[64:79], v[188:191], v[180:183], v[64:79]
    s_waitcnt lgkmcnt(4)
    ds_read_b128 v[160:163], v10 offset:16384
    ds_read_b64_tr_b16 v[168:169], v12 offset:28672
    ds_read_b64_tr_b16 v[170:171], v12 offset:28928
    v_mfma_f32_32x32x16_bf16 v[80:95], v[188:191], v[184:187], v[80:95]
    s_waitcnt lgkmcnt(5)
    ds_read_b128 v[164:167], v10 offset:20480
    ds_read_b64_tr_b16 v[172:173], v12 offset:36864
    ds_read_b64_tr_b16 v[174:175], v12 offset:37120
    v_mfma_f32_32x32x16_bf16 v[96:111], v[192:195], v[180:183], v[96:111]
    ds_read_b64_tr_b16 v[176:177], v12 offset:45056
    ds_read_b64_tr_b16 v[178:179], v12 offset:45312
    v_mfma_f32_32x32x16_bf16 v[112:127], v[192:195], v[184:187], v[112:127]
    s_waitcnt lgkmcnt(8)
    v_mfma_f32_32x32x16_bf16 v[128:143], v[180:183], v[196:199], v[128:143]
    v_mfma_f32_32x32x16_bf16 v[144:159], v[184:187], v[196:199], v[144:159]
    s_waitcnt lgkmcnt(5)
    v_mfma_f32_32x32x16_bf16 v[64:79], v[168:171], v[160:163], v[64:79]
    s_waitcnt lgkmcnt(4)
    ds_read_b128 v[180:183], v11 offset:16384
    ds_read_b64_tr_b16 v[188:189], v12 offset:30720
    ds_read_b64_tr_b16 v[190:191], v12 offset:30976
    v_mfma_f32_32x32x16_bf16 v[80:95], v[168:171], v[164:167], v[80:95]
    s_waitcnt lgkmcnt(5)
    ds_read_b128 v[184:187], v11 offset:20480
    ds_read_b64_tr_b16 v[192:193], v12 offset:38912
    ds_read_b64_tr_b16 v[194:195], v12 offset:39168
    v_mfma_f32_32x32x16_bf16 v[96:111], v[172:175], v[160:163], v[96:111]
    ds_read_b64_tr_b16 v[196:197], v12 offset:47104
    ds_read_b64_tr_b16 v[198:199], v12 offset:47360
    v_mfma_f32_32x32x16_bf16 v[112:127], v[172:175], v[164:167], v[112:127]
    s_waitcnt lgkmcnt(8)
    v_mfma_f32_32x32x16_bf16 v[128:143], v[160:163], v[176:179], v[128:143]
    v_mfma_f32_32x32x16_bf16 v[144:159], v[164:167], v[176:179], v[144:159]
    s_waitcnt lgkmcnt(5)
    v_mfma_f32_32x32x16_bf16 v[64:79], v[188:191], v[180:183], v[64:79]
    s_waitcnt lgkmcnt(4)
    v_mfma_f32_32x32x16_bf16 v[80:95], v[188:191], v[184:187], v[80:95]
    s_waitcnt vmcnt(3) lgkmcnt(0)
    s_barrier
    ds_read_b128 v[160:163], v8 offset:0
    ds_read_b64_tr_b16 v[168:169], v13 offset:0
    ds_read_b64_tr_b16 v[170:171], v13 offset:256
    v_mfma_f32_32x32x16_bf16 v[96:111], v[192:195], v[180:183], v[96:111]
    ds_read_b128 v[164:167], v8 offset:4096
    ds_read_b64_tr_b16 v[172:173], v13 offset:8192
    ds_read_b64_tr_b16 v[174:175], v13 offset:8448
    v_mfma_f32_32x32x16_bf16 v[112:127], v[192:195], v[184:187], v[112:127]
    ds_read_b64_tr_b16 v[176:177], v13 offset:16384
    ds_read_b64_tr_b16 v[178:179], v13 offset:16640
    v_mfma_f32_32x32x16_bf16 v[128:143], v[180:183], v[196:199], v[128:143]
    v_mfma_f32_32x32x16_bf16 v[144:159], v[184:187], v[196:199], v[144:159]
    s_waitcnt lgkmcnt(5)
    v_mfma_f32_32x32x16_bf16 v[64:79], v[168:171], v[160:163], v[64:79]
    s_waitcnt lgkmcnt(4)
    ds_read_b128 v[180:183], v9 offset:0
    ds_read_b64_tr_b16 v[188:189], v13 offset:2048
    ds_read_b64_tr_b16 v[190:191], v13 offset:2304
    v_mfma_f32_32x32x16_bf16 v[80:95], v[168:171], v[164:167], v[80:95]
    s_waitcnt lgkmcnt(5)
    ds_read_b128 v[184:187], v9 offset:4096
    ds_read_b64_tr_b16 v[192:193], v13 offset:10240
    ds_read_b64_tr_b16 v[194:195], v13 offset:10496
    v_mfma_f32_32x32x16_bf16 v[96:111], v[172:175], v[160:163], v[96:111]
    ds_read_b64_tr_b16 v[196:197], v13 offset:18432
    ds_read_b64_tr_b16 v[198:199], v13 offset:18688
    v_mfma_f32_32x32x16_bf16 v[112:127], v[172:175], v[164:167], v[112:127]
    s_waitcnt lgkmcnt(8)
    v_mfma_f32_32x32x16_bf16 v[128:143], v[160:163], v[176:179], v[128:143]
    v_mfma_f32_32x32x16_bf16 v[144:159], v[164:167], v[176:179], v[144:159]
    s_waitcnt lgkmcnt(5)
    v_mfma_f32_32x32x16_bf16 v[64:79], v[188:191], v[180:183], v[64:79]
    s_waitcnt lgkmcnt(4)
    ds_read_b128 v[160:163], v10 offset:0
    ds_read_b64_tr_b16 v[168:169], v13 offset:4096
    ds_read_b64_tr_b16 v[170:171], v13 offset:4352
    v_mfma_f32_32x32x16_bf16 v[80:95], v[188:191], v[184:187], v[80:95]
    s_waitcnt lgkmcnt(5)
    ds_read_b128 v[164:167], v10 offset:4096
    ds_read_b64_tr_b16 v[172:173], v13 offset:12288
    ds_read_b64_tr_b16 v[174:175], v13 offset:12544
    v_mfma_f32_32x32x16_bf16 v[96:111], v[192:195], v[180:183], v[96:111]
    ds_read_b64_tr_b16 v[176:177], v13 offset:20480
    ds_read_b64_tr_b16 v[178:179], v13 offset:20736
    v_mfma_f32_32x32x16_bf16 v[112:127], v[192:195], v[184:187], v[112:127]
    s_waitcnt lgkmcnt(8)
    v_mfma_f32_32x32x16_bf16 v[128:143], v[180:183], v[196:199], v[128:143]
    v_mfma_f32_32x32x16_bf16 v[144:159], v[184:187], v[196:199], v[144:159]
    s_waitcnt lgkmcnt(5)
    v_mfma_f32_32x32x16_bf16 v[64:79], v[168:171], v[160:163], v[64:79]
    s_waitcnt lgkmcnt(4)
    ds_read_b128 v[180:183], v11 offset:0
    ds_read_b64_tr_b16 v[188:189], v13 offset:6144
    ds_read_b64_tr_b16 v[190:191], v13 offset:6400
    v_mfma_f32_32x32x16_bf16 v[80:95], v[168:171], v[164:167], v[80:95]
    s_waitcnt lgkmcnt(5)
    ds_read_b128 v[184:187], v11 offset:4096
    ds_read_b64_tr_b16 v[192:193], v13 offset:14336
    ds_read_b64_tr_b16 v[194:195], v13 offset:14592
    v_mfma_f32_32x32x16_bf16 v[96:111], v[172:175], v[160:163], v[96:111]
    ds_read_b64_tr_b16 v[196:197], v13 offset:22528
    ds_read_b64_tr_b16 v[198:199], v13 offset:22784
    v_mfma_f32_32x32x16_bf16 v[112:127], v[172:175], v[164:167], v[112:127]
    s_waitcnt lgkmcnt(8)
    v_mfma_f32_32x32x16_bf16 v[128:143], v[160:163], v[176:179], v[128:143]
    v_mfma_f32_32x32x16_bf16 v[144:159], v[164:167], v[176:179], v[144:159]
    s_waitcnt lgkmcnt(5)
    v_mfma_f32_32x32x16_bf16 v[64:79], v[188:191], v[180:183], v[64:79]
    s_waitcnt lgkmcnt(4)
    v_mfma_f32_32x32x16_bf16 v[80:95], v[188:191], v[184:187], v[80:95]
    s_waitcnt vmcnt(0) lgkmcnt(0)
    s_barrier
    ds_read_b128 v[160:163], v8 offset:16384
    ds_read_b64_tr_b16 v[168:169], v13 offset:24576
    ds_read_b64_tr_b16 v[170:171], v13 offset:24832
    v_mfma_f32_32x32x16_bf16 v[96:111], v[192:195], v[180:183], v[96:111]
    ds_read_b128 v[164:167], v8 offset:20480
    ds_read_b64_tr_b16 v[172:173], v13 offset:32768
    ds_read_b64_tr_b16 v[174:175], v13 offset:33024
    v_mfma_f32_32x32x16_bf16 v[112:127], v[192:195], v[184:187], v[112:127]
    ds_read_b64_tr_b16 v[176:177], v13 offset:40960
    ds_read_b64_tr_b16 v[178:179], v13 offset:41216
    v_mfma_f32_32x32x16_bf16 v[128:143], v[180:183], v[196:199], v[128:143]
    v_mfma_f32_32x32x16_bf16 v[144:159], v[184:187], v[196:199], v[144:159]
    s_waitcnt lgkmcnt(5)
    v_mfma_f32_32x32x16_bf16 v[64:79], v[168:171], v[160:163], v[64:79]
    s_waitcnt lgkmcnt(4)
    ds_read_b128 v[180:183], v9 offset:16384
    ds_read_b64_tr_b16 v[188:189], v13 offset:26624
    ds_read_b64_tr_b16 v[190:191], v13 offset:26880
    v_mfma_f32_32x32x16_bf16 v[80:95], v[168:171], v[164:167], v[80:95]
    s_waitcnt lgkmcnt(5)
    ds_read_b128 v[184:187], v9 offset:20480
    ds_read_b64_tr_b16 v[192:193], v13 offset:34816
    ds_read_b64_tr_b16 v[194:195], v13 offset:35072
    v_mfma_f32_32x32x16_bf16 v[96:111], v[172:175], v[160:163], v[96:111]
    ds_read_b64_tr_b16 v[196:197], v13 offset:43008
    ds_read_b64_tr_b16 v[198:199], v13 offset:43264
    v_mfma_f32_32x32x16_bf16 v[112:127], v[172:175], v[164:167], v[112:127]
    s_waitcnt lgkmcnt(8)
    v_mfma_f32_32x32x16_bf16 v[128:143], v[160:163], v[176:179], v[128:143]
    v_mfma_f32_32x32x16_bf16 v[144:159], v[164:167], v[176:179], v[144:159]
    s_waitcnt lgkmcnt(5)
    v_mfma_f32_32x32x16_bf16 v[64:79], v[188:191], v[180:183], v[64:79]
    s_waitcnt lgkmcnt(4)
    ds_read_b128 v[160:163], v10 offset:16384
    ds_read_b64_tr_b16 v[168:169], v13 offset:28672
    ds_read_b64_tr_b16 v[170:171], v13 offset:28928
    v_mfma_f32_32x32x16_bf16 v[80:95], v[188:191], v[184:187], v[80:95]
    s_waitcnt lgkmcnt(5)
    ds_read_b128 v[164:167], v10 offset:20480
    ds_read_b64_tr_b16 v[172:173], v13 offset:36864
    ds_read_b64_tr_b16 v[174:175], v13 offset:37120
    v_mfma_f32_32x32x16_bf16 v[96:111], v[192:195], v[180:183], v[96:111]
    ds_read_b64_tr_b16 v[176:177], v13 offset:45056
    ds_read_b64_tr_b16 v[178:179], v13 offset:45312
    v_mfma_f32_32x32x16_bf16 v[112:127], v[192:195], v[184:187], v[112:127]
    s_waitcnt lgkmcnt(8)
    v_mfma_f32_32x32x16_bf16 v[128:143], v[180:183], v[196:199], v[128:143]
    v_mfma_f32_32x32x16_bf16 v[144:159], v[184:187], v[196:199], v[144:159]
    s_waitcnt lgkmcnt(5)
    v_mfma_f32_32x32x16_bf16 v[64:79], v[168:171], v[160:163], v[64:79]
    s_waitcnt lgkmcnt(4)
    ds_read_b128 v[180:183], v11 offset:16384
    ds_read_b64_tr_b16 v[188:189], v13 offset:30720
    ds_read_b64_tr_b16 v[190:191], v13 offset:30976
    v_mfma_f32_32x32x16_bf16 v[80:95], v[168:171], v[164:167], v[80:95]
    s_waitcnt lgkmcnt(5)
    ds_read_b128 v[184:187], v11 offset:20480
    ds_read_b64_tr_b16 v[192:193], v13 offset:38912
    ds_read_b64_tr_b16 v[194:195], v13 offset:39168
    v_mfma_f32_32x32x16_bf16 v[96:111], v[172:175], v[160:163], v[96:111]
    ds_read_b64_tr_b16 v[196:197], v13 offset:47104
    ds_read_b64_tr_b16 v[198:199], v13 offset:47360
    v_mfma_f32_32x32x16_bf16 v[112:127], v[172:175], v[164:167], v[112:127]
    s_waitcnt lgkmcnt(8)
    v_mfma_f32_32x32x16_bf16 v[128:143], v[160:163], v[176:179], v[128:143]
    v_mfma_f32_32x32x16_bf16 v[144:159], v[164:167], v[176:179], v[144:159]
    s_waitcnt lgkmcnt(5)
    v_mfma_f32_32x32x16_bf16 v[64:79], v[188:191], v[180:183], v[64:79]
    s_waitcnt lgkmcnt(4)
    v_mfma_f32_32x32x16_bf16 v[80:95], v[188:191], v[184:187], v[80:95]
    s_waitcnt lgkmcnt(2)
    v_mfma_f32_32x32x16_bf16 v[96:111], v[192:195], v[180:183], v[96:111]
    v_mfma_f32_32x32x16_bf16 v[112:127], v[192:195], v[184:187], v[112:127]
    s_waitcnt lgkmcnt(0)
    v_mfma_f32_32x32x16_bf16 v[128:143], v[180:183], v[196:199], v[128:143]
    v_mfma_f32_32x32x16_bf16 v[144:159], v[184:187], v[196:199], v[144:159]
    s_nop 15
    s_mov_b32 s41, 0x3e8293ee
    v_mul_f32 v64, s41, v64
    v_mul_f32 v65, s41, v65
    v_mul_f32 v66, s41, v66
    v_mul_f32 v67, s41, v67
    v_mul_f32 v68, s41, v68
    v_mul_f32 v69, s41, v69
    v_mul_f32 v70, s41, v70
    v_mul_f32 v71, s41, v71
    v_mul_f32 v72, s41, v72
    v_mul_f32 v73, s41, v73
    v_mul_f32 v74, s41, v74
    v_mul_f32 v75, s41, v75
    v_mul_f32 v76, s41, v76
    v_mul_f32 v77, s41, v77
    v_mul_f32 v78, s41, v78
    v_mul_f32 v79, s41, v79
    v_mul_f32 v80, s41, v80
    v_mul_f32 v81, s41, v81
    v_mul_f32 v82, s41, v82
    v_mul_f32 v83, s41, v83
    v_mul_f32 v84, s41, v84
    v_mul_f32 v85, s41, v85
    v_mul_f32 v86, s41, v86
    v_mul_f32 v87, s41, v87
    v_mul_f32 v88, s41, v88
    v_mul_f32 v89, s41, v89
    v_mul_f32 v90, s41, v90
    v_mul_f32 v91, s41, v91
    v_mul_f32 v92, s41, v92
    v_mul_f32 v93, s41, v93
    v_mul_f32 v94, s41, v94
    v_mul_f32 v95, s41, v95
    v_cvt_pk_bf16_f32 v24, v64, v65
    v_cvt_pk_bf16_f32 v25, v66, v67
    v_cvt_pk_bf16_f32 v26, v68, v69
    v_cvt_pk_bf16_f32 v27, v70, v71
    v_cvt_pk_bf16_f32 v28, v72, v73
    v_cvt_pk_bf16_f32 v29, v74, v75
    v_cvt_pk_bf16_f32 v30, v76, v77
    v_cvt_pk_bf16_f32 v31, v78, v79
    s_add_u32 s42, s40, 0
    s_nop 0
    v_permlane16_swap_b32 v24, v28
    v_permlane16_swap_b32 v25, v29
    v_permlane16_swap_b32 v26, v30
    v_permlane16_swap_b32 v27, v31
    buffer_store_dwordx4 v[24:27], v17, s[20:23], s42 offen offset:0 sc1
    buffer_store_dwordx4 v[28:31], v17, s[20:23], s42 offen offset:1024 sc1
    v_cvt_pk_bf16_f32 v32, v80, v81
    v_cvt_pk_bf16_f32 v33, v82, v83
    v_cvt_pk_bf16_f32 v34, v84, v85
    v_cvt_pk_bf16_f32 v35, v86, v87
    v_cvt_pk_bf16_f32 v36, v88, v89
    v_cvt_pk_bf16_f32 v37, v90, v91
    v_cvt_pk_bf16_f32 v38, v92, v93
    v_cvt_pk_bf16_f32 v39, v94, v95
    s_add_u32 s42, s40, 0
    s_nop 0
    v_permlane16_swap_b32 v32, v36
    v_permlane16_swap_b32 v33, v37
    v_permlane16_swap_b32 v34, v38
    v_permlane16_swap_b32 v35, v39
    buffer_store_dwordx4 v[32:35], v17, s[20:23], s42 offen offset:2048 sc1
    buffer_store_dwordx4 v[36:39], v17, s[20:23], s42 offen offset:3072 sc1
    v_cvt_pk_bf16_f32 v40, v96, v97
    v_cvt_pk_bf16_f32 v41, v98, v99
    v_cvt_pk_bf16_f32 v42, v100, v101
    v_cvt_pk_bf16_f32 v43, v102, v103
    v_cvt_pk_bf16_f32 v44, v104, v105
    v_cvt_pk_bf16_f32 v45, v106, v107
    v_cvt_pk_bf16_f32 v46, v108, v109
    v_cvt_pk_bf16_f32 v47, v110, v111
    s_add_u32 s42, s40, 4194304
    s_nop 0
    v_permlane16_swap_b32 v40, v44
    v_permlane16_swap_b32 v41, v45
    v_permlane16_swap_b32 v42, v46
    v_permlane16_swap_b32 v43, v47
    buffer_store_dwordx4 v[40:43], v17, s[20:23], s42 offen offset:0 sc1
    buffer_store_dwordx4 v[44:47], v17, s[20:23], s42 offen offset:1024 sc1
    v_cvt_pk_bf16_f32 v48, v112, v113
    v_cvt_pk_bf16_f32 v49, v114, v115
    v_cvt_pk_bf16_f32 v50, v116, v117
    v_cvt_pk_bf16_f32 v51, v118, v119
    v_cvt_pk_bf16_f32 v52, v120, v121
    v_cvt_pk_bf16_f32 v53, v122, v123
    v_cvt_pk_bf16_f32 v54, v124, v125
    v_cvt_pk_bf16_f32 v55, v126, v127
    s_add_u32 s42, s40, 4194304
    s_nop 0
    v_permlane16_swap_b32 v48, v52
    v_permlane16_swap_b32 v49, v53
    v_permlane16_swap_b32 v50, v54
    v_permlane16_swap_b32 v51, v55
    buffer_store_dwordx4 v[48:51], v17, s[20:23], s42 offen offset:2048 sc1
    buffer_store_dwordx4 v[52:55], v17, s[20:23], s42 offen offset:3072 sc1
    v_cvt_pk_bf16_f32 v24, v128, v129
    v_cvt_pk_bf16_f32 v25, v130, v131
    v_cvt_pk_bf16_f32 v26, v132, v133
    v_cvt_pk_bf16_f32 v27, v134, v135
    v_cvt_pk_bf16_f32 v28, v136, v137
    v_cvt_pk_bf16_f32 v29, v138, v139
    v_cvt_pk_bf16_f32 v30, v140, v141
    v_cvt_pk_bf16_f32 v31, v142, v143
    s_add_u32 s42, s40, 8388608
    s_nop 0
    v_permlane16_swap_b32 v24, v28
    v_permlane16_swap_b32 v25, v29
    v_permlane16_swap_b32 v26, v30
    v_permlane16_swap_b32 v27, v31
    buffer_store_dwordx4 v[24:27], v17, s[20:23], s42 offen offset:0 sc1
    buffer_store_dwordx4 v[28:31], v17, s[20:23], s42 offen offset:1024 sc1
    v_cvt_pk_bf16_f32 v32, v144, v145
    v_cvt_pk_bf16_f32 v33, v146, v147
    v_cvt_pk_bf16_f32 v34, v148, v149
    v_cvt_pk_bf16_f32 v35, v150, v151
    v_cvt_pk_bf16_f32 v36, v152, v153
    v_cvt_pk_bf16_f32 v37, v154, v155
    v_cvt_pk_bf16_f32 v38, v156, v157
    v_cvt_pk_bf16_f32 v39, v158, v159
    s_add_u32 s42, s40, 8388608
    s_nop 0
    v_permlane16_swap_b32 v32, v36
    v_permlane16_swap_b32 v33, v37
    v_permlane16_swap_b32 v34, v38
    v_permlane16_swap_b32 v35, v39
    buffer_store_dwordx4 v[32:35], v17, s[20:23], s42 offen offset:2048 sc1
    buffer_store_dwordx4 v[36:39], v17, s[20:23], s42 offen offset:3072 sc1
L_kb_done:
    s_endpgm
.globl kc_attn_kernel
.p2align 8
.type kc_attn_kernel,@function
kc_attn_kernel:
    s_cmp_ge_u32 s2, 256
    s_cbranch_scc1 L_kc_done
    s_load_dwordx2 s[8:9], s[0:1], 96
    s_load_dwordx2 s[10:11], s[0:1], 32
    s_load_dwordx2 s[56:57], s[0:1], 16
    s_load_dwordx4 s[72:75], s[0:1], 40
    s_load_dwordx2 s[52:53], s[0:1], 56
    s_load_dwordx2 s[60:61], s[0:1], 0
    s_and_b32 s24, s2, 7
    s_lshl_b32 s24, s24, 2
    s_bfe_u32 s25, s2, 0x20003
    s_add_u32 s24, s24, s25
    s_lshr_b32 s25, s2, 5
    v_lshrrev_b32 v1, 6, v0
    v_and_b32 v2, 63, v0
    s_nop 0
    v_readfirstlane_b32 s26, v1
    s_nop 0
    s_and_b32 s27, s26, 3
    s_lshr_b32 s28, s26, 2
    s_lshl_b32 s29, s24, 17
    s_lshl_b32 s30, s26, 11
    s_add_u32 s31, s29, s30
    s_add_u32 s31, s31, 0x400000
    v_and_b32 v3, 31, v2
    v_lshrrev_b32 v12, 5, v2
    v_bfe_u32 v13, v2, 2, 2
    v_lshlrev_b32 v14, 1, v12
    v_xor_b32 v14, v14, v13
    v_lshlrev_b32 v14, 4, v14
    v_lshl_add_u32 v7, v3, 6, v14
    v_xor_b32 v8, 16, v7
    v_lshlrev_b32 v6, 4, v2
    s_lshl_b32 s32, s28, 13
    v_add_u32 v9, s32, v7
    s_lshl_b32 s33, s25, 14
    s_lshl_b32 s34, s27, 12
    s_add_u32 s33, s33, s34
    s_add_u32 s33, s33, s29
    s_waitcnt lgkmcnt(0)
    s_add_u32 s12, s8, 0x500000
    s_addc_u32 s13, s9, 0
    s_mov_b32 s14, 0xc00000
    s_mov_b32 s15, 0x00020000
    s_add_u32 s20, s8, 0x900000
    s_addc_u32 s21, s9, 0
    s_mov_b32 s22, 0x800000
    s_mov_b32 s23, 0x00020000
    s_add_u32 m0, s30, 0
    s_add_u32 s37, s31, 0
    buffer_load_dwordx4 v6, s[12:15], s37 offen lds
    buffer_load_dwordx4 v6, s[12:15], s37 offen offset:1024 lds
    s_add_u32 m0, s30, 16384
    s_nop 0
    buffer_load_dwordx4 v6, s[20:23], s37 offen lds
    buffer_load_dwordx4 v6, s[20:23], s37 offen offset:1024 lds
    buffer_load_dwordx4 v[16:19], v7, s[12:15], s33 offen
    buffer_load_dwordx4 v[20:23], v8, s[12:15], s33 offen
    buffer_load_dwordx4 v[24:27], v7, s[12:15], s33 offen offset:2048
    buffer_load_dwordx4 v[28:31], v8, s[12:15], s33 offen offset:2048
    s_add_u32 m0, s30, 32768
    s_add_u32 s37, s31, 16384
    buffer_load_dwordx4 v6, s[12:15], s37 offen lds
    buffer_load_dwordx4 v6, s[12:15], s37 offen offset:1024 lds
    s_add_u32 m0, s30, 49152
    s_nop 0
    buffer_load_dwordx4 v6, s[20:23], s37 offen lds
    buffer_load_dwordx4 v6, s[20:23], s37 offen offset:1024 lds
    s_add_u32 s16, s8, 0x1100000
    s_addc_u32 s17, s9, 0
    s_mov_b32 s18, 0x400000
    s_mov_b32 s19, 0x00020000
    s_mov_b32 s44, s72
    s_mov_b32 s45, s73
    s_mov_b32 s46, 0x700000
    s_mov_b32 s47, 0x00020000
    s_mov_b32 s48, s74
    s_mov_b32 s49, s75
    s_mov_b32 s50, 0x700000
    s_mov_b32 s51, 0x00020000
    s_mov_b32 s54, 7340032
    s_mov_b32 s55, 0x00020000
    s_mov_b32 s58, 2097152
    s_mov_b32 s59, 0x00020000
    s_and_b32 s66, s2, 7
    s_lshr_b32 s67, s2, 3
    s_lshl_b32 s76, s67, 3
    s_add_u32 s76, s76, s26
    s_mul_i32 s77, s76, 28
    v_add_u32 v14, s77, v2
    v_lshrrev_b32 v15, 10, v14
    v_and_b32 v14, 1023, v14
    s_movk_i32 s77, 7168
    v_mul_lo_u32 v204, v14, s77
    v_lshl_add_u32 v204, v15, 10, v204
    s_lshl_b32 s77, s66, 7
    v_add_u32 v204, s77, v204
    v_lshlrev_b32 v206, 20, v15
    v_lshl_add_u32 v206, v14, 7, v206
    s_lshl_b32 s77, s66, 17
    v_add_u32 v206, s77, v206
    v_mov_b32 v205, 0x7fffffff
    v_cmp_gt_u32 vcc, 28, v2
    v_lshrrev_b32 v14, 3, v2
    v_and_b32 v15, 7, v2
    v_cndmask_b32 v204, v205, v204, vcc
    v_cndmask_b32 v206, v205, v206, vcc
    v_lshlrev_b32 v14, 11, v14
    v_lshl_add_u32 v14, v15, 7, v14
    s_lshr_b32 s77, s66, 2
    s_lshl_b32 s77, s77, 10
    s_lshl_b32 s78, s76, 13
    s_add_u32 s78, s78, s77
    v_add_u32 v207, s78, v14
    v_cmp_gt_u32 vcc, 32, v2
    s_and_b32 s78, s66, 3
    s_lshl_b32 s78, s78, 20
    s_add_u32 s78, s78, s77
    s_lshl_b32 s77, s76, 12
    s_add_u32 s78, s78, s77
    v_cndmask_b32 v207, v205, v207, vcc
    v_add_u32 v208, s78, v14
    v_cmp_gt_u32 vcc, 16, v2
    s_mov_b32 s62, 4194304
    s_mov_b32 s63, 0x00020000
    v_cndmask_b32 v208, v205, v208, vcc
    v_lshlrev_b32 v14, 7, v2
    s_lshl_b32 s78, s76, 13
    v_add_u32 v207, s78, v14
    s_lshl_b32 s78, s66, 19
    s_lshl_b32 s77, s76, 11
    s_add_u32 s78, s78, s77
    v_add_u32 v208, s78, v14
    v_cndmask_b32 v208, v205, v208, vcc
    v_lshrrev_b32 v14, 4, v2
    v_lshrrev_b32 v15, 2, v2
    v_xor_b32 v14, v14, v15
    v_and_b32 v14, 1, v14
    v_cmp_eq_u32 vcc, 0, v14
    v_mov_b32 v15, 0x3f803f80
    v_mov_b32 v14, 0
    v_cndmask_b32 v32, v14, v15, vcc
    v_mov_b32 v33, v32
    v_mov_b32 v34, v32
    v_mov_b32 v35, v32
    v_and_b32 v14, 15, v2
    v_lshrrev_b32 v15, 4, v2
    v_lshlrev_b32 v10, 6, v14
    v_lshl_add_u32 v10, v15, 4, v10
    s_mul_i32 s35, s26, 5120
    s_add_u32 s35, s35, 98304
    v_add_u32 v11, s35, v6
    v_mov_b32 v14, 139264
    v_mov_b32 v15, 0
    ds_write_b32 v14, v15
    s_mov_b32 s36, 0
    s_mov_b32 s4, s8
    s_mov_b32 s5, s9
    s_mov_b32 s6, 0x60000
    s_mov_b32 s7, 0x00020000
    s_mov_b32 s68, s10
    s_mov_b32 s69, s11
    s_mov_b32 s70, 0x800
    s_mov_b32 s71, 0x00020000
    v_lshlrev_b32 v211, 2, v3
    s_lshl_b32 s65, s26, 8
    s_add_u32 s65, s65, s2
    s_cmp_lt_u32 s65, 128
    s_cselect_b32 s65, 1, 0
    s_branch L_kc_start2
L_kc_start:
    s_add_u32 m0, s30, 0
    s_add_u32 s37, s31, 0
    buffer_load_dwordx4 v6, s[12:15], s37 offen lds
    buffer_load_dwordx4 v6, s[12:15], s37 offen offset:1024 lds
    s_add_u32 m0, s30, 16384
    s_nop 0
    buffer_load_dwordx4 v6, s[20:23], s37 offen lds
    buffer_load_dwordx4 v6, s[20:23], s37 offen offset:1024 lds
    s_add_u32 m0, s30, 32768
    s_add_u32 s37, s31, 16384
    buffer_load_dwordx4 v6, s[12:15], s37 offen lds
    buffer_load_dwordx4 v6, s[12:15], s37 offen offset:1024 lds
    s_add_u32 m0, s30, 49152
    s_nop 0
    buffer_load_dwordx4 v6, s[20:23], s37 offen lds
    buffer_load_dwordx4 v6, s[20:23], s37 offen offset:1024 lds
L_kc_start2:
    v_mov_b32 v4, v9
    v_xor_b32 v5, 16, v9
    v_add_u32 v92, 0x10000, v4
    v_add_u32 v93, 0x10000, v5
    v_mov_b32 v128, 0
    v_mov_b32 v129, 0
    v_mov_b32 v130, 0
    v_mov_b32 v131, 0
    v_mov_b32 v132, 0
    v_mov_b32 v133, 0
    v_mov_b32 v134, 0
    v_mov_b32 v135, 0
    v_mov_b32 v136, 0
    v_mov_b32 v137, 0
    v_mov_b32 v138, 0
    v_mov_b32 v139, 0
    v_mov_b32 v140, 0
    v_mov_b32 v141, 0
    v_mov_b32 v142, 0
    v_mov_b32 v143, 0
    v_mov_b32 v36, 0
    v_mov_b32 v37, 0
    v_mov_b32 v38, 0
    v_mov_b32 v39, 0
    v_mov_b32 v144, 0
    v_mov_b32 v145, 0
    v_mov_b32 v146, 0
    v_mov_b32 v147, 0
    v_mov_b32 v148, 0
    v_mov_b32 v149, 0
    v_mov_b32 v150, 0
    v_mov_b32 v151, 0
    v_mov_b32 v152, 0
    v_mov_b32 v153, 0
    v_mov_b32 v154, 0
    v_mov_b32 v155, 0
    v_mov_b32 v156, 0
    v_mov_b32 v157, 0
    v_mov_b32 v158, 0
    v_mov_b32 v159, 0
    v_mov_b32 v40, 0
    v_mov_b32 v41, 0
    v_mov_b32 v42, 0
    v_mov_b32 v43, 0
    v_mov_b32 v84, 0
    v_mov_b32 v68, 0
    v_mov_b32 v85, 0
    v_mov_b32 v69, 0
    v_mov_b32 v86, 0
    v_mov_b32 v70, 0
    v_mov_b32 v87, 0
    v_mov_b32 v71, 0
    v_mov_b32 v88, 0
    v_mov_b32 v72, 0
    v_mov_b32 v89, 0
    v_mov_b32 v73, 0
    v_mov_b32 v90, 0
    v_mov_b32 v74, 0
    v_mov_b32 v91, 0
    v_mov_b32 v75, 0
    s_waitcnt vmcnt(4) lgkmcnt(0)
    s_barrier
    ds_read_b128 v[44:47], v4 offset:0
    ds_read_b128 v[48:51], v5 offset:0
    s_waitcnt lgkmcnt(0)
    s_cmp_lg_u32 s36, 0
    s_cbranch_scc1 L_kc_havemax
    v_mfma_f32_32x32x16_bf16 v[96:111], v[44:47], v[16:19], 0
    v_mfma_f32_32x32x16_bf16 v[96:111], v[48:51], v[20:23], v[96:111]
    v_mfma_f32_32x32x16_bf16 v[112:127], v[44:47], v[24:27], 0
    v_mfma_f32_32x32x16_bf16 v[112:127], v[48:51], v[28:31], v[112:127]
    s_nop 11
    v_max3_f32 v192, v96, v97, v98
    v_max3_f32 v192, v192, v99, v100
    v_max3_f32 v192, v192, v101, v102
    v_max3_f32 v192, v192, v103, v104
    v_max3_f32 v192, v192, v105, v106
    v_max3_f32 v192, v192, v107, v108
    v_max3_f32 v192, v192, v109, v110
    v_max_f32 v192, v192, v111
    v_max3_f32 v193, v112, v113, v114
    v_max3_f32 v193, v193, v115, v116
    v_max3_f32 v193, v193, v117, v118
    v_max3_f32 v193, v193, v119, v120
    v_max3_f32 v193, v193, v121, v122
    v_max3_f32 v193, v193, v123, v124
    v_max3_f32 v193, v193, v125, v126
    v_max_f32 v193, v193, v127
    v_mov_b32 v194, v192
    v_mov_b32 v195, v193
    s_nop 1
    v_permlane32_swap_b32 v194, v192
    v_permlane32_swap_b32 v195, v193
    s_nop 0
    v_max_f32 v192, v192, v194
    v_max_f32 v193, v193, v195
    v_sub_f32 v160, 0, v192
    v_sub_f32 v161, 0, v192
    v_sub_f32 v162, 0, v192
    v_sub_f32 v163, 0, v192
    v_sub_f32 v164, 0, v192
    v_sub_f32 v165, 0, v192
    v_sub_f32 v166, 0, v192
    v_sub_f32 v167, 0, v192
    v_sub_f32 v168, 0, v192
    v_sub_f32 v169, 0, v192
    v_sub_f32 v170, 0, v192
    v_sub_f32 v171, 0, v192
    v_sub_f32 v172, 0, v192
    v_sub_f32 v173, 0, v192
    v_sub_f32 v174, 0, v192
    v_sub_f32 v175, 0, v192
    v_sub_f32 v176, 0, v193
    v_sub_f32 v177, 0, v193
    v_sub_f32 v178, 0, v193
    v_sub_f32 v179, 0, v193
    v_sub_f32 v180, 0, v193
    v_sub_f32 v181, 0, v193
    v_sub_f32 v182, 0, v193
    v_sub_f32 v183, 0, v193
    v_sub_f32 v184, 0, v193
    v_sub_f32 v185, 0, v193
    v_sub_f32 v186, 0, v193
    v_sub_f32 v187, 0, v193
    v_sub_f32 v188, 0, v193
    v_sub_f32 v189, 0, v193
    v_sub_f32 v190, 0, v193
    v_sub_f32 v191, 0, v193
L_kc_havemax:
    s_nop 1
    v_mfma_f32_32x32x16_bf16 v[96:111], v[44:47], v[16:19], v[160:175]
    v_mfma_f32_32x32x16_bf16 v[96:111], v[48:51], v[20:23], v[96:111]
    s_nop 9
    v_mfma_f32_32x32x16_bf16 v[112:127], v[44:47], v[24:27], v[176:191]
    ds_read_b128 v[60:63], v4 offset:16384
    ds_read_b128 v[64:67], v5 offset:16384
    v_exp_f32 v96, v96
    v_exp_f32 v97, v97
    v_exp_f32 v98, v98
    v_exp_f32 v99, v99
    v_mfma_f32_32x32x16_bf16 v[112:127], v[48:51], v[28:31], v[112:127]
    ds_read_b128 v[52:55], v4 offset:2048
    ds_read_b128 v[56:59], v5 offset:2048
    v_exp_f32 v100, v100
    v_exp_f32 v101, v101
    v_exp_f32 v102, v102
    v_exp_f32 v103, v103
    v_mfma_f32_32x32x16_bf16 v[144:159], v[68:71], v[84:87], v[144:159]
    v_exp_f32 v104, v104
    v_exp_f32 v105, v105
    v_cvt_pk_bf16_f32 v76, v96, v97
    v_cvt_pk_bf16_f32 v77, v98, v99
    v_exp_f32 v106, v106
    v_exp_f32 v107, v107
    v_mfma_f32_16x16x32_bf16 v[40:43], v[32:35], v[84:87], v[40:43]
    v_exp_f32 v108, v108
    v_mfma_f32_32x32x16_bf16 v[144:159], v[72:75], v[88:91], v[144:159]
    s_cmp_eq_u32 s65, 0
    s_cbranch_scc1 L_kc_ml
    v_lshl_add_u32 v209, v12, 16, v211
    v_lshlrev_b32 v210, 1, v3
    s_lshl_b32 s38, s2, 7
    s_add_u32 s38, s38, 262144
    s_lshl_b32 s39, s2, 6
    s_and_b32 s39, s39, 0x7ff
    buffer_load_dword v212, v209, s[4:7], s38 offen
    s_add_u32 s38, s38, 16384
    buffer_load_dword v213, v209, s[4:7], s38 offen
    s_add_u32 s38, s38, 16384
    buffer_load_dword v214, v209, s[4:7], s38 offen
    s_add_u32 s38, s38, 16384
    buffer_load_dword v215, v209, s[4:7], s38 offen
    buffer_load_ushort v210, v210, s[68:71], s39 offen
L_kc_ml:
    v_exp_f32 v109, v109
    v_cvt_pk_bf16_f32 v78, v100, v101
    v_cvt_pk_bf16_f32 v79, v102, v103
    v_exp_f32 v110, v110
    v_exp_f32 v111, v111
    v_mfma_f32_16x16x32_bf16 v[40:43], v[32:35], v[88:91], v[40:43]
    v_cvt_pk_bf16_f32 v80, v104, v105
    v_cvt_pk_bf16_f32 v81, v106, v107
    v_cvt_pk_bf16_f32 v82, v108, v109
    v_cvt_pk_bf16_f32 v83, v110, v111
    s_waitcnt lgkmcnt(0)
    v_mfma_f32_32x32x16_bf16 v[96:111], v[52:55], v[16:19], v[160:175]
    v_exp_f32 v112, v112
    v_exp_f32 v113, v113
    v_exp_f32 v114, v114
    v_exp_f32 v115, v115
    v_mfma_f32_32x32x16_bf16 v[96:111], v[56:59], v[20:23], v[96:111]
    v_exp_f32 v116, v116
    v_exp_f32 v117, v117
    v_exp_f32 v118, v118
    v_exp_f32 v119, v119
    v_mfma_f32_32x32x16_bf16 v[128:143], v[60:63], v[76:79], v[128:143]
    v_exp_f32 v120, v120
    v_exp_f32 v121, v121
    v_cvt_pk_bf16_f32 v84, v112, v113
    v_cvt_pk_bf16_f32 v85, v114, v115
    v_exp_f32 v122, v122
    v_exp_f32 v123, v123
    v_mfma_f32_16x16x32_bf16 v[36:39], v[32:35], v[76:79], v[36:39]
    v_exp_f32 v124, v124
    v_mfma_f32_32x32x16_bf16 v[128:143], v[64:67], v[80:83], v[128:143]
    s_add_u32 m0, s30, 65536
    s_add_u32 s37, s31, 32768
    buffer_load_dwordx4 v6, s[12:15], s37 offen lds
    v_exp_f32 v125, v125
    v_cvt_pk_bf16_f32 v86, v116, v117
    v_cvt_pk_bf16_f32 v87, v118, v119
    v_exp_f32 v126, v126
    v_exp_f32 v127, v127
    v_mfma_f32_16x16x32_bf16 v[36:39], v[32:35], v[80:83], v[36:39]
    v_cvt_pk_bf16_f32 v88, v120, v121
    v_cvt_pk_bf16_f32 v89, v122, v123
    v_cvt_pk_bf16_f32 v90, v124, v125
    v_cvt_pk_bf16_f32 v91, v126, v127
    v_mfma_f32_32x32x16_bf16 v[112:127], v[52:55], v[24:27], v[176:191]
    ds_read_b128 v[68:71], v4 offset:18432
    ds_read_b128 v[72:75], v5 offset:18432
    v_exp_f32 v96, v96
    v_exp_f32 v97, v97
    v_exp_f32 v98, v98
    v_exp_f32 v99, v99
    v_mfma_f32_32x32x16_bf16 v[112:127], v[56:59], v[28:31], v[112:127]
    ds_read_b128 v[44:47], v4 offset:4096
    ds_read_b128 v[48:51], v5 offset:4096
    v_exp_f32 v100, v100
    v_exp_f32 v101, v101
    v_exp_f32 v102, v102
    v_exp_f32 v103, v103
    v_mfma_f32_32x32x16_bf16 v[144:159], v[60:63], v[84:87], v[144:159]
    v_exp_f32 v104, v104
    v_exp_f32 v105, v105
    v_cvt_pk_bf16_f32 v76, v96, v97
    v_cvt_pk_bf16_f32 v77, v98, v99
    v_exp_f32 v106, v106
    v_exp_f32 v107, v107
    v_mfma_f32_16x16x32_bf16 v[40:43], v[32:35], v[84:87], v[40:43]
    v_exp_f32 v108, v108
    v_mfma_f32_32x32x16_bf16 v[144:159], v[64:67], v[88:91], v[144:159]
    buffer_load_dwordx4 v6, s[12:15], s37 offen offset:1024 lds
    v_exp_f32 v109, v109
    v_cvt_pk_bf16_f32 v78, v100, v101
    v_cvt_pk_bf16_f32 v79, v102, v103
    v_exp_f32 v110, v110
    v_exp_f32 v111, v111
    v_mfma_f32_16x16x32_bf16 v[40:43], v[32:35], v[88:91], v[40:43]
    v_cvt_pk_bf16_f32 v80, v104, v105
    v_cvt_pk_bf16_f32 v81, v106, v107
    v_cvt_pk_bf16_f32 v82, v108, v109
    v_cvt_pk_bf16_f32 v83, v110, v111
    s_waitcnt lgkmcnt(0)
    v_mfma_f32_32x32x16_bf16 v[96:111], v[44:47], v[16:19], v[160:175]
    v_exp_f32 v112, v112
    v_exp_f32 v113, v113
    v_exp_f32 v114, v114
    v_exp_f32 v115, v115
    v_mfma_f32_32x32x16_bf16 v[96:111], v[48:51], v[20:23], v[96:111]
    v_exp_f32 v116, v116
    v_exp_f32 v117, v117
    v_exp_f32 v118, v118
    v_exp_f32 v119, v119
    v_mfma_f32_32x32x16_bf16 v[128:143], v[68:71], v[76:79], v[128:143]
    v_exp_f32 v120, v120
    v_exp_f32 v121, v121
    v_cvt_pk_bf16_f32 v84, v112, v113
    v_cvt_pk_bf16_f32 v85, v114, v115
    v_exp_f32 v122, v122
    v_exp_f32 v123, v123
    v_mfma_f32_16x16x32_bf16 v[36:39], v[32:35], v[76:79], v[36:39]
    v_exp_f32 v124, v124
    v_mfma_f32_32x32x16_bf16 v[128:143], v[72:75], v[80:83], v[128:143]
    s_add_u32 m0, s30, 81920
    s_nop 0
    buffer_load_dwordx4 v6, s[20:23], s37 offen lds
    v_exp_f32 v125, v125
    v_cvt_pk_bf16_f32 v86, v116, v117
    v_cvt_pk_bf16_f32 v87, v118, v119
    v_exp_f32 v126, v126
    v_exp_f32 v127, v127
    v_mfma_f32_16x16x32_bf16 v[36:39], v[32:35], v[80:83], v[36:39]
    v_cvt_pk_bf16_f32 v88, v120, v121
    v_cvt_pk_bf16_f32 v89, v122, v123
    v_cvt_pk_bf16_f32 v90, v124, v125
    v_cvt_pk_bf16_f32 v91, v126, v127
    v_mfma_f32_32x32x16_bf16 v[112:127], v[44:47], v[24:27], v[176:191]
    ds_read_b128 v[60:63], v4 offset:20480
    ds_read_b128 v[64:67], v5 offset:20480
    v_exp_f32 v96, v96
    v_exp_f32 v97, v97
    v_exp_f32 v98, v98
    v_exp_f32 v99, v99
    v_mfma_f32_32x32x16_bf16 v[112:127], v[48:51], v[28:31], v[112:127]
    ds_read_b128 v[52:55], v4 offset:6144
    ds_read_b128 v[56:59], v5 offset:6144
    v_exp_f32 v100, v100
    v_exp_f32 v101, v101
    v_exp_f32 v102, v102
    v_exp_f32 v103, v103
    v_mfma_f32_32x32x16_bf16 v[144:159], v[68:71], v[84:87], v[144:159]
    v_exp_f32 v104, v104
    v_exp_f32 v105, v105
    v_cvt_pk_bf16_f32 v76, v96, v97
    v_cvt_pk_bf16_f32 v77, v98, v99
    v_exp_f32 v106, v106
    v_exp_f32 v107, v107
    v_mfma_f32_16x16x32_bf16 v[40:43], v[32:35], v[84:87], v[40:43]
    v_exp_f32 v108, v108
    v_mfma_f32_32x32x16_bf16 v[144:159], v[72:75], v[88:91], v[144:159]
    buffer_load_dwordx4 v6, s[20:23], s37 offen offset:1024 lds
    v_exp_f32 v109, v109
    v_cvt_pk_bf16_f32 v78, v100, v101
    v_cvt_pk_bf16_f32 v79, v102, v103
    v_exp_f32 v110, v110
    v_exp_f32 v111, v111
    v_mfma_f32_16x16x32_bf16 v[40:43], v[32:35], v[88:91], v[40:43]
    v_cvt_pk_bf16_f32 v80, v104, v105
    v_cvt_pk_bf16_f32 v81, v106, v107
    v_cvt_pk_bf16_f32 v82, v108, v109
    v_cvt_pk_bf16_f32 v83, v110, v111
    s_waitcnt lgkmcnt(0)
    v_mfma_f32_32x32x16_bf16 v[96:111], v[52:55], v[16:19], v[160:175]
    v_exp_f32 v112, v112
    v_exp_f32 v113, v113
    v_exp_f32 v114, v114
    v_exp_f32 v115, v115
    v_mfma_f32_32x32x16_bf16 v[96:111], v[56:59], v[20:23], v[96:111]
    v_exp_f32 v116, v116
    v_exp_f32 v117, v117
    v_exp_f32 v118, v118
    v_exp_f32 v119, v119
    v_mfma_f32_32x32x16_bf16 v[128:143], v[60:63], v[76:79], v[128:143]
    v_exp_f32 v120, v120
    v_exp_f32 v121, v121
    v_cvt_pk_bf16_f32 v84, v112, v113
    v_cvt_pk_bf16_f32 v85, v114, v115
    v_exp_f32 v122, v122
    v_exp_f32 v123, v123
    v_mfma_f32_16x16x32_bf16 v[36:39], v[32:35], v[76:79], v[36:39]
    v_exp_f32 v124, v124
    v_mfma_f32_32x32x16_bf16 v[128:143], v[64:67], v[80:83], v[128:143]
    v_exp_f32 v125, v125
    v_cvt_pk_bf16_f32 v86, v116, v117
    v_cvt_pk_bf16_f32 v87, v118, v119
    v_exp_f32 v126, v126
    v_exp_f32 v127, v127
    v_mfma_f32_16x16x32_bf16 v[36:39], v[32:35], v[80:83], v[36:39]
    v_cvt_pk_bf16_f32 v88, v120, v121
    v_cvt_pk_bf16_f32 v89, v122, v123
    v_cvt_pk_bf16_f32 v90, v124, v125
    v_cvt_pk_bf16_f32 v91, v126, v127
    v_mfma_f32_32x32x16_bf16 v[112:127], v[52:55], v[24:27], v[176:191]
    ds_read_b128 v[68:71], v4 offset:22528
    ds_read_b128 v[72:75], v5 offset:22528
    v_exp_f32 v96, v96
    v_exp_f32 v97, v97
    v_exp_f32 v98, v98
    v_exp_f32 v99, v99
    v_mfma_f32_32x32x16_bf16 v[112:127], v[56:59], v[28:31], v[112:127]
    v_exp_f32 v100, v100
    v_exp_f32 v101, v101
    v_exp_f32 v102, v102
    v_exp_f32 v103, v103
    v_mfma_f32_32x32x16_bf16 v[144:159], v[60:63], v[84:87], v[144:159]
    s_waitcnt vmcnt(4) lgkmcnt(0)
    s_barrier
    ds_read_b128 v[44:47], v4 offset:32768
    ds_read_b128 v[48:51], v5 offset:32768
    v_exp_f32 v104, v104
    v_exp_f32 v105, v105
    v_cvt_pk_bf16_f32 v76, v96, v97
    v_cvt_pk_bf16_f32 v77, v98, v99
    v_exp_f32 v106, v106
    v_exp_f32 v107, v107
    v_mfma_f32_16x16x32_bf16 v[40:43], v[32:35], v[84:87], v[40:43]
    v_exp_f32 v108, v108
    v_mfma_f32_32x32x16_bf16 v[144:159], v[64:67], v[88:91], v[144:159]
    v_exp_f32 v109, v109
    v_cvt_pk_bf16_f32 v78, v100, v101
    v_cvt_pk_bf16_f32 v79, v102, v103
    v_exp_f32 v110, v110
    v_exp_f32 v111, v111
    v_mfma_f32_16x16x32_bf16 v[40:43], v[32:35], v[88:91], v[40:43]
    v_cvt_pk_bf16_f32 v80, v104, v105
    v_cvt_pk_bf16_f32 v81, v106, v107
    v_cvt_pk_bf16_f32 v82, v108, v109
    v_cvt_pk_bf16_f32 v83, v110, v111
    s_waitcnt lgkmcnt(0)
    v_mfma_f32_32x32x16_bf16 v[96:111], v[44:47], v[16:19], v[160:175]
    v_exp_f32 v112, v112
    v_exp_f32 v113, v113
    v_exp_f32 v114, v114
    v_exp_f32 v115, v115
    v_mfma_f32_32x32x16_bf16 v[96:111], v[48:51], v[20:23], v[96:111]
    v_exp_f32 v116, v116
    v_exp_f32 v117, v117
    v_exp_f32 v118, v118
    v_exp_f32 v119, v119
    v_mfma_f32_32x32x16_bf16 v[128:143], v[68:71], v[76:79], v[128:143]
    v_exp_f32 v120, v120
    v_exp_f32 v121, v121
    v_cvt_pk_bf16_f32 v84, v112, v113
    v_cvt_pk_bf16_f32 v85, v114, v115
    v_exp_f32 v122, v122
    v_exp_f32 v123, v123
    v_mfma_f32_16x16x32_bf16 v[36:39], v[32:35], v[76:79], v[36:39]
    v_exp_f32 v124, v124
    v_mfma_f32_32x32x16_bf16 v[128:143], v[72:75], v[80:83], v[128:143]
    s_add_u32 m0, s30, 0
    s_add_u32 s37, s31, 49152
    buffer_load_dwordx4 v6, s[12:15], s37 offen lds
    v_exp_f32 v125, v125
    v_cvt_pk_bf16_f32 v86, v116, v117
    v_cvt_pk_bf16_f32 v87, v118, v119
    v_exp_f32 v126, v126
    v_exp_f32 v127, v127
    v_mfma_f32_16x16x32_bf16 v[36:39], v[32:35], v[80:83], v[36:39]
    v_cvt_pk_bf16_f32 v88, v120, v121
    v_cvt_pk_bf16_f32 v89, v122, v123
    v_cvt_pk_bf16_f32 v90, v124, v125
    v_cvt_pk_bf16_f32 v91, v126, v127
    v_mfma_f32_32x32x16_bf16 v[112:127], v[44:47], v[24:27], v[176:191]
    ds_read_b128 v[60:63], v4 offset:49152
    ds_read_b128 v[64:67], v5 offset:49152
    v_exp_f32 v96, v96
    v_exp_f32 v97, v97
    v_exp_f32 v98, v98
    v_exp_f32 v99, v99
    v_mfma_f32_32x32x16_bf16 v[112:127], v[48:51], v[28:31], v[112:127]
    ds_read_b128 v[52:55], v4 offset:34816
    ds_read_b128 v[56:59], v5 offset:34816
    v_exp_f32 v100, v100
    v_exp_f32 v101, v101
    v_exp_f32 v102, v102
    v_exp_f32 v103, v103
    v_mfma_f32_32x32x16_bf16 v[144:159], v[68:71], v[84:87], v[144:159]
    v_exp_f32 v104, v104
    v_exp_f32 v105, v105
    v_cvt_pk_bf16_f32 v76, v96, v97
    v_cvt_pk_bf16_f32 v77, v98, v99
    v_exp_f32 v106, v106
    v_exp_f32 v107, v107
    v_mfma_f32_16x16x32_bf16 v[40:43], v[32:35], v[84:87], v[40:43]
    v_exp_f32 v108, v108
    v_mfma_f32_32x32x16_bf16 v[144:159], v[72:75], v[88:91], v[144:159]
    buffer_load_dwordx4 v6, s[12:15], s37 offen offset:1024 lds
    v_exp_f32 v109, v109
    v_cvt_pk_bf16_f32 v78, v100, v101
    v_cvt_pk_bf16_f32 v79, v102, v103
    v_exp_f32 v110, v110
    v_exp_f32 v111, v111
    v_mfma_f32_16x16x32_bf16 v[40:43], v[32:35], v[88:91], v[40:43]
    v_cvt_pk_bf16_f32 v80, v104, v105
    v_cvt_pk_bf16_f32 v81, v106, v107
    v_cvt_pk_bf16_f32 v82, v108, v109
    v_cvt_pk_bf16_f32 v83, v110, v111
    s_waitcnt lgkmcnt(0)
    v_mfma_f32_32x32x16_bf16 v[96:111], v[52:55], v[16:19], v[160:175]
    v_exp_f32 v112, v112
    v_exp_f32 v113, v113
    v_exp_f32 v114, v114
    v_exp_f32 v115, v115
    v_mfma_f32_32x32x16_bf16 v[96:111], v[56:59], v[20:23], v[96:111]
    v_exp_f32 v116, v116
    v_exp_f32 v117, v117
    v_exp_f32 v118, v118
    v_exp_f32 v119, v119
    v_mfma_f32_32x32x16_bf16 v[128:143], v[60:63], v[76:79], v[128:143]
    v_exp_f32 v120, v120
    v_exp_f32 v121, v121
    v_cvt_pk_bf16_f32 v84, v112, v113
    v_cvt_pk_bf16_f32 v85, v114, v115
    v_exp_f32 v122, v122
    v_exp_f32 v123, v123
    v_mfma_f32_16x16x32_bf16 v[36:39], v[32:35], v[76:79], v[36:39]
    v_exp_f32 v124, v124
    v_mfma_f32_32x32x16_bf16 v[128:143], v[64:67], v[80:83], v[128:143]
    s_add_u32 m0, s30, 16384
    s_nop 0
    buffer_load_dwordx4 v6, s[20:23], s37 offen lds
    v_exp_f32 v125, v125
    v_cvt_pk_bf16_f32 v86, v116, v117
    v_cvt_pk_bf16_f32 v87, v118, v119
    v_exp_f32 v126, v126
    v_exp_f32 v127, v127
    v_mfma_f32_16x16x32_bf16 v[36:39], v[32:35], v[80:83], v[36:39]
    v_cvt_pk_bf16_f32 v88, v120, v121
    v_cvt_pk_bf16_f32 v89, v122, v123
    v_cvt_pk_bf16_f32 v90, v124, v125
    v_cvt_pk_bf16_f32 v91, v126, v127
    v_mfma_f32_32x32x16_bf16 v[112:127], v[52:55], v[24:27], v[176:191]
    ds_read_b128 v[68:71], v4 offset:51200
    ds_read_b128 v[72:75], v5 offset:51200
    v_exp_f32 v96, v96
    v_exp_f32 v97, v97
    v_exp_f32 v98, v98
    v_exp_f32 v99, v99
    v_mfma_f32_32x32x16_bf16 v[112:127], v[56:59], v[28:31], v[112:127]
    ds_read_b128 v[44:47], v4 offset:36864
    ds_read_b128 v[48:51], v5 offset:36864
    v_exp_f32 v100, v100
    v_exp_f32 v101, v101
    v_exp_f32 v102, v102
    v_exp_f32 v103, v103
    v_mfma_f32_32x32x16_bf16 v[144:159], v[60:63], v[84:87], v[144:159]
    v_exp_f32 v104, v104
    v_exp_f32 v105, v105
    v_cvt_pk_bf16_f32 v76, v96, v97
    v_cvt_pk_bf16_f32 v77, v98, v99
    v_exp_f32 v106, v106
    v_exp_f32 v107, v107
    v_mfma_f32_16x16x32_bf16 v[40:43], v[32:35], v[84:87], v[40:43]
    v_exp_f32 v108, v108
    v_mfma_f32_32x32x16_bf16 v[144:159], v[64:67], v[88:91], v[144:159]
    buffer_load_dwordx4 v6, s[20:23], s37 offen offset:1024 lds
    v_exp_f32 v109, v109
    v_cvt_pk_bf16_f32 v78, v100, v101
    v_cvt_pk_bf16_f32 v79, v102, v103
    v_exp_f32 v110, v110
    v_exp_f32 v111, v111
    v_mfma_f32_16x16x32_bf16 v[40:43], v[32:35], v[88:91], v[40:43]
    v_cvt_pk_bf16_f32 v80, v104, v105
    v_cvt_pk_bf16_f32 v81, v106, v107
    v_cvt_pk_bf16_f32 v82, v108, v109
    v_cvt_pk_bf16_f32 v83, v110, v111
    s_waitcnt lgkmcnt(0)
    v_mfma_f32_32x32x16_bf16 v[96:111], v[44:47], v[16:19], v[160:175]
    v_exp_f32 v112, v112
    v_exp_f32 v113, v113
    v_exp_f32 v114, v114
    v_exp_f32 v115, v115
    v_mfma_f32_32x32x16_bf16 v[96:111], v[48:51], v[20:23], v[96:111]
    v_exp_f32 v116, v116
    v_exp_f32 v117, v117
    v_exp_f32 v118, v118
    v_exp_f32 v119, v119
    v_mfma_f32_32x32x16_bf16 v[128:143], v[68:71], v[76:79], v[128:143]
    v_exp_f32 v120, v120
    v_exp_f32 v121, v121
    v_cvt_pk_bf16_f32 v84, v112, v113
    v_cvt_pk_bf16_f32 v85, v114, v115
    v_exp_f32 v122, v122
    v_exp_f32 v123, v123
    v_mfma_f32_16x16x32_bf16 v[36:39], v[32:35], v[76:79], v[36:39]
    v_exp_f32 v124, v124
    v_mfma_f32_32x32x16_bf16 v[128:143], v[72:75], v[80:83], v[128:143]
    s_cmp_eq_u32 s65, 0
    s_cbranch_scc1 L_kc_mp
    v_add_f32 v212, v212, v213
    v_add_f32 v214, v214, v215
    s_lshl_b32 s38, s2, 7
    v_add_f32 v212, v212, v214
    s_add_u32 s38, s38, 8192
    v_mov_b32 v213, v212
    s_sub_u32 s39, s2, 32
    v_mov_b32 v215, 0
    v_permlane32_swap_b32 v213, v212
    s_cmp_ge_u32 s39, 64
    v_add_f32 v212, v212, v213
    v_cvt_pk_bf16_f32 v213, v212, v212
    v_lshlrev_b32 v212, 16, v213
    buffer_store_dword v212, v211, s[4:7], s38 offen
    s_cbranch_scc1 L_kc_mp
    v_add_f32 v214, 1.0, v212
    v_cvt_pk_bf16_f32 v214, v214, v214
    v_lshlrev_b32 v214, 16, v214
    s_cmp_ge_u32 s39, 32
    s_cselect_b64 vcc, -1, 0
    s_xor_b32 s39, s39, 32
    s_lshl_b32 s39, s39, 2
    s_add_u32 s39, s39, 133120
    v_lshlrev_b32 v209, 16, v210
    v_cndmask_b32 v213, v212, v214, vcc
    v_mul_f32 v213, v213, v209
    s_nop 1
    v_add_f32_dpp v213, v213, v213 quad_perm:[1,0,3,2] row_mask:0xf bank_mask:0xf
    s_nop 1
    v_add_f32_dpp v213, v213, v213 quad_perm:[2,3,0,1] row_mask:0xf bank_mask:0xf
    s_nop 1
    v_add_f32_dpp v213, v213, v213 row_half_mirror row_mask:0xf bank_mask:0xf
    s_nop 1
    v_add_f32_dpp v213, v213, v213 row_mirror row_mask:0xf bank_mask:0xf
    v_mov_b32 v214, v213
    s_nop 1
    v_permlane16_swap_b32 v214, v213
    s_nop 0
    v_add_f32 v213, v213, v214
    buffer_store_dword v213, v215, s[4:7], s39 offen
L_kc_mp:
    v_exp_f32 v125, v125
    v_cvt_pk_bf16_f32 v86, v116, v117
    v_cvt_pk_bf16_f32 v87, v118, v119
    v_exp_f32 v126, v126
    v_exp_f32 v127, v127
    v_mfma_f32_16x16x32_bf16 v[36:39], v[32:35], v[80:83], v[36:39]
    v_cvt_pk_bf16_f32 v88, v120, v121
    v_cvt_pk_bf16_f32 v89, v122, v123
    v_cvt_pk_bf16_f32 v90, v124, v125
    v_cvt_pk_bf16_f32 v91, v126, v127
    v_mfma_f32_32x32x16_bf16 v[112:127], v[44:47], v[24:27], v[176:191]
    ds_read_b128 v[60:63], v4 offset:53248
    ds_read_b128 v[64:67], v5 offset:53248
    v_exp_f32 v96, v96
    v_exp_f32 v97, v97
    v_exp_f32 v98, v98
    v_exp_f32 v99, v99
    v_mfma_f32_32x32x16_bf16 v[112:127], v[48:51], v[28:31], v[112:127]
    ds_read_b128 v[52:55], v4 offset:38912
    ds_read_b128 v[56:59], v5 offset:38912
    v_exp_f32 v100, v100
    v_exp_f32 v101, v101
    v_exp_f32 v102, v102
    v_exp_f32 v103, v103
    v_mfma_f32_32x32x16_bf16 v[144:159], v[68:71], v[84:87], v[144:159]
    v_exp_f32 v104, v104
    v_exp_f32 v105, v105
    v_cvt_pk_bf16_f32 v76, v96, v97
    v_cvt_pk_bf16_f32 v77, v98, v99
    v_exp_f32 v106, v106
    v_exp_f32 v107, v107
    v_mfma_f32_16x16x32_bf16 v[40:43], v[32:35], v[84:87], v[40:43]
    v_exp_f32 v108, v108
    v_mfma_f32_32x32x16_bf16 v[144:159], v[72:75], v[88:91], v[144:159]
    v_exp_f32 v109, v109
    v_cvt_pk_bf16_f32 v78, v100, v101
    v_cvt_pk_bf16_f32 v79, v102, v103
    v_exp_f32 v110, v110
    v_exp_f32 v111, v111
    v_mfma_f32_16x16x32_bf16 v[40:43], v[32:35], v[88:91], v[40:43]
    v_cvt_pk_bf16_f32 v80, v104, v105
    v_cvt_pk_bf16_f32 v81, v106, v107
    v_cvt_pk_bf16_f32 v82, v108, v109
    v_cvt_pk_bf16_f32 v83, v110, v111
    s_waitcnt lgkmcnt(0)
    v_mfma_f32_32x32x16_bf16 v[96:111], v[52:55], v[16:19], v[160:175]
    v_exp_f32 v112, v112
    v_exp_f32 v113, v113
    v_exp_f32 v114, v114
    v_exp_f32 v115, v115
    v_mfma_f32_32x32x16_bf16 v[96:111], v[56:59], v[20:23], v[96:111]
    v_exp_f32 v116, v116
    v_exp_f32 v117, v117
    v_exp_f32 v118, v118
    v_exp_f32 v119, v119
    v_mfma_f32_32x32x16_bf16 v[128:143], v[60:63], v[76:79], v[128:143]
    v_exp_f32 v120, v120
    v_exp_f32 v121, v121
    v_cvt_pk_bf16_f32 v84, v112, v113
    v_cvt_pk_bf16_f32 v85, v114, v115
    v_exp_f32 v122, v122
    v_exp_f32 v123, v123
    v_mfma_f32_16x16x32_bf16 v[36:39], v[32:35], v[76:79], v[36:39]
    v_exp_f32 v124, v124
    v_mfma_f32_32x32x16_bf16 v[128:143], v[64:67], v[80:83], v[128:143]
    v_exp_f32 v125, v125
    v_cvt_pk_bf16_f32 v86, v116, v117
    v_cvt_pk_bf16_f32 v87, v118, v119
    v_exp_f32 v126, v126
    v_exp_f32 v127, v127
    v_mfma_f32_16x16x32_bf16 v[36:39], v[32:35], v[80:83], v[36:39]
    v_cvt_pk_bf16_f32 v88, v120, v121
    v_cvt_pk_bf16_f32 v89, v122, v123
    v_cvt_pk_bf16_f32 v90, v124, v125
    v_cvt_pk_bf16_f32 v91, v126, v127
    v_mfma_f32_32x32x16_bf16 v[112:127], v[52:55], v[24:27], v[176:191]
    ds_read_b128 v[68:71], v4 offset:55296
    ds_read_b128 v[72:75], v5 offset:55296
    v_exp_f32 v96, v96
    v_exp_f32 v97, v97
    v_exp_f32 v98, v98
    v_exp_f32 v99, v99
    v_mfma_f32_32x32x16_bf16 v[112:127], v[56:59], v[28:31], v[112:127]
    v_exp_f32 v100, v100
    v_exp_f32 v101, v101
    v_exp_f32 v102, v102
    v_exp_f32 v103, v103
    v_mfma_f32_32x32x16_bf16 v[144:159], v[60:63], v[84:87], v[144:159]
    s_waitcnt vmcnt(4) lgkmcnt(0)
    s_barrier
    ds_read_b128 v[44:47], v92 offset:0
    ds_read_b128 v[48:51], v93 offset:0
    v_exp_f32 v104, v104
    v_exp_f32 v105, v105
    v_cvt_pk_bf16_f32 v76, v96, v97
    v_cvt_pk_bf16_f32 v77, v98, v99
    v_exp_f32 v106, v106
    v_exp_f32 v107, v107
    v_mfma_f32_16x16x32_bf16 v[40:43], v[32:35], v[84:87], v[40:43]
    v_exp_f32 v108, v108
    v_mfma_f32_32x32x16_bf16 v[144:159], v[64:67], v[88:91], v[144:159]
    v_exp_f32 v109, v109
    v_cvt_pk_bf16_f32 v78, v100, v101
    v_cvt_pk_bf16_f32 v79, v102, v103
    v_exp_f32 v110, v110
    v_exp_f32 v111, v111
    v_mfma_f32_16x16x32_bf16 v[40:43], v[32:35], v[88:91], v[40:43]
    v_cvt_pk_bf16_f32 v80, v104, v105
    v_cvt_pk_bf16_f32 v81, v106, v107
    v_cvt_pk_bf16_f32 v82, v108, v109
    v_cvt_pk_bf16_f32 v83, v110, v111
    s_waitcnt lgkmcnt(0)
    v_mfma_f32_32x32x16_bf16 v[96:111], v[44:47], v[16:19], v[160:175]
    v_exp_f32 v112, v112
    v_exp_f32 v113, v113
    v_exp_f32 v114, v114
    v_exp_f32 v115, v115
    v_mfma_f32_32x32x16_bf16 v[96:111], v[48:51], v[20:23], v[96:111]
    v_exp_f32 v116, v116
    v_exp_f32 v117, v117
    v_exp_f32 v118, v118
    v_exp_f32 v119, v119
    v_mfma_f32_32x32x16_bf16 v[128:143], v[68:71], v[76:79], v[128:143]
    v_exp_f32 v120, v120
    v_exp_f32 v121, v121
    v_cvt_pk_bf16_f32 v84, v112, v113
    v_cvt_pk_bf16_f32 v85, v114, v115
    v_exp_f32 v122, v122
    v_exp_f32 v123, v123
    v_mfma_f32_16x16x32_bf16 v[36:39], v[32:35], v[76:79], v[36:39]
    v_exp_f32 v124, v124
    v_mfma_f32_32x32x16_bf16 v[128:143], v[72:75], v[80:83], v[128:143]
    s_add_u32 m0, s30, 32768
    s_add_u32 s37, s31, 65536
    buffer_load_dwordx4 v6, s[12:15], s37 offen lds
    v_exp_f32 v125, v125
    v_cvt_pk_bf16_f32 v86, v116, v117
    v_cvt_pk_bf16_f32 v87, v118, v119
    v_exp_f32 v126, v126
    v_exp_f32 v127, v127
    v_mfma_f32_16x16x32_bf16 v[36:39], v[32:35], v[80:83], v[36:39]
    v_cvt_pk_bf16_f32 v88, v120, v121
    v_cvt_pk_bf16_f32 v89, v122, v123
    v_cvt_pk_bf16_f32 v90, v124, v125
    v_cvt_pk_bf16_f32 v91, v126, v127
    v_mfma_f32_32x32x16_bf16 v[112:127], v[44:47], v[24:27], v[176:191]
    ds_read_b128 v[60:63], v92 offset:16384
    ds_read_b128 v[64:67], v93 offset:16384
    v_exp_f32 v96, v96
    v_exp_f32 v97, v97
    v_exp_f32 v98, v98
    v_exp_f32 v99, v99
    v_mfma_f32_32x32x16_bf16 v[112:127], v[48:51], v[28:31], v[112:127]
    ds_read_b128 v[52:55], v92 offset:2048
    ds_read_b128 v[56:59], v93 offset:2048
    v_exp_f32 v100, v100
    v_exp_f32 v101, v101
    v_exp_f32 v102, v102
    v_exp_f32 v103, v103
    v_mfma_f32_32x32x16_bf16 v[144:159], v[68:71], v[84:87], v[144:159]
    v_exp_f32 v104, v104
    v_exp_f32 v105, v105
    v_cvt_pk_bf16_f32 v76, v96, v97
    v_cvt_pk_bf16_f32 v77, v98, v99
    v_exp_f32 v106, v106
    v_exp_f32 v107, v107
    v_mfma_f32_16x16x32_bf16 v[40:43], v[32:35], v[84:87], v[40:43]
    v_exp_f32 v108, v108
    v_mfma_f32_32x32x16_bf16 v[144:159], v[72:75], v[88:91], v[144:159]
    buffer_load_dwordx4 v6, s[12:15], s37 offen offset:1024 lds
    v_exp_f32 v109, v109
    v_cvt_pk_bf16_f32 v78, v100, v101
    v_cvt_pk_bf16_f32 v79, v102, v103
    v_exp_f32 v110, v110
    v_exp_f32 v111, v111
    v_mfma_f32_16x16x32_bf16 v[40:43], v[32:35], v[88:91], v[40:43]
    v_cvt_pk_bf16_f32 v80, v104, v105
    v_cvt_pk_bf16_f32 v81, v106, v107
    v_cvt_pk_bf16_f32 v82, v108, v109
    v_cvt_pk_bf16_f32 v83, v110, v111
    s_waitcnt lgkmcnt(0)
    v_mfma_f32_32x32x16_bf16 v[96:111], v[52:55], v[16:19], v[160:175]
    v_exp_f32 v112, v112
    v_exp_f32 v113, v113
    v_exp_f32 v114, v114
    v_exp_f32 v115, v115
    v_mfma_f32_32x32x16_bf16 v[96:111], v[56:59], v[20:23], v[96:111]
    v_exp_f32 v116, v116
    v_exp_f32 v117, v117
    v_exp_f32 v118, v118
    v_exp_f32 v119, v119
    v_mfma_f32_32x32x16_bf16 v[128:143], v[60:63], v[76:79], v[128:143]
    v_exp_f32 v120, v120
    v_exp_f32 v121, v121
    v_cvt_pk_bf16_f32 v84, v112, v113
    v_cvt_pk_bf16_f32 v85, v114, v115
    v_exp_f32 v122, v122
    v_exp_f32 v123, v123
    v_mfma_f32_16x16x32_bf16 v[36:39], v[32:35], v[76:79], v[36:39]
    v_exp_f32 v124, v124
    v_mfma_f32_32x32x16_bf16 v[128:143], v[64:67], v[80:83], v[128:143]
    s_add_u32 m0, s30, 49152
    s_nop 0
    buffer_load_dwordx4 v6, s[20:23], s37 offen lds
    v_exp_f32 v125, v125
    v_cvt_pk_bf16_f32 v86, v116, v117
    v_cvt_pk_bf16_f32 v87, v118, v119
    v_exp_f32 v126, v126
    v_exp_f32 v127, v127
    v_mfma_f32_16x16x32_bf16 v[36:39], v[32:35], v[80:83], v[36:39]
    v_cvt_pk_bf16_f32 v88, v120, v121
    v_cvt_pk_bf16_f32 v89, v122, v123
    v_cvt_pk_bf16_f32 v90, v124, v125
    v_cvt_pk_bf16_f32 v91, v126, v127
    v_mfma_f32_32x32x16_bf16 v[112:127], v[52:55], v[24:27], v[176:191]
    ds_read_b128 v[68:71], v92 offset:18432
    ds_read_b128 v[72:75], v93 offset:18432
    v_exp_f32 v96, v96
    v_exp_f32 v97, v97
    v_exp_f32 v98, v98
    v_exp_f32 v99, v99
    v_mfma_f32_32x32x16_bf16 v[112:127], v[56:59], v[28:31], v[112:127]
    ds_read_b128 v[44:47], v92 offset:4096
    ds_read_b128 v[48:51], v93 offset:4096
    v_exp_f32 v100, v100
    v_exp_f32 v101, v101
    v_exp_f32 v102, v102
    v_exp_f32 v103, v103
    v_mfma_f32_32x32x16_bf16 v[144:159], v[60:63], v[84:87], v[144:159]
    v_exp_f32 v104, v104
    v_exp_f32 v105, v105
    v_cvt_pk_bf16_f32 v76, v96, v97
    v_cvt_pk_bf16_f32 v77, v98, v99
    v_exp_f32 v106, v106
    v_exp_f32 v107, v107
    v_mfma_f32_16x16x32_bf16 v[40:43], v[32:35], v[84:87], v[40:43]
    v_exp_f32 v108, v108
    v_mfma_f32_32x32x16_bf16 v[144:159], v[64:67], v[88:91], v[144:159]
    buffer_load_dwordx4 v6, s[20:23], s37 offen offset:1024 lds
    v_exp_f32 v109, v109
    v_cvt_pk_bf16_f32 v78, v100, v101
    v_cvt_pk_bf16_f32 v79, v102, v103
    v_exp_f32 v110, v110
    v_exp_f32 v111, v111
    v_mfma_f32_16x16x32_bf16 v[40:43], v[32:35], v[88:91], v[40:43]
    v_cvt_pk_bf16_f32 v80, v104, v105
    v_cvt_pk_bf16_f32 v81, v106, v107
    v_cvt_pk_bf16_f32 v82, v108, v109
    v_cvt_pk_bf16_f32 v83, v110, v111
    s_waitcnt lgkmcnt(0)
    v_mfma_f32_32x32x16_bf16 v[96:111], v[44:47], v[16:19], v[160:175]
    v_exp_f32 v112, v112
    v_exp_f32 v113, v113
    v_exp_f32 v114, v114
    v_exp_f32 v115, v115
    v_mfma_f32_32x32x16_bf16 v[96:111], v[48:51], v[20:23], v[96:111]
    v_exp_f32 v116, v116
    v_exp_f32 v117, v117
    v_exp_f32 v118, v118
    v_exp_f32 v119, v119
    v_mfma_f32_32x32x16_bf16 v[128:143], v[68:71], v[76:79], v[128:143]
    v_exp_f32 v120, v120
    v_exp_f32 v121, v121
    v_cvt_pk_bf16_f32 v84, v112, v113
    v_cvt_pk_bf16_f32 v85, v114, v115
    v_exp_f32 v122, v122
    v_exp_f32 v123, v123
    v_mfma_f32_16x16x32_bf16 v[36:39], v[32:35], v[76:79], v[36:39]
    v_exp_f32 v124, v124
    v_mfma_f32_32x32x16_bf16 v[128:143], v[72:75], v[80:83], v[128:143]
    v_exp_f32 v125, v125
    v_cvt_pk_bf16_f32 v86, v116, v117
    v_cvt_pk_bf16_f32 v87, v118, v119
    v_exp_f32 v126, v126
    v_exp_f32 v127, v127
    v_mfma_f32_16x16x32_bf16 v[36:39], v[32:35], v[80:83], v[36:39]
    v_cvt_pk_bf16_f32 v88, v120, v121
    v_cvt_pk_bf16_f32 v89, v122, v123
    v_cvt_pk_bf16_f32 v90, v124, v125
    v_cvt_pk_bf16_f32 v91, v126, v127
    v_mfma_f32_32x32x16_bf16 v[112:127], v[44:47], v[24:27], v[176:191]
    ds_read_b128 v[60:63], v92 offset:20480
    ds_read_b128 v[64:67], v93 offset:20480
    v_exp_f32 v96, v96
    v_exp_f32 v97, v97
    v_exp_f32 v98, v98
    v_exp_f32 v99, v99
    v_mfma_f32_32x32x16_bf16 v[112:127], v[48:51], v[28:31], v[112:127]
    ds_read_b128 v[52:55], v92 offset:6144
    ds_read_b128 v[56:59], v93 offset:6144
    v_exp_f32 v100, v100
    v_exp_f32 v101, v101
    v_exp_f32 v102, v102
    v_exp_f32 v103, v103
    v_mfma_f32_32x32x16_bf16 v[144:159], v[68:71], v[84:87], v[144:159]
    v_exp_f32 v104, v104
    v_exp_f32 v105, v105
    v_cvt_pk_bf16_f32 v76, v96, v97
    v_cvt_pk_bf16_f32 v77, v98, v99
    v_exp_f32 v106, v106
    v_exp_f32 v107, v107
    v_mfma_f32_16x16x32_bf16 v[40:43], v[32:35], v[84:87], v[40:43]
    v_exp_f32 v108, v108
    v_mfma_f32_32x32x16_bf16 v[144:159], v[72:75], v[88:91], v[144:159]
    v_exp_f32 v109, v109
    v_cvt_pk_bf16_f32 v78, v100, v101
    v_cvt_pk_bf16_f32 v79, v102, v103
    v_exp_f32 v110, v110
    v_exp_f32 v111, v111
    v_mfma_f32_16x16x32_bf16 v[40:43], v[32:35], v[88:91], v[40:43]
    v_cvt_pk_bf16_f32 v80, v104, v105
    v_cvt_pk_bf16_f32 v81, v106, v107
    v_cvt_pk_bf16_f32 v82, v108, v109
    v_cvt_pk_bf16_f32 v83, v110, v111
    s_waitcnt lgkmcnt(0)
    v_mfma_f32_32x32x16_bf16 v[96:111], v[52:55], v[16:19], v[160:175]
    v_exp_f32 v112, v112
    v_exp_f32 v113, v113
    v_exp_f32 v114, v114
    v_exp_f32 v115, v115
    v_mfma_f32_32x32x16_bf16 v[96:111], v[56:59], v[20:23], v[96:111]
    v_exp_f32 v116, v116
    v_exp_f32 v117, v117
    v_exp_f32 v118, v118
    v_exp_f32 v119, v119
    v_mfma_f32_32x32x16_bf16 v[128:143], v[60:63], v[76:79], v[128:143]
    v_exp_f32 v120, v120
    v_exp_f32 v121, v121
    v_cvt_pk_bf16_f32 v84, v112, v113
    v_cvt_pk_bf16_f32 v85, v114, v115
    v_exp_f32 v122, v122
    v_exp_f32 v123, v123
    v_mfma_f32_16x16x32_bf16 v[36:39], v[32:35], v[76:79], v[36:39]
    v_exp_f32 v124, v124
    v_mfma_f32_32x32x16_bf16 v[128:143], v[64:67], v[80:83], v[128:143]
    v_exp_f32 v125, v125
    v_cvt_pk_bf16_f32 v86, v116, v117
    v_cvt_pk_bf16_f32 v87, v118, v119
    v_exp_f32 v126, v126
    v_exp_f32 v127, v127
    v_mfma_f32_16x16x32_bf16 v[36:39], v[32:35], v[80:83], v[36:39]
    v_cvt_pk_bf16_f32 v88, v120, v121
    v_cvt_pk_bf16_f32 v89, v122, v123
    v_cvt_pk_bf16_f32 v90, v124, v125
    v_cvt_pk_bf16_f32 v91, v126, v127
    v_mfma_f32_32x32x16_bf16 v[112:127], v[52:55], v[24:27], v[176:191]
    ds_read_b128 v[68:71], v92 offset:22528
    ds_read_b128 v[72:75], v93 offset:22528
    v_exp_f32 v96, v96
    v_exp_f32 v97, v97
    v_exp_f32 v98, v98
    v_exp_f32 v99, v99
    v_mfma_f32_32x32x16_bf16 v[112:127], v[56:59], v[28:31], v[112:127]
    v_exp_f32 v100, v100
    v_exp_f32 v101, v101
    v_exp_f32 v102, v102
    v_exp_f32 v103, v103
    v_mfma_f32_32x32x16_bf16 v[144:159], v[60:63], v[84:87], v[144:159]
    s_waitcnt vmcnt(4) lgkmcnt(0)
    s_barrier
    ds_read_b128 v[44:47], v4 offset:0
    ds_read_b128 v[48:51], v5 offset:0
    v_exp_f32 v104, v104
    v_exp_f32 v105, v105
    v_cvt_pk_bf16_f32 v76, v96, v97
    v_cvt_pk_bf16_f32 v77, v98, v99
    v_exp_f32 v106, v106
    v_exp_f32 v107, v107
    v_mfma_f32_16x16x32_bf16 v[40:43], v[32:35], v[84:87], v[40:43]
    v_exp_f32 v108, v108
    v_mfma_f32_32x32x16_bf16 v[144:159], v[64:67], v[88:91], v[144:159]
    v_exp_f32 v109, v109
    v_cvt_pk_bf16_f32 v78, v100, v101
    v_cvt_pk_bf16_f32 v79, v102, v103
    v_exp_f32 v110, v110
    v_exp_f32 v111, v111
    v_mfma_f32_16x16x32_bf16 v[40:43], v[32:35], v[88:91], v[40:43]
    v_cvt_pk_bf16_f32 v80, v104, v105
    v_cvt_pk_bf16_f32 v81, v106, v107
    v_cvt_pk_bf16_f32 v82, v108, v109
    v_cvt_pk_bf16_f32 v83, v110, v111
    s_waitcnt lgkmcnt(0)
    v_mfma_f32_32x32x16_bf16 v[96:111], v[44:47], v[16:19], v[160:175]
    v_exp_f32 v112, v112
    v_exp_f32 v113, v113
    v_exp_f32 v114, v114
    v_exp_f32 v115, v115
    v_mfma_f32_32x32x16_bf16 v[96:111], v[48:51], v[20:23], v[96:111]
    v_exp_f32 v116, v116
    v_exp_f32 v117, v117
    v_exp_f32 v118, v118
    v_exp_f32 v119, v119
    v_mfma_f32_32x32x16_bf16 v[128:143], v[68:71], v[76:79], v[128:143]
    v_exp_f32 v120, v120
    v_exp_f32 v121, v121
    v_cvt_pk_bf16_f32 v84, v112, v113
    v_cvt_pk_bf16_f32 v85, v114, v115
    v_exp_f32 v122, v122
    v_exp_f32 v123, v123
    v_mfma_f32_16x16x32_bf16 v[36:39], v[32:35], v[76:79], v[36:39]
    v_exp_f32 v124, v124
    v_mfma_f32_32x32x16_bf16 v[128:143], v[72:75], v[80:83], v[128:143]
    s_add_u32 m0, s30, 65536
    s_add_u32 s37, s31, 81920
    buffer_load_dwordx4 v6, s[12:15], s37 offen lds
    v_exp_f32 v125, v125
    v_cvt_pk_bf16_f32 v86, v116, v117
    v_cvt_pk_bf16_f32 v87, v118, v119
    v_exp_f32 v126, v126
    v_exp_f32 v127, v127
    v_mfma_f32_16x16x32_bf16 v[36:39], v[32:35], v[80:83], v[36:39]
    v_cvt_pk_bf16_f32 v88, v120, v121
    v_cvt_pk_bf16_f32 v89, v122, v123
    v_cvt_pk_bf16_f32 v90, v124, v125
    v_cvt_pk_bf16_f32 v91, v126, v127
    v_mfma_f32_32x32x16_bf16 v[112:127], v[44:47], v[24:27], v[176:191]
    ds_read_b128 v[60:63], v4 offset:16384
    ds_read_b128 v[64:67], v5 offset:16384
    v_exp_f32 v96, v96
    v_exp_f32 v97, v97
    v_exp_f32 v98, v98
    v_exp_f32 v99, v99
    v_mfma_f32_32x32x16_bf16 v[112:127], v[48:51], v[28:31], v[112:127]
    ds_read_b128 v[52:55], v4 offset:2048
    ds_read_b128 v[56:59], v5 offset:2048
    v_exp_f32 v100, v100
    v_exp_f32 v101, v101
    v_exp_f32 v102, v102
    v_exp_f32 v103, v103
    v_mfma_f32_32x32x16_bf16 v[144:159], v[68:71], v[84:87], v[144:159]
    v_exp_f32 v104, v104
    v_exp_f32 v105, v105
    v_cvt_pk_bf16_f32 v76, v96, v97
    v_cvt_pk_bf16_f32 v77, v98, v99
    v_exp_f32 v106, v106
    v_exp_f32 v107, v107
    v_mfma_f32_16x16x32_bf16 v[40:43], v[32:35], v[84:87], v[40:43]
    v_exp_f32 v108, v108
    v_mfma_f32_32x32x16_bf16 v[144:159], v[72:75], v[88:91], v[144:159]
    buffer_load_dwordx4 v6, s[12:15], s37 offen offset:1024 lds
    v_exp_f32 v109, v109
    v_cvt_pk_bf16_f32 v78, v100, v101
    v_cvt_pk_bf16_f32 v79, v102, v103
    v_exp_f32 v110, v110
    v_exp_f32 v111, v111
    v_mfma_f32_16x16x32_bf16 v[40:43], v[32:35], v[88:91], v[40:43]
    v_cvt_pk_bf16_f32 v80, v104, v105
    v_cvt_pk_bf16_f32 v81, v106, v107
    v_cvt_pk_bf16_f32 v82, v108, v109
    v_cvt_pk_bf16_f32 v83, v110, v111
    s_waitcnt lgkmcnt(0)
    v_mfma_f32_32x32x16_bf16 v[96:111], v[52:55], v[16:19], v[160:175]
    v_exp_f32 v112, v112
    v_exp_f32 v113, v113
    v_exp_f32 v114, v114
    v_exp_f32 v115, v115
    v_mfma_f32_32x32x16_bf16 v[96:111], v[56:59], v[20:23], v[96:111]
    v_exp_f32 v116, v116
    v_exp_f32 v117, v117
    v_exp_f32 v118, v118
    v_exp_f32 v119, v119
    v_mfma_f32_32x32x16_bf16 v[128:143], v[60:63], v[76:79], v[128:143]
    v_exp_f32 v120, v120
    v_exp_f32 v121, v121
    v_cvt_pk_bf16_f32 v84, v112, v113
    v_cvt_pk_bf16_f32 v85, v114, v115
    v_exp_f32 v122, v122
    v_exp_f32 v123, v123
    v_mfma_f32_16x16x32_bf16 v[36:39], v[32:35], v[76:79], v[36:39]
    v_exp_f32 v124, v124
    v_mfma_f32_32x32x16_bf16 v[128:143], v[64:67], v[80:83], v[128:143]
    s_add_u32 m0, s30, 81920
    s_nop 0
    buffer_load_dwordx4 v6, s[20:23], s37 offen lds
    v_exp_f32 v125, v125
    v_cvt_pk_bf16_f32 v86, v116, v117
    v_cvt_pk_bf16_f32 v87, v118, v119
    v_exp_f32 v126, v126
    v_exp_f32 v127, v127
    v_mfma_f32_16x16x32_bf16 v[36:39], v[32:35], v[80:83], v[36:39]
    v_cvt_pk_bf16_f32 v88, v120, v121
    v_cvt_pk_bf16_f32 v89, v122, v123
    v_cvt_pk_bf16_f32 v90, v124, v125
    v_cvt_pk_bf16_f32 v91, v126, v127
    v_mfma_f32_32x32x16_bf16 v[112:127], v[52:55], v[24:27], v[176:191]
    ds_read_b128 v[68:71], v4 offset:18432
    ds_read_b128 v[72:75], v5 offset:18432
    v_exp_f32 v96, v96
    v_exp_f32 v97, v97
    v_exp_f32 v98, v98
    v_exp_f32 v99, v99
    v_mfma_f32_32x32x16_bf16 v[112:127], v[56:59], v[28:31], v[112:127]
    ds_read_b128 v[44:47], v4 offset:4096
    ds_read_b128 v[48:51], v5 offset:4096
    v_exp_f32 v100, v100
    v_exp_f32 v101, v101
    v_exp_f32 v102, v102
    v_exp_f32 v103, v103
    v_mfma_f32_32x32x16_bf16 v[144:159], v[60:63], v[84:87], v[144:159]
    v_exp_f32 v104, v104
    v_exp_f32 v105, v105
    v_cvt_pk_bf16_f32 v76, v96, v97
    v_cvt_pk_bf16_f32 v77, v98, v99
    v_exp_f32 v106, v106
    v_exp_f32 v107, v107
    v_mfma_f32_16x16x32_bf16 v[40:43], v[32:35], v[84:87], v[40:43]
    v_exp_f32 v108, v108
    v_mfma_f32_32x32x16_bf16 v[144:159], v[64:67], v[88:91], v[144:159]
    buffer_load_dwordx4 v6, s[20:23], s37 offen offset:1024 lds
    v_exp_f32 v109, v109
    v_cvt_pk_bf16_f32 v78, v100, v101
    v_cvt_pk_bf16_f32 v79, v102, v103
    v_exp_f32 v110, v110
    v_exp_f32 v111, v111
    v_mfma_f32_16x16x32_bf16 v[40:43], v[32:35], v[88:91], v[40:43]
    v_cvt_pk_bf16_f32 v80, v104, v105
    v_cvt_pk_bf16_f32 v81, v106, v107
    v_cvt_pk_bf16_f32 v82, v108, v109
    v_cvt_pk_bf16_f32 v83, v110, v111
    s_waitcnt lgkmcnt(0)
    v_mfma_f32_32x32x16_bf16 v[96:111], v[44:47], v[16:19], v[160:175]
    v_exp_f32 v112, v112
    v_exp_f32 v113, v113
    v_exp_f32 v114, v114
    v_exp_f32 v115, v115
    v_mfma_f32_32x32x16_bf16 v[96:111], v[48:51], v[20:23], v[96:111]
    v_exp_f32 v116, v116
    v_exp_f32 v117, v117
    v_exp_f32 v118, v118
    v_exp_f32 v119, v119
    v_mfma_f32_32x32x16_bf16 v[128:143], v[68:71], v[76:79], v[128:143]
    v_exp_f32 v120, v120
    v_exp_f32 v121, v121
    v_cvt_pk_bf16_f32 v84, v112, v113
    v_cvt_pk_bf16_f32 v85, v114, v115
    v_exp_f32 v122, v122
    v_exp_f32 v123, v123
    v_mfma_f32_16x16x32_bf16 v[36:39], v[32:35], v[76:79], v[36:39]
    v_exp_f32 v124, v124
    v_mfma_f32_32x32x16_bf16 v[128:143], v[72:75], v[80:83], v[128:143]
    buffer_load_dword v205, v206, s[52:55], 0 offen
    v_exp_f32 v125, v125
    v_cvt_pk_bf16_f32 v86, v116, v117
    v_cvt_pk_bf16_f32 v87, v118, v119
    v_exp_f32 v126, v126
    v_exp_f32 v127, v127
    v_mfma_f32_16x16x32_bf16 v[36:39], v[32:35], v[80:83], v[36:39]
    v_cvt_pk_bf16_f32 v88, v120, v121
    v_cvt_pk_bf16_f32 v89, v122, v123
    v_cvt_pk_bf16_f32 v90, v124, v125
    v_cvt_pk_bf16_f32 v91, v126, v127
    v_mfma_f32_32x32x16_bf16 v[112:127], v[44:47], v[24:27], v[176:191]
    ds_read_b128 v[60:63], v4 offset:20480
    ds_read_b128 v[64:67], v5 offset:20480
    v_exp_f32 v96, v96
    v_exp_f32 v97, v97
    v_exp_f32 v98, v98
    v_exp_f32 v99, v99
    v_mfma_f32_32x32x16_bf16 v[112:127], v[48:51], v[28:31], v[112:127]
    ds_read_b128 v[52:55], v4 offset:6144
    ds_read_b128 v[56:59], v5 offset:6144
    v_exp_f32 v100, v100
    v_exp_f32 v101, v101
    v_exp_f32 v102, v102
    v_exp_f32 v103, v103
    v_mfma_f32_32x32x16_bf16 v[144:159], v[68:71], v[84:87], v[144:159]
    v_exp_f32 v104, v104
    v_exp_f32 v105, v105
    v_cvt_pk_bf16_f32 v76, v96, v97
    v_cvt_pk_bf16_f32 v77, v98, v99
    v_exp_f32 v106, v106
    v_exp_f32 v107, v107
    v_mfma_f32_16x16x32_bf16 v[40:43], v[32:35], v[84:87], v[40:43]
    v_exp_f32 v108, v108
    v_mfma_f32_32x32x16_bf16 v[144:159], v[72:75], v[88:91], v[144:159]
    v_exp_f32 v109, v109
    v_cvt_pk_bf16_f32 v78, v100, v101
    v_cvt_pk_bf16_f32 v79, v102, v103
    v_exp_f32 v110, v110
    v_exp_f32 v111, v111
    v_mfma_f32_16x16x32_bf16 v[40:43], v[32:35], v[88:91], v[40:43]
    v_cvt_pk_bf16_f32 v80, v104, v105
    v_cvt_pk_bf16_f32 v81, v106, v107
    v_cvt_pk_bf16_f32 v82, v108, v109
    v_cvt_pk_bf16_f32 v83, v110, v111
    s_waitcnt lgkmcnt(0)
    v_mfma_f32_32x32x16_bf16 v[96:111], v[52:55], v[16:19], v[160:175]
    v_exp_f32 v112, v112
    v_exp_f32 v113, v113
    v_exp_f32 v114, v114
    v_exp_f32 v115, v115
    v_mfma_f32_32x32x16_bf16 v[96:111], v[56:59], v[20:23], v[96:111]
    v_exp_f32 v116, v116
    v_exp_f32 v117, v117
    v_exp_f32 v118, v118
    v_exp_f32 v119, v119
    v_mfma_f32_32x32x16_bf16 v[128:143], v[60:63], v[76:79], v[128:143]
    v_exp_f32 v120, v120
    v_exp_f32 v121, v121
    v_cvt_pk_bf16_f32 v84, v112, v113
    v_cvt_pk_bf16_f32 v85, v114, v115
    v_exp_f32 v122, v122
    v_exp_f32 v123, v123
    v_mfma_f32_16x16x32_bf16 v[36:39], v[32:35], v[76:79], v[36:39]
    v_exp_f32 v124, v124
    v_mfma_f32_32x32x16_bf16 v[128:143], v[64:67], v[80:83], v[128:143]
    v_exp_f32 v125, v125
    v_cvt_pk_bf16_f32 v86, v116, v117
    v_cvt_pk_bf16_f32 v87, v118, v119
    v_exp_f32 v126, v126
    v_exp_f32 v127, v127
    v_mfma_f32_16x16x32_bf16 v[36:39], v[32:35], v[80:83], v[36:39]
    v_cvt_pk_bf16_f32 v88, v120, v121
    v_cvt_pk_bf16_f32 v89, v122, v123
    v_cvt_pk_bf16_f32 v90, v124, v125
    v_cvt_pk_bf16_f32 v91, v126, v127
    v_mfma_f32_32x32x16_bf16 v[112:127], v[52:55], v[24:27], v[176:191]
    ds_read_b128 v[68:71], v4 offset:22528
    ds_read_b128 v[72:75], v5 offset:22528
    v_exp_f32 v96, v96
    v_exp_f32 v97, v97
    v_exp_f32 v98, v98
    v_exp_f32 v99, v99
    v_mfma_f32_32x32x16_bf16 v[112:127], v[56:59], v[28:31], v[112:127]
    v_exp_f32 v100, v100
    v_exp_f32 v101, v101
    v_exp_f32 v102, v102
    v_exp_f32 v103, v103
    v_mfma_f32_32x32x16_bf16 v[144:159], v[60:63], v[84:87], v[144:159]
    s_waitcnt vmcnt(5) lgkmcnt(0)
    s_barrier
    ds_read_b128 v[44:47], v4 offset:32768
    ds_read_b128 v[48:51], v5 offset:32768
    v_exp_f32 v104, v104
    v_exp_f32 v105, v105
    v_cvt_pk_bf16_f32 v76, v96, v97
    v_cvt_pk_bf16_f32 v77, v98, v99
    v_exp_f32 v106, v106
    v_exp_f32 v107, v107
    v_mfma_f32_16x16x32_bf16 v[40:43], v[32:35], v[84:87], v[40:43]
    v_exp_f32 v108, v108
    v_mfma_f32_32x32x16_bf16 v[144:159], v[64:67], v[88:91], v[144:159]
    v_exp_f32 v109, v109
    v_cvt_pk_bf16_f32 v78, v100, v101
    v_cvt_pk_bf16_f32 v79, v102, v103
    v_exp_f32 v110, v110
    v_exp_f32 v111, v111
    v_mfma_f32_16x16x32_bf16 v[40:43], v[32:35], v[88:91], v[40:43]
    v_cvt_pk_bf16_f32 v80, v104, v105
    v_cvt_pk_bf16_f32 v81, v106, v107
    v_cvt_pk_bf16_f32 v82, v108, v109
    v_cvt_pk_bf16_f32 v83, v110, v111
    s_waitcnt lgkmcnt(0)
    v_mfma_f32_32x32x16_bf16 v[96:111], v[44:47], v[16:19], v[160:175]
    v_exp_f32 v112, v112
    v_exp_f32 v113, v113
    v_exp_f32 v114, v114
    v_exp_f32 v115, v115
    v_mfma_f32_32x32x16_bf16 v[96:111], v[48:51], v[20:23], v[96:111]
    v_exp_f32 v116, v116
    v_exp_f32 v117, v117
    v_exp_f32 v118, v118
    v_exp_f32 v119, v119
    v_mfma_f32_32x32x16_bf16 v[128:143], v[68:71], v[76:79], v[128:143]
    v_exp_f32 v120, v120
    v_exp_f32 v121, v121
    v_cvt_pk_bf16_f32 v84, v112, v113
    v_cvt_pk_bf16_f32 v85, v114, v115
    v_exp_f32 v122, v122
    v_exp_f32 v123, v123
    v_mfma_f32_16x16x32_bf16 v[36:39], v[32:35], v[76:79], v[36:39]
    v_exp_f32 v124, v124
    v_mfma_f32_32x32x16_bf16 v[128:143], v[72:75], v[80:83], v[128:143]
    s_add_u32 m0, s30, 0
    s_add_u32 s37, s31, 98304
    buffer_load_dwordx4 v6, s[12:15], s37 offen lds
    v_exp_f32 v125, v125
    v_cvt_pk_bf16_f32 v86, v116, v117
    v_cvt_pk_bf16_f32 v87, v118, v119
    v_exp_f32 v126, v126
    v_exp_f32 v127, v127
    v_mfma_f32_16x16x32_bf16 v[36:39], v[32:35], v[80:83], v[36:39]
    v_cvt_pk_bf16_f32 v88, v120, v121
    v_cvt_pk_bf16_f32 v89, v122, v123
    v_cvt_pk_bf16_f32 v90, v124, v125
    v_cvt_pk_bf16_f32 v91, v126, v127
    v_mfma_f32_32x32x16_bf16 v[112:127], v[44:47], v[24:27], v[176:191]
    ds_read_b128 v[60:63], v4 offset:49152
    ds_read_b128 v[64:67], v5 offset:49152
    v_exp_f32 v96, v96
    v_exp_f32 v97, v97
    v_exp_f32 v98, v98
    v_exp_f32 v99, v99
    v_mfma_f32_32x32x16_bf16 v[112:127], v[48:51], v[28:31], v[112:127]
    ds_read_b128 v[52:55], v4 offset:34816
    ds_read_b128 v[56:59], v5 offset:34816
    v_exp_f32 v100, v100
    v_exp_f32 v101, v101
    v_exp_f32 v102, v102
    v_exp_f32 v103, v103
    v_mfma_f32_32x32x16_bf16 v[144:159], v[68:71], v[84:87], v[144:159]
    v_exp_f32 v104, v104
    v_exp_f32 v105, v105
    v_cvt_pk_bf16_f32 v76, v96, v97
    v_cvt_pk_bf16_f32 v77, v98, v99
    v_exp_f32 v106, v106
    v_exp_f32 v107, v107
    v_mfma_f32_16x16x32_bf16 v[40:43], v[32:35], v[84:87], v[40:43]
    v_exp_f32 v108, v108
    v_mfma_f32_32x32x16_bf16 v[144:159], v[72:75], v[88:91], v[144:159]
    buffer_load_dwordx4 v6, s[12:15], s37 offen offset:1024 lds
    v_exp_f32 v109, v109
    v_cvt_pk_bf16_f32 v78, v100, v101
    v_cvt_pk_bf16_f32 v79, v102, v103
    v_exp_f32 v110, v110
    v_exp_f32 v111, v111
    v_mfma_f32_16x16x32_bf16 v[40:43], v[32:35], v[88:91], v[40:43]
    v_cvt_pk_bf16_f32 v80, v104, v105
    v_cvt_pk_bf16_f32 v81, v106, v107
    v_cvt_pk_bf16_f32 v82, v108, v109
    v_cvt_pk_bf16_f32 v83, v110, v111
    s_waitcnt lgkmcnt(0)
    v_mfma_f32_32x32x16_bf16 v[96:111], v[52:55], v[16:19], v[160:175]
    v_exp_f32 v112, v112
    v_exp_f32 v113, v113
    v_exp_f32 v114, v114
    v_exp_f32 v115, v115
    v_mfma_f32_32x32x16_bf16 v[96:111], v[56:59], v[20:23], v[96:111]
    v_exp_f32 v116, v116
    v_exp_f32 v117, v117
    v_exp_f32 v118, v118
    v_exp_f32 v119, v119
    v_mfma_f32_32x32x16_bf16 v[128:143], v[60:63], v[76:79], v[128:143]
    v_exp_f32 v120, v120
    v_exp_f32 v121, v121
    v_cvt_pk_bf16_f32 v84, v112, v113
    v_cvt_pk_bf16_f32 v85, v114, v115
    v_exp_f32 v122, v122
    v_exp_f32 v123, v123
    v_mfma_f32_16x16x32_bf16 v[36:39], v[32:35], v[76:79], v[36:39]
    v_exp_f32 v124, v124
    v_mfma_f32_32x32x16_bf16 v[128:143], v[64:67], v[80:83], v[128:143]
    s_add_u32 m0, s30, 16384
    s_nop 0
    buffer_load_dwordx4 v6, s[20:23], s37 offen lds
    v_exp_f32 v125, v125
    v_cvt_pk_bf16_f32 v86, v116, v117
    v_cvt_pk_bf16_f32 v87, v118, v119
    v_exp_f32 v126, v126
    v_exp_f32 v127, v127
    v_mfma_f32_16x16x32_bf16 v[36:39], v[32:35], v[80:83], v[36:39]
    v_cvt_pk_bf16_f32 v88, v120, v121
    v_cvt_pk_bf16_f32 v89, v122, v123
    v_cvt_pk_bf16_f32 v90, v124, v125
    v_cvt_pk_bf16_f32 v91, v126, v127
    v_mfma_f32_32x32x16_bf16 v[112:127], v[52:55], v[24:27], v[176:191]
    ds_read_b128 v[68:71], v4 offset:51200
    ds_read_b128 v[72:75], v5 offset:51200
    v_exp_f32 v96, v96
    v_exp_f32 v97, v97
    v_exp_f32 v98, v98
    v_exp_f32 v99, v99
    v_mfma_f32_32x32x16_bf16 v[112:127], v[56:59], v[28:31], v[112:127]
    ds_read_b128 v[44:47], v4 offset:36864
    ds_read_b128 v[48:51], v5 offset:36864
    v_exp_f32 v100, v100
    v_exp_f32 v101, v101
    v_exp_f32 v102, v102
    v_exp_f32 v103, v103
    v_mfma_f32_32x32x16_bf16 v[144:159], v[60:63], v[84:87], v[144:159]
    v_exp_f32 v104, v104
    v_exp_f32 v105, v105
    v_cvt_pk_bf16_f32 v76, v96, v97
    v_cvt_pk_bf16_f32 v77, v98, v99
    v_exp_f32 v106, v106
    v_exp_f32 v107, v107
    v_mfma_f32_16x16x32_bf16 v[40:43], v[32:35], v[84:87], v[40:43]
    v_exp_f32 v108, v108
    v_mfma_f32_32x32x16_bf16 v[144:159], v[64:67], v[88:91], v[144:159]
    buffer_load_dwordx4 v6, s[20:23], s37 offen offset:1024 lds
    v_exp_f32 v109, v109
    v_cvt_pk_bf16_f32 v78, v100, v101
    v_cvt_pk_bf16_f32 v79, v102, v103
    v_exp_f32 v110, v110
    v_exp_f32 v111, v111
    v_mfma_f32_16x16x32_bf16 v[40:43], v[32:35], v[88:91], v[40:43]
    v_cvt_pk_bf16_f32 v80, v104, v105
    v_cvt_pk_bf16_f32 v81, v106, v107
    v_cvt_pk_bf16_f32 v82, v108, v109
    v_cvt_pk_bf16_f32 v83, v110, v111
    s_waitcnt lgkmcnt(0)
    v_mfma_f32_32x32x16_bf16 v[96:111], v[44:47], v[16:19], v[160:175]
    v_exp_f32 v112, v112
    v_exp_f32 v113, v113
    v_exp_f32 v114, v114
    v_exp_f32 v115, v115
    v_mfma_f32_32x32x16_bf16 v[96:111], v[48:51], v[20:23], v[96:111]
    v_exp_f32 v116, v116
    v_exp_f32 v117, v117
    v_exp_f32 v118, v118
    v_exp_f32 v119, v119
    v_mfma_f32_32x32x16_bf16 v[128:143], v[68:71], v[76:79], v[128:143]
    v_exp_f32 v120, v120
    v_exp_f32 v121, v121
    v_cvt_pk_bf16_f32 v84, v112, v113
    v_cvt_pk_bf16_f32 v85, v114, v115
    v_exp_f32 v122, v122
    v_exp_f32 v123, v123
    v_mfma_f32_16x16x32_bf16 v[36:39], v[32:35], v[76:79], v[36:39]
    v_exp_f32 v124, v124
    v_mfma_f32_32x32x16_bf16 v[128:143], v[72:75], v[80:83], v[128:143]
    buffer_load_dword v205, v204, s[44:47], 0 offen
    v_exp_f32 v125, v125
    v_cvt_pk_bf16_f32 v86, v116, v117
    v_cvt_pk_bf16_f32 v87, v118, v119
    v_exp_f32 v126, v126
    v_exp_f32 v127, v127
    v_mfma_f32_16x16x32_bf16 v[36:39], v[32:35], v[80:83], v[36:39]
    v_cvt_pk_bf16_f32 v88, v120, v121
    v_cvt_pk_bf16_f32 v89, v122, v123
    v_cvt_pk_bf16_f32 v90, v124, v125
    v_cvt_pk_bf16_f32 v91, v126, v127
    v_mfma_f32_32x32x16_bf16 v[112:127], v[44:47], v[24:27], v[176:191]
    ds_read_b128 v[60:63], v4 offset:53248
    ds_read_b128 v[64:67], v5 offset:53248
    v_exp_f32 v96, v96
    v_exp_f32 v97, v97
    v_exp_f32 v98, v98
    v_exp_f32 v99, v99
    v_mfma_f32_32x32x16_bf16 v[112:127], v[48:51], v[28:31], v[112:127]
    ds_read_b128 v[52:55], v4 offset:38912
    ds_read_b128 v[56:59], v5 offset:38912
    v_exp_f32 v100, v100
    v_exp_f32 v101, v101
    v_exp_f32 v102, v102
    v_exp_f32 v103, v103
    v_mfma_f32_32x32x16_bf16 v[144:159], v[68:71], v[84:87], v[144:159]
    v_exp_f32 v104, v104
    v_exp_f32 v105, v105
    v_cvt_pk_bf16_f32 v76, v96, v97
    v_cvt_pk_bf16_f32 v77, v98, v99
    v_exp_f32 v106, v106
    v_exp_f32 v107, v107
    v_mfma_f32_16x16x32_bf16 v[40:43], v[32:35], v[84:87], v[40:43]
    v_exp_f32 v108, v108
    v_mfma_f32_32x32x16_bf16 v[144:159], v[72:75], v[88:91], v[144:159]
    v_exp_f32 v109, v109
    v_cvt_pk_bf16_f32 v78, v100, v101
    v_cvt_pk_bf16_f32 v79, v102, v103
    v_exp_f32 v110, v110
    v_exp_f32 v111, v111
    v_mfma_f32_16x16x32_bf16 v[40:43], v[32:35], v[88:91], v[40:43]
    v_cvt_pk_bf16_f32 v80, v104, v105
    v_cvt_pk_bf16_f32 v81, v106, v107
    v_cvt_pk_bf16_f32 v82, v108, v109
    v_cvt_pk_bf16_f32 v83, v110, v111
    s_waitcnt lgkmcnt(0)
    v_mfma_f32_32x32x16_bf16 v[96:111], v[52:55], v[16:19], v[160:175]
    v_exp_f32 v112, v112
    v_exp_f32 v113, v113
    v_exp_f32 v114, v114
    v_exp_f32 v115, v115
    v_mfma_f32_32x32x16_bf16 v[96:111], v[56:59], v[20:23], v[96:111]
    v_exp_f32 v116, v116
    v_exp_f32 v117, v117
    v_exp_f32 v118, v118
    v_exp_f32 v119, v119
    v_mfma_f32_32x32x16_bf16 v[128:143], v[60:63], v[76:79], v[128:143]
    v_exp_f32 v120, v120
    v_exp_f32 v121, v121
    v_cvt_pk_bf16_f32 v84, v112, v113
    v_cvt_pk_bf16_f32 v85, v114, v115
    v_exp_f32 v122, v122
    v_exp_f32 v123, v123
    v_mfma_f32_16x16x32_bf16 v[36:39], v[32:35], v[76:79], v[36:39]
    v_exp_f32 v124, v124
    v_mfma_f32_32x32x16_bf16 v[128:143], v[64:67], v[80:83], v[128:143]
    v_exp_f32 v125, v125
    v_cvt_pk_bf16_f32 v86, v116, v117
    v_cvt_pk_bf16_f32 v87, v118, v119
    v_exp_f32 v126, v126
    v_exp_f32 v127, v127
    v_mfma_f32_16x16x32_bf16 v[36:39], v[32:35], v[80:83], v[36:39]
    v_cvt_pk_bf16_f32 v88, v120, v121
    v_cvt_pk_bf16_f32 v89, v122, v123
    v_cvt_pk_bf16_f32 v90, v124, v125
    v_cvt_pk_bf16_f32 v91, v126, v127
    v_mfma_f32_32x32x16_bf16 v[112:127], v[52:55], v[24:27], v[176:191]
    ds_read_b128 v[68:71], v4 offset:55296
    ds_read_b128 v[72:75], v5 offset:55296
    v_exp_f32 v96, v96
    v_exp_f32 v97, v97
    v_exp_f32 v98, v98
    v_exp_f32 v99, v99
    v_mfma_f32_32x32x16_bf16 v[112:127], v[56:59], v[28:31], v[112:127]
    v_exp_f32 v100, v100
    v_exp_f32 v101, v101
    v_exp_f32 v102, v102
    v_exp_f32 v103, v103
    v_mfma_f32_32x32x16_bf16 v[144:159], v[60:63], v[84:87], v[144:159]
    s_waitcnt vmcnt(6) lgkmcnt(0)
    s_barrier
    ds_read_b128 v[44:47], v92 offset:0
    ds_read_b128 v[48:51], v93 offset:0
    v_exp_f32 v104, v104
    v_exp_f32 v105, v105
    v_cvt_pk_bf16_f32 v76, v96, v97
    v_cvt_pk_bf16_f32 v77, v98, v99
    v_exp_f32 v106, v106
    v_exp_f32 v107, v107
    v_mfma_f32_16x16x32_bf16 v[40:43], v[32:35], v[84:87], v[40:43]
    v_exp_f32 v108, v108
    v_mfma_f32_32x32x16_bf16 v[144:159], v[64:67], v[88:91], v[144:159]
    v_exp_f32 v109, v109
    v_cvt_pk_bf16_f32 v78, v100, v101
    v_cvt_pk_bf16_f32 v79, v102, v103
    v_exp_f32 v110, v110
    v_exp_f32 v111, v111
    v_mfma_f32_16x16x32_bf16 v[40:43], v[32:35], v[88:91], v[40:43]
    v_cvt_pk_bf16_f32 v80, v104, v105
    v_cvt_pk_bf16_f32 v81, v106, v107
    v_cvt_pk_bf16_f32 v82, v108, v109
    v_cvt_pk_bf16_f32 v83, v110, v111
    s_waitcnt lgkmcnt(0)
    v_mfma_f32_32x32x16_bf16 v[96:111], v[44:47], v[16:19], v[160:175]
    v_exp_f32 v112, v112
    v_exp_f32 v113, v113
    v_exp_f32 v114, v114
    v_exp_f32 v115, v115
    v_mfma_f32_32x32x16_bf16 v[96:111], v[48:51], v[20:23], v[96:111]
    v_exp_f32 v116, v116
    v_exp_f32 v117, v117
    v_exp_f32 v118, v118
    v_exp_f32 v119, v119
    v_mfma_f32_32x32x16_bf16 v[128:143], v[68:71], v[76:79], v[128:143]
    v_exp_f32 v120, v120
    v_exp_f32 v121, v121
    v_cvt_pk_bf16_f32 v84, v112, v113
    v_cvt_pk_bf16_f32 v85, v114, v115
    v_exp_f32 v122, v122
    v_exp_f32 v123, v123
    v_mfma_f32_16x16x32_bf16 v[36:39], v[32:35], v[76:79], v[36:39]
    v_exp_f32 v124, v124
    v_mfma_f32_32x32x16_bf16 v[128:143], v[72:75], v[80:83], v[128:143]
    s_add_u32 m0, s30, 32768
    s_add_u32 s37, s31, 114688
    buffer_load_dwordx4 v6, s[12:15], s37 offen lds
    v_exp_f32 v125, v125
    v_cvt_pk_bf16_f32 v86, v116, v117
    v_cvt_pk_bf16_f32 v87, v118, v119
    v_exp_f32 v126, v126
    v_exp_f32 v127, v127
    v_mfma_f32_16x16x32_bf16 v[36:39], v[32:35], v[80:83], v[36:39]
    v_cvt_pk_bf16_f32 v88, v120, v121
    v_cvt_pk_bf16_f32 v89, v122, v123
    v_cvt_pk_bf16_f32 v90, v124, v125
    v_cvt_pk_bf16_f32 v91, v126, v127
    v_mfma_f32_32x32x16_bf16 v[112:127], v[44:47], v[24:27], v[176:191]
    ds_read_b128 v[60:63], v92 offset:16384
    ds_read_b128 v[64:67], v93 offset:16384
    v_exp_f32 v96, v96
    v_exp_f32 v97, v97
    v_exp_f32 v98, v98
    v_exp_f32 v99, v99
    v_mfma_f32_32x32x16_bf16 v[112:127], v[48:51], v[28:31], v[112:127]
    ds_read_b128 v[52:55], v92 offset:2048
    ds_read_b128 v[56:59], v93 offset:2048
    v_exp_f32 v100, v100
    v_exp_f32 v101, v101
    v_exp_f32 v102, v102
    v_exp_f32 v103, v103
    v_mfma_f32_32x32x16_bf16 v[144:159], v[68:71], v[84:87], v[144:159]
    v_exp_f32 v104, v104
    v_exp_f32 v105, v105
    v_cvt_pk_bf16_f32 v76, v96, v97
    v_cvt_pk_bf16_f32 v77, v98, v99
    v_exp_f32 v106, v106
    v_exp_f32 v107, v107
    v_mfma_f32_16x16x32_bf16 v[40:43], v[32:35], v[84:87], v[40:43]
    v_exp_f32 v108, v108
    v_mfma_f32_32x32x16_bf16 v[144:159], v[72:75], v[88:91], v[144:159]
    buffer_load_dwordx4 v6, s[12:15], s37 offen offset:1024 lds
    v_exp_f32 v109, v109
    v_cvt_pk_bf16_f32 v78, v100, v101
    v_cvt_pk_bf16_f32 v79, v102, v103
    v_exp_f32 v110, v110
    v_exp_f32 v111, v111
    v_mfma_f32_16x16x32_bf16 v[40:43], v[32:35], v[88:91], v[40:43]
    v_cvt_pk_bf16_f32 v80, v104, v105
    v_cvt_pk_bf16_f32 v81, v106, v107
    v_cvt_pk_bf16_f32 v82, v108, v109
    v_cvt_pk_bf16_f32 v83, v110, v111
    s_waitcnt lgkmcnt(0)
    v_mfma_f32_32x32x16_bf16 v[96:111], v[52:55], v[16:19], v[160:175]
    v_exp_f32 v112, v112
    v_exp_f32 v113, v113
    v_exp_f32 v114, v114
    v_exp_f32 v115, v115
    v_mfma_f32_32x32x16_bf16 v[96:111], v[56:59], v[20:23], v[96:111]
    v_exp_f32 v116, v116
    v_exp_f32 v117, v117
    v_exp_f32 v118, v118
    v_exp_f32 v119, v119
    v_mfma_f32_32x32x16_bf16 v[128:143], v[60:63], v[76:79], v[128:143]
    v_exp_f32 v120, v120
    v_exp_f32 v121, v121
    v_cvt_pk_bf16_f32 v84, v112, v113
    v_cvt_pk_bf16_f32 v85, v114, v115
    v_exp_f32 v122, v122
    v_exp_f32 v123, v123
    v_mfma_f32_16x16x32_bf16 v[36:39], v[32:35], v[76:79], v[36:39]
    v_exp_f32 v124, v124
    v_mfma_f32_32x32x16_bf16 v[128:143], v[64:67], v[80:83], v[128:143]
    s_add_u32 m0, s30, 49152
    s_nop 0
    buffer_load_dwordx4 v6, s[20:23], s37 offen lds
    v_exp_f32 v125, v125
    v_cvt_pk_bf16_f32 v86, v116, v117
    v_cvt_pk_bf16_f32 v87, v118, v119
    v_exp_f32 v126, v126
    v_exp_f32 v127, v127
    v_mfma_f32_16x16x32_bf16 v[36:39], v[32:35], v[80:83], v[36:39]
    v_cvt_pk_bf16_f32 v88, v120, v121
    v_cvt_pk_bf16_f32 v89, v122, v123
    v_cvt_pk_bf16_f32 v90, v124, v125
    v_cvt_pk_bf16_f32 v91, v126, v127
    v_mfma_f32_32x32x16_bf16 v[112:127], v[52:55], v[24:27], v[176:191]
    ds_read_b128 v[68:71], v92 offset:18432
    ds_read_b128 v[72:75], v93 offset:18432
    v_exp_f32 v96, v96
    v_exp_f32 v97, v97
    v_exp_f32 v98, v98
    v_exp_f32 v99, v99
    v_mfma_f32_32x32x16_bf16 v[112:127], v[56:59], v[28:31], v[112:127]
    ds_read_b128 v[44:47], v92 offset:4096
    ds_read_b128 v[48:51], v93 offset:4096
    v_exp_f32 v100, v100
    v_exp_f32 v101, v101
    v_exp_f32 v102, v102
    v_exp_f32 v103, v103
    v_mfma_f32_32x32x16_bf16 v[144:159], v[60:63], v[84:87], v[144:159]
    v_exp_f32 v104, v104
    v_exp_f32 v105, v105
    v_cvt_pk_bf16_f32 v76, v96, v97
    v_cvt_pk_bf16_f32 v77, v98, v99
    v_exp_f32 v106, v106
    v_exp_f32 v107, v107
    v_mfma_f32_16x16x32_bf16 v[40:43], v[32:35], v[84:87], v[40:43]
    v_exp_f32 v108, v108
    v_mfma_f32_32x32x16_bf16 v[144:159], v[64:67], v[88:91], v[144:159]
    buffer_load_dwordx4 v6, s[20:23], s37 offen offset:1024 lds
    v_exp_f32 v109, v109
    v_cvt_pk_bf16_f32 v78, v100, v101
    v_cvt_pk_bf16_f32 v79, v102, v103
    v_exp_f32 v110, v110
    v_exp_f32 v111, v111
    v_mfma_f32_16x16x32_bf16 v[40:43], v[32:35], v[88:91], v[40:43]
    v_cvt_pk_bf16_f32 v80, v104, v105
    v_cvt_pk_bf16_f32 v81, v106, v107
    v_cvt_pk_bf16_f32 v82, v108, v109
    v_cvt_pk_bf16_f32 v83, v110, v111
    s_waitcnt lgkmcnt(0)
    v_mfma_f32_32x32x16_bf16 v[96:111], v[44:47], v[16:19], v[160:175]
    v_exp_f32 v112, v112
    v_exp_f32 v113, v113
    v_exp_f32 v114, v114
    v_exp_f32 v115, v115
    v_mfma_f32_32x32x16_bf16 v[96:111], v[48:51], v[20:23], v[96:111]
    v_exp_f32 v116, v116
    v_exp_f32 v117, v117
    v_exp_f32 v118, v118
    v_exp_f32 v119, v119
    v_mfma_f32_32x32x16_bf16 v[128:143], v[68:71], v[76:79], v[128:143]
    v_exp_f32 v120, v120
    v_exp_f32 v121, v121
    v_cvt_pk_bf16_f32 v84, v112, v113
    v_cvt_pk_bf16_f32 v85, v114, v115
    v_exp_f32 v122, v122
    v_exp_f32 v123, v123
    v_mfma_f32_16x16x32_bf16 v[36:39], v[32:35], v[76:79], v[36:39]
    v_exp_f32 v124, v124
    v_mfma_f32_32x32x16_bf16 v[128:143], v[72:75], v[80:83], v[128:143]
    buffer_load_dword v205, v204, s[48:51], 0 offen
    v_exp_f32 v125, v125
    v_cvt_pk_bf16_f32 v86, v116, v117
    v_cvt_pk_bf16_f32 v87, v118, v119
    v_exp_f32 v126, v126
    v_exp_f32 v127, v127
    v_mfma_f32_16x16x32_bf16 v[36:39], v[32:35], v[80:83], v[36:39]
    v_cvt_pk_bf16_f32 v88, v120, v121
    v_cvt_pk_bf16_f32 v89, v122, v123
    v_cvt_pk_bf16_f32 v90, v124, v125
    v_cvt_pk_bf16_f32 v91, v126, v127
    v_mfma_f32_32x32x16_bf16 v[112:127], v[44:47], v[24:27], v[176:191]
    ds_read_b128 v[60:63], v92 offset:20480
    ds_read_b128 v[64:67], v93 offset:20480
    v_exp_f32 v96, v96
    v_exp_f32 v97, v97
    v_exp_f32 v98, v98
    v_exp_f32 v99, v99
    v_mfma_f32_32x32x16_bf16 v[112:127], v[48:51], v[28:31], v[112:127]
    ds_read_b128 v[52:55], v92 offset:6144
    ds_read_b128 v[56:59], v93 offset:6144
    v_exp_f32 v100, v100
    v_exp_f32 v101, v101
    v_exp_f32 v102, v102
    v_exp_f32 v103, v103
    v_mfma_f32_32x32x16_bf16 v[144:159], v[68:71], v[84:87], v[144:159]
    v_exp_f32 v104, v104
    v_exp_f32 v105, v105
    v_cvt_pk_bf16_f32 v76, v96, v97
    v_cvt_pk_bf16_f32 v77, v98, v99
    v_exp_f32 v106, v106
    v_exp_f32 v107, v107
    v_mfma_f32_16x16x32_bf16 v[40:43], v[32:35], v[84:87], v[40:43]
    v_exp_f32 v108, v108
    v_mfma_f32_32x32x16_bf16 v[144:159], v[72:75], v[88:91], v[144:159]
    v_exp_f32 v109, v109
    v_cvt_pk_bf16_f32 v78, v100, v101
    v_cvt_pk_bf16_f32 v79, v102, v103
    v_exp_f32 v110, v110
    v_exp_f32 v111, v111
    v_mfma_f32_16x16x32_bf16 v[40:43], v[32:35], v[88:91], v[40:43]
    v_cvt_pk_bf16_f32 v80, v104, v105
    v_cvt_pk_bf16_f32 v81, v106, v107
    v_cvt_pk_bf16_f32 v82, v108, v109
    v_cvt_pk_bf16_f32 v83, v110, v111
    s_waitcnt lgkmcnt(0)
    v_mfma_f32_32x32x16_bf16 v[96:111], v[52:55], v[16:19], v[160:175]
    v_exp_f32 v112, v112
    v_exp_f32 v113, v113
    v_exp_f32 v114, v114
    v_exp_f32 v115, v115
    v_mfma_f32_32x32x16_bf16 v[96:111], v[56:59], v[20:23], v[96:111]
    v_exp_f32 v116, v116
    v_exp_f32 v117, v117
    v_exp_f32 v118, v118
    v_exp_f32 v119, v119
    v_mfma_f32_32x32x16_bf16 v[128:143], v[60:63], v[76:79], v[128:143]
    v_exp_f32 v120, v120
    v_exp_f32 v121, v121
    v_cvt_pk_bf16_f32 v84, v112, v113
    v_cvt_pk_bf16_f32 v85, v114, v115
    v_exp_f32 v122, v122
    v_exp_f32 v123, v123
    v_mfma_f32_16x16x32_bf16 v[36:39], v[32:35], v[76:79], v[36:39]
    v_exp_f32 v124, v124
    v_mfma_f32_32x32x16_bf16 v[128:143], v[64:67], v[80:83], v[128:143]
    v_exp_f32 v125, v125
    v_cvt_pk_bf16_f32 v86, v116, v117
    v_cvt_pk_bf16_f32 v87, v118, v119
    v_exp_f32 v126, v126
    v_exp_f32 v127, v127
    v_mfma_f32_16x16x32_bf16 v[36:39], v[32:35], v[80:83], v[36:39]
    v_cvt_pk_bf16_f32 v88, v120, v121
    v_cvt_pk_bf16_f32 v89, v122, v123
    v_cvt_pk_bf16_f32 v90, v124, v125
    v_cvt_pk_bf16_f32 v91, v126, v127
    v_mfma_f32_32x32x16_bf16 v[112:127], v[52:55], v[24:27], v[176:191]
    ds_read_b128 v[68:71], v92 offset:22528
    ds_read_b128 v[72:75], v93 offset:22528
    v_exp_f32 v96, v96
    v_exp_f32 v97, v97
    v_exp_f32 v98, v98
    v_exp_f32 v99, v99
    v_mfma_f32_32x32x16_bf16 v[112:127], v[56:59], v[28:31], v[112:127]
    v_exp_f32 v100, v100
    v_exp_f32 v101, v101
    v_exp_f32 v102, v102
    v_exp_f32 v103, v103
    v_mfma_f32_32x32x16_bf16 v[144:159], v[60:63], v[84:87], v[144:159]
    s_waitcnt vmcnt(6) lgkmcnt(0)
    s_barrier
    ds_read_b128 v[44:47], v4 offset:0
    ds_read_b128 v[48:51], v5 offset:0
    v_exp_f32 v104, v104
    v_exp_f32 v105, v105
    v_cvt_pk_bf16_f32 v76, v96, v97
    v_cvt_pk_bf16_f32 v77, v98, v99
    v_exp_f32 v106, v106
    v_exp_f32 v107, v107
    v_mfma_f32_16x16x32_bf16 v[40:43], v[32:35], v[84:87], v[40:43]
    v_exp_f32 v108, v108
    v_mfma_f32_32x32x16_bf16 v[144:159], v[64:67], v[88:91], v[144:159]
    v_exp_f32 v109, v109
    v_cvt_pk_bf16_f32 v78, v100, v101
    v_cvt_pk_bf16_f32 v79, v102, v103
    v_exp_f32 v110, v110
    v_exp_f32 v111, v111
    v_mfma_f32_16x16x32_bf16 v[40:43], v[32:35], v[88:91], v[40:43]
    v_cvt_pk_bf16_f32 v80, v104, v105
    v_cvt_pk_bf16_f32 v81, v106, v107
    v_cvt_pk_bf16_f32 v82, v108, v109
    v_cvt_pk_bf16_f32 v83, v110, v111
    s_waitcnt lgkmcnt(0)
    v_mfma_f32_32x32x16_bf16 v[96:111], v[44:47], v[16:19], v[160:175]
    v_exp_f32 v112, v112
    v_exp_f32 v113, v113
    v_exp_f32 v114, v114
    v_exp_f32 v115, v115
    v_mfma_f32_32x32x16_bf16 v[96:111], v[48:51], v[20:23], v[96:111]
    v_exp_f32 v116, v116
    v_exp_f32 v117, v117
    v_exp_f32 v118, v118
    v_exp_f32 v119, v119
    v_mfma_f32_32x32x16_bf16 v[128:143], v[68:71], v[76:79], v[128:143]
    v_exp_f32 v120, v120
    v_exp_f32 v121, v121
    v_cvt_pk_bf16_f32 v84, v112, v113
    v_cvt_pk_bf16_f32 v85, v114, v115
    v_exp_f32 v122, v122
    v_exp_f32 v123, v123
    v_mfma_f32_16x16x32_bf16 v[36:39], v[32:35], v[76:79], v[36:39]
    v_exp_f32 v124, v124
    v_mfma_f32_32x32x16_bf16 v[128:143], v[72:75], v[80:83], v[128:143]
    buffer_load_dword v205, v207, s[56:59], 0 offen
    v_exp_f32 v125, v125
    v_cvt_pk_bf16_f32 v86, v116, v117
    v_cvt_pk_bf16_f32 v87, v118, v119
    v_exp_f32 v126, v126
    v_exp_f32 v127, v127
    v_mfma_f32_16x16x32_bf16 v[36:39], v[32:35], v[80:83], v[36:39]
    v_cvt_pk_bf16_f32 v88, v120, v121
    v_cvt_pk_bf16_f32 v89, v122, v123
    v_cvt_pk_bf16_f32 v90, v124, v125
    v_cvt_pk_bf16_f32 v91, v126, v127
    v_mfma_f32_32x32x16_bf16 v[112:127], v[44:47], v[24:27], v[176:191]
    ds_read_b128 v[60:63], v4 offset:16384
    ds_read_b128 v[64:67], v5 offset:16384
    v_exp_f32 v96, v96
    v_exp_f32 v97, v97
    v_exp_f32 v98, v98
    v_exp_f32 v99, v99
    v_mfma_f32_32x32x16_bf16 v[112:127], v[48:51], v[28:31], v[112:127]
    ds_read_b128 v[52:55], v4 offset:2048
    ds_read_b128 v[56:59], v5 offset:2048
    v_exp_f32 v100, v100
    v_exp_f32 v101, v101
    v_exp_f32 v102, v102
    v_exp_f32 v103, v103
    v_mfma_f32_32x32x16_bf16 v[144:159], v[68:71], v[84:87], v[144:159]
    v_exp_f32 v104, v104
    v_exp_f32 v105, v105
    v_cvt_pk_bf16_f32 v76, v96, v97
    v_cvt_pk_bf16_f32 v77, v98, v99
    v_exp_f32 v106, v106
    v_exp_f32 v107, v107
    v_mfma_f32_16x16x32_bf16 v[40:43], v[32:35], v[84:87], v[40:43]
    v_exp_f32 v108, v108
    v_mfma_f32_32x32x16_bf16 v[144:159], v[72:75], v[88:91], v[144:159]
    v_exp_f32 v109, v109
    v_cvt_pk_bf16_f32 v78, v100, v101
    v_cvt_pk_bf16_f32 v79, v102, v103
    v_exp_f32 v110, v110
    v_exp_f32 v111, v111
    v_mfma_f32_16x16x32_bf16 v[40:43], v[32:35], v[88:91], v[40:43]
    v_cvt_pk_bf16_f32 v80, v104, v105
    v_cvt_pk_bf16_f32 v81, v106, v107
    v_cvt_pk_bf16_f32 v82, v108, v109
    v_cvt_pk_bf16_f32 v83, v110, v111
    s_waitcnt lgkmcnt(0)
    v_mfma_f32_32x32x16_bf16 v[96:111], v[52:55], v[16:19], v[160:175]
    v_exp_f32 v112, v112
    v_exp_f32 v113, v113
    v_exp_f32 v114, v114
    v_exp_f32 v115, v115
    v_mfma_f32_32x32x16_bf16 v[96:111], v[56:59], v[20:23], v[96:111]
    v_exp_f32 v116, v116
    v_exp_f32 v117, v117
    v_exp_f32 v118, v118
    v_exp_f32 v119, v119
    v_mfma_f32_32x32x16_bf16 v[128:143], v[60:63], v[76:79], v[128:143]
    v_exp_f32 v120, v120
    v_exp_f32 v121, v121
    v_cvt_pk_bf16_f32 v84, v112, v113
    v_cvt_pk_bf16_f32 v85, v114, v115
    v_exp_f32 v122, v122
    v_exp_f32 v123, v123
    v_mfma_f32_16x16x32_bf16 v[36:39], v[32:35], v[76:79], v[36:39]
    v_exp_f32 v124, v124
    v_mfma_f32_32x32x16_bf16 v[128:143], v[64:67], v[80:83], v[128:143]
    v_exp_f32 v125, v125
    v_cvt_pk_bf16_f32 v86, v116, v117
    v_cvt_pk_bf16_f32 v87, v118, v119
    v_exp_f32 v126, v126
    v_exp_f32 v127, v127
    v_mfma_f32_16x16x32_bf16 v[36:39], v[32:35], v[80:83], v[36:39]
    v_cvt_pk_bf16_f32 v88, v120, v121
    v_cvt_pk_bf16_f32 v89, v122, v123
    v_cvt_pk_bf16_f32 v90, v124, v125
    v_cvt_pk_bf16_f32 v91, v126, v127
    v_mfma_f32_32x32x16_bf16 v[112:127], v[52:55], v[24:27], v[176:191]
    ds_read_b128 v[68:71], v4 offset:18432
    ds_read_b128 v[72:75], v5 offset:18432
    v_exp_f32 v96, v96
    v_exp_f32 v97, v97
    v_exp_f32 v98, v98
    v_exp_f32 v99, v99
    v_mfma_f32_32x32x16_bf16 v[112:127], v[56:59], v[28:31], v[112:127]
    ds_read_b128 v[44:47], v4 offset:4096
    ds_read_b128 v[48:51], v5 offset:4096
    v_exp_f32 v100, v100
    v_exp_f32 v101, v101
    v_exp_f32 v102, v102
    v_exp_f32 v103, v103
    v_mfma_f32_32x32x16_bf16 v[144:159], v[60:63], v[84:87], v[144:159]
    v_exp_f32 v104, v104
    v_exp_f32 v105, v105
    v_cvt_pk_bf16_f32 v76, v96, v97
    v_cvt_pk_bf16_f32 v77, v98, v99
    v_exp_f32 v106, v106
    v_exp_f32 v107, v107
    v_mfma_f32_16x16x32_bf16 v[40:43], v[32:35], v[84:87], v[40:43]
    v_exp_f32 v108, v108
    v_mfma_f32_32x32x16_bf16 v[144:159], v[64:67], v[88:91], v[144:159]
    v_exp_f32 v109, v109
    v_cvt_pk_bf16_f32 v78, v100, v101
    v_cvt_pk_bf16_f32 v79, v102, v103
    v_exp_f32 v110, v110
    v_exp_f32 v111, v111
    v_mfma_f32_16x16x32_bf16 v[40:43], v[32:35], v[88:91], v[40:43]
    v_cvt_pk_bf16_f32 v80, v104, v105
    v_cvt_pk_bf16_f32 v81, v106, v107
    v_cvt_pk_bf16_f32 v82, v108, v109
    v_cvt_pk_bf16_f32 v83, v110, v111
    s_waitcnt lgkmcnt(0)
    v_mfma_f32_32x32x16_bf16 v[96:111], v[44:47], v[16:19], v[160:175]
    v_exp_f32 v112, v112
    v_exp_f32 v113, v113
    v_exp_f32 v114, v114
    v_exp_f32 v115, v115
    v_mfma_f32_32x32x16_bf16 v[96:111], v[48:51], v[20:23], v[96:111]
    v_exp_f32 v116, v116
    v_exp_f32 v117, v117
    v_exp_f32 v118, v118
    v_exp_f32 v119, v119
    v_mfma_f32_32x32x16_bf16 v[128:143], v[68:71], v[76:79], v[128:143]
    v_exp_f32 v120, v120
    v_exp_f32 v121, v121
    v_cvt_pk_bf16_f32 v84, v112, v113
    v_cvt_pk_bf16_f32 v85, v114, v115
    v_exp_f32 v122, v122
    v_exp_f32 v123, v123
    v_mfma_f32_16x16x32_bf16 v[36:39], v[32:35], v[76:79], v[36:39]
    v_exp_f32 v124, v124
    v_mfma_f32_32x32x16_bf16 v[128:143], v[72:75], v[80:83], v[128:143]
    v_exp_f32 v125, v125
    v_cvt_pk_bf16_f32 v86, v116, v117
    v_cvt_pk_bf16_f32 v87, v118, v119
    v_exp_f32 v126, v126
    v_exp_f32 v127, v127
    v_mfma_f32_16x16x32_bf16 v[36:39], v[32:35], v[80:83], v[36:39]
    v_cvt_pk_bf16_f32 v88, v120, v121
    v_cvt_pk_bf16_f32 v89, v122, v123
    v_cvt_pk_bf16_f32 v90, v124, v125
    v_cvt_pk_bf16_f32 v91, v126, v127
    v_mfma_f32_32x32x16_bf16 v[112:127], v[44:47], v[24:27], v[176:191]
    ds_read_b128 v[60:63], v4 offset:20480
    ds_read_b128 v[64:67], v5 offset:20480
    v_exp_f32 v96, v96
    v_exp_f32 v97, v97
    v_exp_f32 v98, v98
    v_exp_f32 v99, v99
    v_mfma_f32_32x32x16_bf16 v[112:127], v[48:51], v[28:31], v[112:127]
    ds_read_b128 v[52:55], v4 offset:6144
    ds_read_b128 v[56:59], v5 offset:6144
    v_exp_f32 v100, v100
    v_exp_f32 v101, v101
    v_exp_f32 v102, v102
    v_exp_f32 v103, v103
    v_mfma_f32_32x32x16_bf16 v[144:159], v[68:71], v[84:87], v[144:159]
    v_exp_f32 v104, v104
    v_exp_f32 v105, v105
    v_cvt_pk_bf16_f32 v76, v96, v97
    v_cvt_pk_bf16_f32 v77, v98, v99
    v_exp_f32 v106, v106
    v_exp_f32 v107, v107
    v_mfma_f32_16x16x32_bf16 v[40:43], v[32:35], v[84:87], v[40:43]
    v_exp_f32 v108, v108
    v_mfma_f32_32x32x16_bf16 v[144:159], v[72:75], v[88:91], v[144:159]
    v_exp_f32 v109, v109
    v_cvt_pk_bf16_f32 v78, v100, v101
    v_cvt_pk_bf16_f32 v79, v102, v103
    v_exp_f32 v110, v110
    v_exp_f32 v111, v111
    v_mfma_f32_16x16x32_bf16 v[40:43], v[32:35], v[88:91], v[40:43]
    v_cvt_pk_bf16_f32 v80, v104, v105
    v_cvt_pk_bf16_f32 v81, v106, v107
    v_cvt_pk_bf16_f32 v82, v108, v109
    v_cvt_pk_bf16_f32 v83, v110, v111
    s_waitcnt lgkmcnt(0)
    v_mfma_f32_32x32x16_bf16 v[96:111], v[52:55], v[16:19], v[160:175]
    v_exp_f32 v112, v112
    v_exp_f32 v113, v113
    v_exp_f32 v114, v114
    v_exp_f32 v115, v115
    v_mfma_f32_32x32x16_bf16 v[96:111], v[56:59], v[20:23], v[96:111]
    v_exp_f32 v116, v116
    v_exp_f32 v117, v117
    v_exp_f32 v118, v118
    v_exp_f32 v119, v119
    v_mfma_f32_32x32x16_bf16 v[128:143], v[60:63], v[76:79], v[128:143]
    v_exp_f32 v120, v120
    v_exp_f32 v121, v121
    v_cvt_pk_bf16_f32 v84, v112, v113
    v_cvt_pk_bf16_f32 v85, v114, v115
    v_exp_f32 v122, v122
    v_exp_f32 v123, v123
    v_mfma_f32_16x16x32_bf16 v[36:39], v[32:35], v[76:79], v[36:39]
    v_exp_f32 v124, v124
    v_mfma_f32_32x32x16_bf16 v[128:143], v[64:67], v[80:83], v[128:143]
    v_exp_f32 v125, v125
    v_cvt_pk_bf16_f32 v86, v116, v117
    v_cvt_pk_bf16_f32 v87, v118, v119
    v_exp_f32 v126, v126
    v_exp_f32 v127, v127
    v_mfma_f32_16x16x32_bf16 v[36:39], v[32:35], v[80:83], v[36:39]
    v_cvt_pk_bf16_f32 v88, v120, v121
    v_cvt_pk_bf16_f32 v89, v122, v123
    v_cvt_pk_bf16_f32 v90, v124, v125
    v_cvt_pk_bf16_f32 v91, v126, v127
    v_mfma_f32_32x32x16_bf16 v[112:127], v[52:55], v[24:27], v[176:191]
    ds_read_b128 v[68:71], v4 offset:22528
    ds_read_b128 v[72:75], v5 offset:22528
    v_exp_f32 v96, v96
    v_exp_f32 v97, v97
    v_exp_f32 v98, v98
    v_exp_f32 v99, v99
    v_mfma_f32_32x32x16_bf16 v[112:127], v[56:59], v[28:31], v[112:127]
    v_exp_f32 v100, v100
    v_exp_f32 v101, v101
    v_exp_f32 v102, v102
    v_exp_f32 v103, v103
    v_mfma_f32_32x32x16_bf16 v[144:159], v[60:63], v[84:87], v[144:159]
    s_waitcnt vmcnt(2) lgkmcnt(0)
    s_barrier
    ds_read_b128 v[44:47], v4 offset:32768
    ds_read_b128 v[48:51], v5 offset:32768
    v_exp_f32 v104, v104
    v_exp_f32 v105, v105
    v_cvt_pk_bf16_f32 v76, v96, v97
    v_cvt_pk_bf16_f32 v77, v98, v99
    v_exp_f32 v106, v106
    v_exp_f32 v107, v107
    v_mfma_f32_16x16x32_bf16 v[40:43], v[32:35], v[84:87], v[40:43]
    v_exp_f32 v108, v108
    v_mfma_f32_32x32x16_bf16 v[144:159], v[64:67], v[88:91], v[144:159]
    v_exp_f32 v109, v109
    v_cvt_pk_bf16_f32 v78, v100, v101
    v_cvt_pk_bf16_f32 v79, v102, v103
    v_exp_f32 v110, v110
    v_exp_f32 v111, v111
    v_mfma_f32_16x16x32_bf16 v[40:43], v[32:35], v[88:91], v[40:43]
    v_cvt_pk_bf16_f32 v80, v104, v105
    v_cvt_pk_bf16_f32 v81, v106, v107
    v_cvt_pk_bf16_f32 v82, v108, v109
    v_cvt_pk_bf16_f32 v83, v110, v111
    s_waitcnt lgkmcnt(0)
    v_mfma_f32_32x32x16_bf16 v[96:111], v[44:47], v[16:19], v[160:175]
    v_exp_f32 v112, v112
    v_exp_f32 v113, v113
    v_exp_f32 v114, v114
    v_exp_f32 v115, v115
    v_mfma_f32_32x32x16_bf16 v[96:111], v[48:51], v[20:23], v[96:111]
    v_exp_f32 v116, v116
    v_exp_f32 v117, v117
    v_exp_f32 v118, v118
    v_exp_f32 v119, v119
    v_mfma_f32_32x32x16_bf16 v[128:143], v[68:71], v[76:79], v[128:143]
    v_exp_f32 v120, v120
    v_exp_f32 v121, v121
    v_cvt_pk_bf16_f32 v84, v112, v113
    v_cvt_pk_bf16_f32 v85, v114, v115
    v_exp_f32 v122, v122
    v_exp_f32 v123, v123
    v_mfma_f32_16x16x32_bf16 v[36:39], v[32:35], v[76:79], v[36:39]
    v_exp_f32 v124, v124
    v_mfma_f32_32x32x16_bf16 v[128:143], v[72:75], v[80:83], v[128:143]
    buffer_load_dword v205, v208, s[60:63], 0 offen
    v_exp_f32 v125, v125
    v_cvt_pk_bf16_f32 v86, v116, v117
    v_cvt_pk_bf16_f32 v87, v118, v119
    v_exp_f32 v126, v126
    v_exp_f32 v127, v127
    v_mfma_f32_16x16x32_bf16 v[36:39], v[32:35], v[80:83], v[36:39]
    v_cvt_pk_bf16_f32 v88, v120, v121
    v_cvt_pk_bf16_f32 v89, v122, v123
    v_cvt_pk_bf16_f32 v90, v124, v125
    v_cvt_pk_bf16_f32 v91, v126, v127
    v_mfma_f32_32x32x16_bf16 v[112:127], v[44:47], v[24:27], v[176:191]
    ds_read_b128 v[60:63], v4 offset:49152
    ds_read_b128 v[64:67], v5 offset:49152
    v_exp_f32 v96, v96
    v_exp_f32 v97, v97
    v_exp_f32 v98, v98
    v_exp_f32 v99, v99
    v_mfma_f32_32x32x16_bf16 v[112:127], v[48:51], v[28:31], v[112:127]
    ds_read_b128 v[52:55], v4 offset:34816
    ds_read_b128 v[56:59], v5 offset:34816
    v_exp_f32 v100, v100
    v_exp_f32 v101, v101
    v_exp_f32 v102, v102
    v_exp_f32 v103, v103
    v_mfma_f32_32x32x16_bf16 v[144:159], v[68:71], v[84:87], v[144:159]
    v_exp_f32 v104, v104
    v_exp_f32 v105, v105
    v_cvt_pk_bf16_f32 v76, v96, v97
    v_cvt_pk_bf16_f32 v77, v98, v99
    v_exp_f32 v106, v106
    v_exp_f32 v107, v107
    v_mfma_f32_16x16x32_bf16 v[40:43], v[32:35], v[84:87], v[40:43]
    v_exp_f32 v108, v108
    v_mfma_f32_32x32x16_bf16 v[144:159], v[72:75], v[88:91], v[144:159]
    v_exp_f32 v109, v109
    v_cvt_pk_bf16_f32 v78, v100, v101
    v_cvt_pk_bf16_f32 v79, v102, v103
    v_exp_f32 v110, v110
    v_exp_f32 v111, v111
    v_mfma_f32_16x16x32_bf16 v[40:43], v[32:35], v[88:91], v[40:43]
    v_cvt_pk_bf16_f32 v80, v104, v105
    v_cvt_pk_bf16_f32 v81, v106, v107
    v_cvt_pk_bf16_f32 v82, v108, v109
    v_cvt_pk_bf16_f32 v83, v110, v111
    s_waitcnt lgkmcnt(0)
    v_mfma_f32_32x32x16_bf16 v[96:111], v[52:55], v[16:19], v[160:175]
    v_exp_f32 v112, v112
    v_exp_f32 v113, v113
    v_exp_f32 v114, v114
    v_exp_f32 v115, v115
    v_mfma_f32_32x32x16_bf16 v[96:111], v[56:59], v[20:23], v[96:111]
    v_exp_f32 v116, v116
    v_exp_f32 v117, v117
    v_exp_f32 v118, v118
    v_exp_f32 v119, v119
    v_mfma_f32_32x32x16_bf16 v[128:143], v[60:63], v[76:79], v[128:143]
    v_exp_f32 v120, v120
    v_exp_f32 v121, v121
    v_cvt_pk_bf16_f32 v84, v112, v113
    v_cvt_pk_bf16_f32 v85, v114, v115
    v_exp_f32 v122, v122
    v_exp_f32 v123, v123
    v_mfma_f32_16x16x32_bf16 v[36:39], v[32:35], v[76:79], v[36:39]
    v_exp_f32 v124, v124
    v_mfma_f32_32x32x16_bf16 v[128:143], v[64:67], v[80:83], v[128:143]
    v_exp_f32 v125, v125
    v_cvt_pk_bf16_f32 v86, v116, v117
    v_cvt_pk_bf16_f32 v87, v118, v119
    v_exp_f32 v126, v126
    v_exp_f32 v127, v127
    v_mfma_f32_16x16x32_bf16 v[36:39], v[32:35], v[80:83], v[36:39]
    v_cvt_pk_bf16_f32 v88, v120, v121
    v_cvt_pk_bf16_f32 v89, v122, v123
    v_cvt_pk_bf16_f32 v90, v124, v125
    v_cvt_pk_bf16_f32 v91, v126, v127
    v_mfma_f32_32x32x16_bf16 v[112:127], v[52:55], v[24:27], v[176:191]
    ds_read_b128 v[68:71], v4 offset:51200
    ds_read_b128 v[72:75], v5 offset:51200
    v_exp_f32 v96, v96
    v_exp_f32 v97, v97
    v_exp_f32 v98, v98
    v_exp_f32 v99, v99
    v_mfma_f32_32x32x16_bf16 v[112:127], v[56:59], v[28:31], v[112:127]
    ds_read_b128 v[44:47], v4 offset:36864
    ds_read_b128 v[48:51], v5 offset:36864
    v_exp_f32 v100, v100
    v_exp_f32 v101, v101
    v_exp_f32 v102, v102
    v_exp_f32 v103, v103
    v_mfma_f32_32x32x16_bf16 v[144:159], v[60:63], v[84:87], v[144:159]
    v_exp_f32 v104, v104
    v_exp_f32 v105, v105
    v_cvt_pk_bf16_f32 v76, v96, v97
    v_cvt_pk_bf16_f32 v77, v98, v99
    v_exp_f32 v106, v106
    v_exp_f32 v107, v107
    v_mfma_f32_16x16x32_bf16 v[40:43], v[32:35], v[84:87], v[40:43]
    v_exp_f32 v108, v108
    v_mfma_f32_32x32x16_bf16 v[144:159], v[64:67], v[88:91], v[144:159]
    v_exp_f32 v109, v109
    v_cvt_pk_bf16_f32 v78, v100, v101
    v_cvt_pk_bf16_f32 v79, v102, v103
    v_exp_f32 v110, v110
    v_exp_f32 v111, v111
    v_mfma_f32_16x16x32_bf16 v[40:43], v[32:35], v[88:91], v[40:43]
    v_cvt_pk_bf16_f32 v80, v104, v105
    v_cvt_pk_bf16_f32 v81, v106, v107
    v_cvt_pk_bf16_f32 v82, v108, v109
    v_cvt_pk_bf16_f32 v83, v110, v111
    s_waitcnt lgkmcnt(0)
    v_mfma_f32_32x32x16_bf16 v[96:111], v[44:47], v[16:19], v[160:175]
    v_exp_f32 v112, v112
    v_exp_f32 v113, v113
    v_exp_f32 v114, v114
    v_exp_f32 v115, v115
    v_mfma_f32_32x32x16_bf16 v[96:111], v[48:51], v[20:23], v[96:111]
    v_exp_f32 v116, v116
    v_exp_f32 v117, v117
    v_exp_f32 v118, v118
    v_exp_f32 v119, v119
    v_mfma_f32_32x32x16_bf16 v[128:143], v[68:71], v[76:79], v[128:143]
    v_exp_f32 v120, v120
    v_exp_f32 v121, v121
    v_cvt_pk_bf16_f32 v84, v112, v113
    v_cvt_pk_bf16_f32 v85, v114, v115
    v_exp_f32 v122, v122
    v_exp_f32 v123, v123
    v_mfma_f32_16x16x32_bf16 v[36:39], v[32:35], v[76:79], v[36:39]
    v_exp_f32 v124, v124
    v_mfma_f32_32x32x16_bf16 v[128:143], v[72:75], v[80:83], v[128:143]
    v_exp_f32 v125, v125
    v_cvt_pk_bf16_f32 v86, v116, v117
    v_cvt_pk_bf16_f32 v87, v118, v119
    v_exp_f32 v126, v126
    v_exp_f32 v127, v127
    v_mfma_f32_16x16x32_bf16 v[36:39], v[32:35], v[80:83], v[36:39]
    v_cvt_pk_bf16_f32 v88, v120, v121
    v_cvt_pk_bf16_f32 v89, v122, v123
    v_cvt_pk_bf16_f32 v90, v124, v125
    v_cvt_pk_bf16_f32 v91, v126, v127
    v_mfma_f32_32x32x16_bf16 v[112:127], v[44:47], v[24:27], v[176:191]
    ds_read_b128 v[60:63], v4 offset:53248
    ds_read_b128 v[64:67], v5 offset:53248
    v_exp_f32 v96, v96
    v_exp_f32 v97, v97
    v_exp_f32 v98, v98
    v_exp_f32 v99, v99
    v_mfma_f32_32x32x16_bf16 v[112:127], v[48:51], v[28:31], v[112:127]
    ds_read_b128 v[52:55], v4 offset:38912
    ds_read_b128 v[56:59], v5 offset:38912
    v_exp_f32 v100, v100
    v_exp_f32 v101, v101
    v_exp_f32 v102, v102
    v_exp_f32 v103, v103
    v_mfma_f32_32x32x16_bf16 v[144:159], v[68:71], v[84:87], v[144:159]
    v_exp_f32 v104, v104
    v_exp_f32 v105, v105
    v_cvt_pk_bf16_f32 v76, v96, v97
    v_cvt_pk_bf16_f32 v77, v98, v99
    v_exp_f32 v106, v106
    v_exp_f32 v107, v107
    v_mfma_f32_16x16x32_bf16 v[40:43], v[32:35], v[84:87], v[40:43]
    v_exp_f32 v108, v108
    v_mfma_f32_32x32x16_bf16 v[144:159], v[72:75], v[88:91], v[144:159]
    v_exp_f32 v109, v109
    v_cvt_pk_bf16_f32 v78, v100, v101
    v_cvt_pk_bf16_f32 v79, v102, v103
    v_exp_f32 v110, v110
    v_exp_f32 v111, v111
    v_mfma_f32_16x16x32_bf16 v[40:43], v[32:35], v[88:91], v[40:43]
    v_cvt_pk_bf16_f32 v80, v104, v105
    v_cvt_pk_bf16_f32 v81, v106, v107
    v_cvt_pk_bf16_f32 v82, v108, v109
    v_cvt_pk_bf16_f32 v83, v110, v111
    s_waitcnt lgkmcnt(0)
    v_mfma_f32_32x32x16_bf16 v[96:111], v[52:55], v[16:19], v[160:175]
    v_exp_f32 v112, v112
    v_exp_f32 v113, v113
    v_exp_f32 v114, v114
    v_exp_f32 v115, v115
    v_mfma_f32_32x32x16_bf16 v[96:111], v[56:59], v[20:23], v[96:111]
    v_exp_f32 v116, v116
    v_exp_f32 v117, v117
    v_exp_f32 v118, v118
    v_exp_f32 v119, v119
    v_mfma_f32_32x32x16_bf16 v[128:143], v[60:63], v[76:79], v[128:143]
    v_exp_f32 v120, v120
    v_exp_f32 v121, v121
    v_cvt_pk_bf16_f32 v84, v112, v113
    v_cvt_pk_bf16_f32 v85, v114, v115
    v_exp_f32 v122, v122
    v_exp_f32 v123, v123
    v_mfma_f32_16x16x32_bf16 v[36:39], v[32:35], v[76:79], v[36:39]
    v_exp_f32 v124, v124
    v_mfma_f32_32x32x16_bf16 v[128:143], v[64:67], v[80:83], v[128:143]
    v_exp_f32 v125, v125
    v_cvt_pk_bf16_f32 v86, v116, v117
    v_cvt_pk_bf16_f32 v87, v118, v119
    v_exp_f32 v126, v126
    v_exp_f32 v127, v127
    v_mfma_f32_16x16x32_bf16 v[36:39], v[32:35], v[80:83], v[36:39]
    v_cvt_pk_bf16_f32 v88, v120, v121
    v_cvt_pk_bf16_f32 v89, v122, v123
    v_cvt_pk_bf16_f32 v90, v124, v125
    v_cvt_pk_bf16_f32 v91, v126, v127
    v_mfma_f32_32x32x16_bf16 v[112:127], v[52:55], v[24:27], v[176:191]
    ds_read_b128 v[68:71], v4 offset:55296
    ds_read_b128 v[72:75], v5 offset:55296
    v_exp_f32 v96, v96
    v_exp_f32 v97, v97
    v_exp_f32 v98, v98
    v_exp_f32 v99, v99
    v_mfma_f32_32x32x16_bf16 v[112:127], v[56:59], v[28:31], v[112:127]
    v_exp_f32 v100, v100
    v_exp_f32 v101, v101
    v_exp_f32 v102, v102
    v_exp_f32 v103, v103
    v_mfma_f32_32x32x16_bf16 v[144:159], v[60:63], v[84:87], v[144:159]
    v_exp_f32 v104, v104
    v_exp_f32 v105, v105
    v_cvt_pk_bf16_f32 v76, v96, v97
    v_cvt_pk_bf16_f32 v77, v98, v99
    v_exp_f32 v106, v106
    v_exp_f32 v107, v107
    v_mfma_f32_16x16x32_bf16 v[40:43], v[32:35], v[84:87], v[40:43]
    v_exp_f32 v108, v108
    v_mfma_f32_32x32x16_bf16 v[144:159], v[64:67], v[88:91], v[144:159]
    v_exp_f32 v109, v109
    v_cvt_pk_bf16_f32 v78, v100, v101
    v_cvt_pk_bf16_f32 v79, v102, v103
    v_exp_f32 v110, v110
    v_exp_f32 v111, v111
    v_mfma_f32_16x16x32_bf16 v[40:43], v[32:35], v[88:91], v[40:43]
    v_cvt_pk_bf16_f32 v80, v104, v105
    v_cvt_pk_bf16_f32 v81, v106, v107
    v_cvt_pk_bf16_f32 v82, v108, v109
    v_cvt_pk_bf16_f32 v83, v110, v111
    s_waitcnt lgkmcnt(0)
    v_exp_f32 v112, v112
    v_exp_f32 v113, v113
    v_exp_f32 v114, v114
    v_exp_f32 v115, v115
    v_exp_f32 v116, v116
    v_exp_f32 v117, v117
    v_exp_f32 v118, v118
    v_exp_f32 v119, v119
    v_mfma_f32_32x32x16_bf16 v[128:143], v[68:71], v[76:79], v[128:143]
    v_exp_f32 v120, v120
    v_exp_f32 v121, v121
    v_cvt_pk_bf16_f32 v84, v112, v113
    v_cvt_pk_bf16_f32 v85, v114, v115
    v_exp_f32 v122, v122
    v_exp_f32 v123, v123
    v_mfma_f32_16x16x32_bf16 v[36:39], v[32:35], v[76:79], v[36:39]
    v_exp_f32 v124, v124
    v_mfma_f32_32x32x16_bf16 v[128:143], v[72:75], v[80:83], v[128:143]
    v_exp_f32 v125, v125
    v_cvt_pk_bf16_f32 v86, v116, v117
    v_cvt_pk_bf16_f32 v87, v118, v119
    v_exp_f32 v126, v126
    v_exp_f32 v127, v127
    v_mfma_f32_16x16x32_bf16 v[36:39], v[32:35], v[80:83], v[36:39]
    v_cvt_pk_bf16_f32 v88, v120, v121
    v_cvt_pk_bf16_f32 v89, v122, v123
    v_cvt_pk_bf16_f32 v90, v124, v125
    v_cvt_pk_bf16_f32 v91, v126, v127
    s_nop 0
    v_mfma_f32_32x32x16_bf16 v[144:159], v[68:71], v[84:87], v[144:159]
    v_mfma_f32_16x16x32_bf16 v[40:43], v[32:35], v[84:87], v[40:43]
    v_mfma_f32_32x32x16_bf16 v[144:159], v[72:75], v[88:91], v[144:159]
    v_mfma_f32_16x16x32_bf16 v[40:43], v[32:35], v[88:91], v[40:43]
    s_nop 11
    s_waitcnt lgkmcnt(0)
    s_mov_b32 s41, 0x4e800000
    v_max_f32 v192, v36, v40
    v_add_f32 v193, v36, v40
    v_cmp_nlt_f32 vcc, v193, s41
    s_and_saveexec_b64 s[42:43], vcc
    s_cbranch_execz L_kc_ok
    v_mov_b32 v192, 139264
    v_mov_b32 v193, 1
    ds_write_b32 v192, v193
L_kc_ok:
    s_mov_b64 exec, s[42:43]
    s_cmp_lg_u32 s28, 0
    s_cbranch_scc1 L_kc_merge1
    ds_write_b128 v11, v[144:147] offset:0
    ds_write_b128 v11, v[148:151] offset:1024
    ds_write_b128 v11, v[152:155] offset:2048
    ds_write_b128 v11, v[156:159] offset:3072
    v_mov_b32 v192, v40
    v_mov_b32 v193, v176
    ds_write_b64 v11, v[192:193] offset:4096
    v_mov_b32 v194, 139264
    s_waitcnt lgkmcnt(0)
    s_barrier
    ds_read_b32 v195, v194
    v_add_u32 v196, 20480, v11
    ds_read_b64 v[192:193], v196 offset:4096
    ds_read_b128 v[144:147], v196 offset:0
    ds_read_b128 v[148:151], v196 offset:1024
    ds_read_b128 v[152:155], v196 offset:2048
    ds_read_b128 v[156:159], v196 offset:3072
    s_waitcnt lgkmcnt(5)
    v_readfirstlane_b32 s42, v195
    s_nop 0
    s_andn2_b32 s42, s42, s36
    s_cmp_lg_u32 s42, 0
    s_cbranch_scc1 L_kc_fallback
    s_waitcnt lgkmcnt(4)
    v_min_f32 v197, v160, v193
    v_sub_f32 v198, v197, v160
    v_sub_f32 v199, v197, v193
    v_exp_f32 v198, v198
    v_exp_f32 v199, v199
    s_nop 0
    v_mul_f32 v200, v198, v36
    v_fmac_f32 v200, v199, v192
    v_rcp_f32 v200, v200
    s_nop 0
    v_mul_f32 v198, v198, v200
    v_mul_f32 v199, v199, v200
    s_waitcnt lgkmcnt(0)
    v_mul_f32 v128, v198, v128
    v_mul_f32 v129, v198, v129
    v_mul_f32 v130, v198, v130
    v_mul_f32 v131, v198, v131
    v_mul_f32 v132, v198, v132
    v_mul_f32 v133, v198, v133
    v_mul_f32 v134, v198, v134
    v_mul_f32 v135, v198, v135
    v_mul_f32 v136, v198, v136
    v_mul_f32 v137, v198, v137
    v_mul_f32 v138, v198, v138
    v_mul_f32 v139, v198, v139
    v_mul_f32 v140, v198, v140
    v_mul_f32 v141, v198, v141
    v_mul_f32 v142, v198, v142
    v_mul_f32 v143, v198, v143
    v_fmac_f32 v128, v199, v144
    v_fmac_f32 v129, v199, v145
    v_fmac_f32 v130, v199, v146
    v_fmac_f32 v131, v199, v147
    v_fmac_f32 v132, v199, v148
    v_fmac_f32 v133, v199, v149
    v_fmac_f32 v134, v199, v150
    v_fmac_f32 v135, v199, v151
    v_fmac_f32 v136, v199, v152
    v_fmac_f32 v137, v199, v153
    v_fmac_f32 v138, v199, v154
    v_fmac_f32 v139, v199, v155
    v_fmac_f32 v140, v199, v156
    v_fmac_f32 v141, v199, v157
    v_fmac_f32 v142, v199, v158
    v_fmac_f32 v143, v199, v159
    v_cvt_pk_bf16_f32 v76, v128, v129
    v_cvt_pk_bf16_f32 v77, v130, v131
    v_cvt_pk_bf16_f32 v78, v132, v133
    v_cvt_pk_bf16_f32 v79, v134, v135
    v_cvt_pk_bf16_f32 v80, v136, v137
    v_cvt_pk_bf16_f32 v81, v138, v139
    v_cvt_pk_bf16_f32 v82, v140, v141
    v_cvt_pk_bf16_f32 v83, v142, v143
    s_lshl_b32 s42, s25, 14
    s_lshl_b32 s43, s27, 12
    s_add_u32 s42, s42, s43
    s_add_u32 s42, s42, s29
    v_permlane16_swap_b32 v76, v80
    v_permlane16_swap_b32 v77, v81
    v_permlane16_swap_b32 v78, v82
    v_permlane16_swap_b32 v79, v83
    buffer_store_dwordx4 v[76:79], v10, s[16:19], s42 offen offset:0 sc0 sc1
    buffer_store_dwordx4 v[80:83], v10, s[16:19], s42 offen offset:1024 sc0 sc1
    s_endpgm
L_kc_merge1:
    ds_write_b128 v11, v[128:131] offset:0
    ds_write_b128 v11, v[132:135] offset:1024
    ds_write_b128 v11, v[136:139] offset:2048
    ds_write_b128 v11, v[140:143] offset:3072
    v_mov_b32 v192, v36
    v_mov_b32 v193, v160
    ds_write_b64 v11, v[192:193] offset:4096
    v_mov_b32 v194, 139264
    s_waitcnt lgkmcnt(0)
    s_barrier
    ds_read_b32 v195, v194
    v_add_u32 v196, -20480, v11
    ds_read_b64 v[192:193], v196 offset:4096
    ds_read_b128 v[128:131], v196 offset:0
    ds_read_b128 v[132:135], v196 offset:1024
    ds_read_b128 v[136:139], v196 offset:2048
    ds_read_b128 v[140:143], v196 offset:3072
    s_waitcnt lgkmcnt(5)
    v_readfirstlane_b32 s42, v195
    s_nop 0
    s_andn2_b32 s42, s42, s36
    s_cmp_lg_u32 s42, 0
    s_cbranch_scc1 L_kc_fallback
    s_waitcnt lgkmcnt(4)
    v_min_f32 v197, v176, v193
    v_sub_f32 v198, v197, v176
    v_sub_f32 v199, v197, v193
    v_exp_f32 v198, v198
    v_exp_f32 v199, v199
    s_nop 0
    v_mul_f32 v200, v198, v40
    v_fmac_f32 v200, v199, v192
    v_rcp_f32 v200, v200
    s_nop 0
    v_mul_f32 v198, v198, v200
    v_mul_f32 v199, v199, v200
    s_waitcnt lgkmcnt(0)
    v_mul_f32 v144, v198, v144
    v_mul_f32 v145, v198, v145
    v_mul_f32 v146, v198, v146
    v_mul_f32 v147, v198, v147
    v_mul_f32 v148, v198, v148
    v_mul_f32 v149, v198, v149
    v_mul_f32 v150, v198, v150
    v_mul_f32 v151, v198, v151
    v_mul_f32 v152, v198, v152
    v_mul_f32 v153, v198, v153
    v_mul_f32 v154, v198, v154
    v_mul_f32 v155, v198, v155
    v_mul_f32 v156, v198, v156
    v_mul_f32 v157, v198, v157
    v_mul_f32 v158, v198, v158
    v_mul_f32 v159, v198, v159
    v_fmac_f32 v144, v199, v128
    v_fmac_f32 v145, v199, v129
    v_fmac_f32 v146, v199, v130
    v_fmac_f32 v147, v199, v131
    v_fmac_f32 v148, v199, v132
    v_fmac_f32 v149, v199, v133
    v_fmac_f32 v150, v199, v134
    v_fmac_f32 v151, v199, v135
    v_fmac_f32 v152, v199, v136
    v_fmac_f32 v153, v199, v137
    v_fmac_f32 v154, v199, v138
    v_fmac_f32 v155, v199, v139
    v_fmac_f32 v156, v199, v140
    v_fmac_f32 v157, v199, v141
    v_fmac_f32 v158, v199, v142
    v_fmac_f32 v159, v199, v143
    v_cvt_pk_bf16_f32 v76, v144, v145
    v_cvt_pk_bf16_f32 v77, v146, v147
    v_cvt_pk_bf16_f32 v78, v148, v149
    v_cvt_pk_bf16_f32 v79, v150, v151
    v_cvt_pk_bf16_f32 v80, v152, v153
    v_cvt_pk_bf16_f32 v81, v154, v155
    v_cvt_pk_bf16_f32 v82, v156, v157
    v_cvt_pk_bf16_f32 v83, v158, v159
    s_lshl_b32 s42, s25, 14
    s_lshl_b32 s43, s27, 12
    s_add_u32 s42, s42, s43
    s_add_u32 s42, s42, s29
    v_permlane16_swap_b32 v76, v80
    v_permlane16_swap_b32 v77, v81
    v_permlane16_swap_b32 v78, v82
    v_permlane16_swap_b32 v79, v83
    buffer_store_dwordx4 v[76:79], v10, s[16:19], s42 offen offset:2048 sc0 sc1
    buffer_store_dwordx4 v[80:83], v10, s[16:19], s42 offen offset:3072 sc0 sc1
    s_endpgm
L_kc_fallback:
    s_waitcnt lgkmcnt(0)
    v_mov_b32 v192, 0xff800000
    v_mov_b32 v193, 0xff800000
    s_add_u32 s42, s29, s32
    s_add_u32 s42, s42, 0x400000
    s_mov_b32 s43, 0
L_kc_maxloop:
    buffer_load_dwordx4 v[44:47], v7, s[12:15], s42 offen
    buffer_load_dwordx4 v[48:51], v8, s[12:15], s42 offen
    s_waitcnt vmcnt(0)
    v_mfma_f32_32x32x16_bf16 v[96:111], v[44:47], v[16:19], 0
    v_mfma_f32_32x32x16_bf16 v[96:111], v[48:51], v[20:23], v[96:111]
    v_mfma_f32_32x32x16_bf16 v[112:127], v[44:47], v[24:27], 0
    v_mfma_f32_32x32x16_bf16 v[112:127], v[48:51], v[28:31], v[112:127]
    s_nop 11
    v_max3_f32 v192, v192, v96, v97
    v_max3_f32 v192, v192, v98, v99
    v_max3_f32 v192, v192, v100, v101
    v_max3_f32 v192, v192, v102, v103
    v_max3_f32 v192, v192, v104, v105
    v_max3_f32 v192, v192, v106, v107
    v_max3_f32 v192, v192, v108, v109
    v_max3_f32 v192, v192, v110, v111
    v_max3_f32 v193, v193, v112, v113
    v_max3_f32 v193, v193, v114, v115
    v_max3_f32 v193, v193, v116, v117
    v_max3_f32 v193, v193, v118, v119
    v_max3_f32 v193, v193, v120, v121
    v_max3_f32 v193, v193, v122, v123
    v_max3_f32 v193, v193, v124, v125
    v_max3_f32 v193, v193, v126, v127
    s_add_u32 s43, s43, 1
    s_add_u32 s42, s42, 2048
    s_and_b32 s64, s43, 3
    s_cmp_lg_u32 s64, 0
    s_cbranch_scc1 L_kc_maxnext
    s_add_u32 s42, s42, 8192
L_kc_maxnext:
    s_cmp_lt_u32 s43, 32
    s_cbranch_scc1 L_kc_maxloop
    v_mov_b32 v194, v192
    v_mov_b32 v195, v193
    s_nop 1
    v_permlane32_swap_b32 v194, v192
    v_permlane32_swap_b32 v195, v193
    s_nop 0
    v_max_f32 v192, v192, v194
    v_max_f32 v193, v193, v195
    v_sub_f32 v160, 0, v192
    v_sub_f32 v161, 0, v192
    v_sub_f32 v162, 0, v192
    v_sub_f32 v163, 0, v192
    v_sub_f32 v164, 0, v192
    v_sub_f32 v165, 0, v192
    v_sub_f32 v166, 0, v192
    v_sub_f32 v167, 0, v192
    v_sub_f32 v168, 0, v192
    v_sub_f32 v169, 0, v192
    v_sub_f32 v170, 0, v192
    v_sub_f32 v171, 0, v192
    v_sub_f32 v172, 0, v192
    v_sub_f32 v173, 0, v192
    v_sub_f32 v174, 0, v192
    v_sub_f32 v175, 0, v192
    v_sub_f32 v176, 0, v193
    v_sub_f32 v177, 0, v193
    v_sub_f32 v178, 0, v193
    v_sub_f32 v179, 0, v193
    v_sub_f32 v180, 0, v193
    v_sub_f32 v181, 0, v193
    v_sub_f32 v182, 0, v193
    v_sub_f32 v183, 0, v193
    v_sub_f32 v184, 0, v193
    v_sub_f32 v185, 0, v193
    v_sub_f32 v186, 0, v193
    v_sub_f32 v187, 0, v193
    v_sub_f32 v188, 0, v193
    v_sub_f32 v189, 0, v193
    v_sub_f32 v190, 0, v193
    v_sub_f32 v191, 0, v193
    s_mov_b32 s36, 1
    s_branch L_kc_start
L_kc_done:
    s_endpgm
.globl ke_tail_kernel
.p2align 8
.type ke_tail_kernel,@function
ke_tail_kernel:
    s_cmp_ge_u32 s2, 256
    s_cbranch_scc1 L_ke_done
    s_load_dwordx2 s[4:5], s[0:1], 16
    s_load_dwordx2 s[8:9], s[0:1], 96
    s_load_dwordx2 s[6:7], s[0:1], 0
    s_load_dwordx2 s[10:11], s[0:1], 32
    s_load_dwordx4 s[76:79], s[0:1], 40
    s_load_dwordx2 s[62:63], s[0:1], 56
    s_load_dwordx2 s[60:61], s[0:1], 80
    s_and_b32 s24, s2, 7
    s_lshr_b32 s25, s2, 3
    s_and_b32 s28, s25, 3
    s_lshl_b32 s26, s24, 2
    s_add_u32 s26, s26, s28
    s_lshr_b32 s27, s25, 2
    v_bfe_u32 v1, v0, 6, 2
    v_lshrrev_b32 v3, 6, v0
    v_and_b32 v2, 63, v0
    v_readfirstlane_b32 s30, v1
    v_readfirstlane_b32 s43, v3
    s_lshl_b32 s33, s26, 17
    s_lshl_b32 s34, s27, 8
    s_and_b32 s31, s30, 1
    s_lshr_b32 s32, s30, 1
    s_lshr_b32 s28, s25, 2
    s_lshl_b32 s28, s28, 3
    s_add_u32 s28, s28, s24
    s_and_b32 s29, s25, 3
    v_lshrrev_b32 v4, 4, v2
    v_and_b32 v5, 15, v2
    v_lshlrev_b32 v17, 11, v4
    v_lshl_add_u32 v17, v5, 4, v17
    v_lshl_add_u32 v6, v3, 3, v4
    v_and_b32 v7, 15, v6
    v_xor_b32 v7, v7, v5
    v_lshlrev_b32 v7, 4, v7
    v_lshl_add_u32 v20, v6, 9, v7
    v_add_u32 v20, 49152, v20
    v_xor_b32 v40, 64, v20
    v_add_u32 v40, 2048, v40
    v_lshlrev_b32 v18, 5, v5
    v_add_u32 v18, 147456, v18
    v_bfe_u32 v7, v2, 3, 1
    v_lshl_add_u32 v7, v7, 2, v4
    v_lshlrev_b32 v19, 4, v7
    s_lshl_b32 s37, s26, 6
    s_sub_u32 s37, 2047, s37
    s_lshl_b32 s38, s43, 3
    s_sub_u32 s37, s37, s38
    v_sub_u32 v46, s37, v7
    v_and_b32 v7, 7, v2
    v_lshl_add_u32 v45, v7, 10, v19
    v_lshlrev_b32 v47, 4, v5
    s_lshl_b32 s39, s43, 14
    s_add_u32 s39, s39, s33
    s_add_u32 s39, s39, s34
    s_add_u32 s40, s39, 8192
    s_lshl_b32 s42, s26, 13
    s_lshl_b32 s41, s43, 7
    s_add_u32 s42, s42, s41
    s_lshl_b32 s41, s27, 10
    s_add_u32 s41, s41, s42
    s_cmp_lt_u32 s43, 4
    s_cbranch_scc1 L_ke_compute
    s_lshl_b32 s35, s30, 11
    s_lshl_b32 s36, s30, 12
    v_lshrrev_b32 v3, 3, v2
    v_lshl_add_u32 v3, v1, 4, v3
    v_lshlrev_b32 v3, 6, v3
    v_and_b32 v4, 7, v2
    v_lshrrev_b32 v5, 4, v2
    v_xor_b32 v4, v4, v5
    v_and_b32 v5, 3, v4
    v_lshl_add_u32 v3, v5, 4, v3
    v_lshrrev_b32 v5, 2, v4
    v_lshl_add_u32 v14, v5, 17, v3
    v_xor_b32 v15, 0x20000, v14
    v_add_u32 v15, 512, v15
    s_lshl_b32 s33, s26, 12
    v_bfe_u32 v3, v2, 4, 1
    v_lshlrev_b32 v3, 3, v3
    v_bfe_u32 v4, v2, 2, 2
    v_add_u32 v3, v3, v4
    v_lshlrev_b32 v3, 11, v3
    v_lshrrev_b32 v4, 5, v2
    v_lshl_add_u32 v3, v4, 6, v3
    v_and_b32 v4, 3, v2
    v_lshl_add_u32 v16, v4, 4, v3
    s_lshl_b32 s37, s31, 2
    s_lshl_b32 s38, s32, 5
    s_add_u32 s37, s37, s38
    s_lshl_b32 s37, s37, 11
    s_add_u32 s34, s34, s37
    s_waitcnt lgkmcnt(0)
    s_add_u32 s12, s8, 0x1100000
    s_addc_u32 s13, s9, 0
    s_mov_b32 s14, 0x400000
    s_mov_b32 s15, 0x00020000
    s_mov_b32 s16, s4
    s_mov_b32 s17, s5
    s_mov_b32 s18, 0x200000
    s_mov_b32 s19, 0x00020000
    s_add_u32 m0, s35, 0
    s_add_u32 s38, s33, 0
    buffer_load_dwordx4 v14, s[12:15], s38 offen lds
    s_add_u32 m0, s35, 1024
    s_add_u32 s38, s33, 0
    buffer_load_dwordx4 v15, s[12:15], s38 offen lds
    s_add_u32 m0, s36, 49152
    s_add_u32 s38, s34, 0
    buffer_load_dwordx4 v16, s[16:19], s38 offen lds
    s_add_u32 m0, s36, 50176
    s_add_u32 s38, s34, 128
    buffer_load_dwordx4 v16, s[16:19], s38 offen lds
    s_add_u32 m0, s36, 51200
    s_add_u32 s38, s34, 32768
    buffer_load_dwordx4 v16, s[16:19], s38 offen lds
    s_add_u32 m0, s36, 52224
    s_add_u32 s38, s34, 32896
    buffer_load_dwordx4 v16, s[16:19], s38 offen lds
    s_add_u32 m0, s35, 8192
    s_add_u32 s38, s33, 262144
    buffer_load_dwordx4 v14, s[12:15], s38 offen lds
    s_add_u32 m0, s35, 9216
    s_add_u32 s38, s33, 262144
    buffer_load_dwordx4 v15, s[12:15], s38 offen lds
    s_add_u32 m0, s36, 65536
    s_add_u32 s38, s34, 131072
    buffer_load_dwordx4 v16, s[16:19], s38 offen lds
    s_add_u32 m0, s36, 66560
    s_add_u32 s38, s34, 131200
    buffer_load_dwordx4 v16, s[16:19], s38 offen lds
    s_add_u32 m0, s36, 67584
    s_add_u32 s38, s34, 163840
    buffer_load_dwordx4 v16, s[16:19], s38 offen lds
    s_add_u32 m0, s36, 68608
    s_add_u32 s38, s34, 163968
    buffer_load_dwordx4 v16, s[16:19], s38 offen lds
    s_mov_b32 s20, s60
    s_mov_b32 s21, s61
    s_mov_b32 s22, 0x400000
    s_mov_b32 s23, 0x00020000
    s_mov_b32 s44, s6
    s_mov_b32 s45, s7
    s_mov_b32 s46, 0x400000
    s_mov_b32 s47, 0x00020000
    s_add_u32 s56, s8, 0x1c00000
    s_addc_u32 s57, s9, 0
    s_mov_b32 s58, 0x118000
    s_mov_b32 s59, 0x00020000
    s_waitcnt vmcnt(6)
    s_barrier
    s_add_u32 m0, s35, 16384
    s_add_u32 s38, s33, 524288
    buffer_load_dwordx4 v14, s[12:15], s38 offen lds
    s_add_u32 m0, s35, 17408
    s_add_u32 s38, s33, 524288
    buffer_load_dwordx4 v15, s[12:15], s38 offen lds
    s_add_u32 m0, s36, 81920
    s_add_u32 s38, s34, 262144
    buffer_load_dwordx4 v16, s[16:19], s38 offen lds
    s_add_u32 m0, s36, 82944
    s_add_u32 s38, s34, 262272
    buffer_load_dwordx4 v16, s[16:19], s38 offen lds
    s_add_u32 m0, s36, 83968
    s_add_u32 s38, s34, 294912
    buffer_load_dwordx4 v16, s[16:19], s38 offen lds
    s_add_u32 m0, s36, 84992
    s_add_u32 s38, s34, 295040
    buffer_load_dwordx4 v16, s[16:19], s38 offen lds
    s_add_u32 m0, s35, 24576
    s_add_u32 s38, s33, 786432
    buffer_load_dwordx4 v14, s[12:15], s38 offen lds
    s_add_u32 m0, s35, 25600
    s_add_u32 s38, s33, 786432
    buffer_load_dwordx4 v15, s[12:15], s38 offen lds
    s_add_u32 m0, s36, 98304
    s_add_u32 s38, s34, 393216
    buffer_load_dwordx4 v16, s[16:19], s38 offen lds
    s_add_u32 m0, s36, 99328
    s_add_u32 s38, s34, 393344
    buffer_load_dwordx4 v16, s[16:19], s38 offen lds
    s_add_u32 m0, s36, 100352
    s_add_u32 s38, s34, 425984
    buffer_load_dwordx4 v16, s[16:19], s38 offen lds
    s_add_u32 m0, s36, 101376
    s_add_u32 s38, s34, 426112
    buffer_load_dwordx4 v16, s[16:19], s38 offen lds
    s_waitcnt vmcnt(12)
    s_barrier
    s_add_u32 m0, s35, 32768
    s_add_u32 s38, s33, 1048576
    buffer_load_dwordx4 v14, s[12:15], s38 offen lds
    s_add_u32 m0, s35, 33792
    s_add_u32 s38, s33, 1048576
    buffer_load_dwordx4 v15, s[12:15], s38 offen lds
    s_add_u32 m0, s36, 114688
    s_add_u32 s38, s34, 524288
    buffer_load_dwordx4 v16, s[16:19], s38 offen lds
    s_add_u32 m0, s36, 115712
    s_add_u32 s38, s34, 524416
    buffer_load_dwordx4 v16, s[16:19], s38 offen lds
    s_add_u32 m0, s36, 116736
    s_add_u32 s38, s34, 557056
    buffer_load_dwordx4 v16, s[16:19], s38 offen lds
    s_add_u32 m0, s36, 117760
    s_add_u32 s38, s34, 557184
    buffer_load_dwordx4 v16, s[16:19], s38 offen lds
    s_add_u32 m0, s35, 40960
    s_add_u32 s38, s33, 1310720
    buffer_load_dwordx4 v14, s[12:15], s38 offen lds
    s_add_u32 m0, s35, 41984
    s_add_u32 s38, s33, 1310720
    buffer_load_dwordx4 v15, s[12:15], s38 offen lds
    s_add_u32 m0, s36, 131072
    s_add_u32 s38, s34, 655360
    buffer_load_dwordx4 v16, s[16:19], s38 offen lds
    s_add_u32 m0, s36, 132096
    s_add_u32 s38, s34, 655488
    buffer_load_dwordx4 v16, s[16:19], s38 offen lds
    s_add_u32 m0, s36, 133120
    s_add_u32 s38, s34, 688128
    buffer_load_dwordx4 v16, s[16:19], s38 offen lds
    s_add_u32 m0, s36, 134144
    s_add_u32 s38, s34, 688256
    buffer_load_dwordx4 v16, s[16:19], s38 offen lds
    s_waitcnt vmcnt(18)
    s_barrier
    s_add_u32 m0, s35, 0
    s_add_u32 s38, s33, 1572864
    buffer_load_dwordx4 v14, s[12:15], s38 offen lds
    s_add_u32 m0, s35, 1024
    s_add_u32 s38, s33, 1572864
    buffer_load_dwordx4 v15, s[12:15], s38 offen lds
    s_add_u32 m0, s36, 49152
    s_add_u32 s38, s34, 786432
    buffer_load_dwordx4 v16, s[16:19], s38 offen lds
    s_add_u32 m0, s36, 50176
    s_add_u32 s38, s34, 786560
    buffer_load_dwordx4 v16, s[16:19], s38 offen lds
    s_add_u32 m0, s36, 51200
    s_add_u32 s38, s34, 819200
    buffer_load_dwordx4 v16, s[16:19], s38 offen lds
    s_add_u32 m0, s36, 52224
    s_add_u32 s38, s34, 819328
    buffer_load_dwordx4 v16, s[16:19], s38 offen lds
    s_waitcnt vmcnt(18)
    s_barrier
    s_add_u32 m0, s35, 8192
    s_add_u32 s38, s33, 1835008
    buffer_load_dwordx4 v14, s[12:15], s38 offen lds
    s_add_u32 m0, s35, 9216
    s_add_u32 s38, s33, 1835008
    buffer_load_dwordx4 v15, s[12:15], s38 offen lds
    s_add_u32 m0, s36, 65536
    s_add_u32 s38, s34, 917504
    buffer_load_dwordx4 v16, s[16:19], s38 offen lds
    s_add_u32 m0, s36, 66560
    s_add_u32 s38, s34, 917632
    buffer_load_dwordx4 v16, s[16:19], s38 offen lds
    s_add_u32 m0, s36, 67584
    s_add_u32 s38, s34, 950272
    buffer_load_dwordx4 v16, s[16:19], s38 offen lds
    s_add_u32 m0, s36, 68608
    s_add_u32 s38, s34, 950400
    buffer_load_dwordx4 v16, s[16:19], s38 offen lds
    s_waitcnt vmcnt(18)
    s_barrier
    s_add_u32 m0, s35, 16384
    s_add_u32 s38, s33, 2097152
    buffer_load_dwordx4 v14, s[12:15], s38 offen lds
    s_add_u32 m0, s35, 17408
    s_add_u32 s38, s33, 2097152
    buffer_load_dwordx4 v15, s[12:15], s38 offen lds
    s_add_u32 m0, s36, 81920
    s_add_u32 s38, s34, 1048576
    buffer_load_dwordx4 v16, s[16:19], s38 offen lds
    s_add_u32 m0, s36, 82944
    s_add_u32 s38, s34, 1048704
    buffer_load_dwordx4 v16, s[16:19], s38 offen lds
    s_add_u32 m0, s36, 83968
    s_add_u32 s38, s34, 1081344
    buffer_load_dwordx4 v16, s[16:19], s38 offen lds
    s_add_u32 m0, s36, 84992
    s_add_u32 s38, s34, 1081472
    buffer_load_dwordx4 v16, s[16:19], s38 offen lds
    s_waitcnt vmcnt(18)
    s_barrier
    s_add_u32 m0, s35, 24576
    s_add_u32 s38, s33, 2359296
    buffer_load_dwordx4 v14, s[12:15], s38 offen lds
    s_add_u32 m0, s35, 25600
    s_add_u32 s38, s33, 2359296
    buffer_load_dwordx4 v15, s[12:15], s38 offen lds
    s_add_u32 m0, s36, 98304
    s_add_u32 s38, s34, 1179648
    buffer_load_dwordx4 v16, s[16:19], s38 offen lds
    s_add_u32 m0, s36, 99328
    s_add_u32 s38, s34, 1179776
    buffer_load_dwordx4 v16, s[16:19], s38 offen lds
    s_add_u32 m0, s36, 100352
    s_add_u32 s38, s34, 1212416
    buffer_load_dwordx4 v16, s[16:19], s38 offen lds
    s_add_u32 m0, s36, 101376
    s_add_u32 s38, s34, 1212544
    buffer_load_dwordx4 v16, s[16:19], s38 offen lds
    s_waitcnt vmcnt(18)
    s_barrier
    s_add_u32 m0, s35, 32768
    s_add_u32 s38, s33, 2621440
    buffer_load_dwordx4 v14, s[12:15], s38 offen lds
    s_add_u32 m0, s35, 33792
    s_add_u32 s38, s33, 2621440
    buffer_load_dwordx4 v15, s[12:15], s38 offen lds
    s_add_u32 m0, s36, 114688
    s_add_u32 s38, s34, 1310720
    buffer_load_dwordx4 v16, s[16:19], s38 offen lds
    s_add_u32 m0, s36, 115712
    s_add_u32 s38, s34, 1310848
    buffer_load_dwordx4 v16, s[16:19], s38 offen lds
    s_add_u32 m0, s36, 116736
    s_add_u32 s38, s34, 1343488
    buffer_load_dwordx4 v16, s[16:19], s38 offen lds
    s_add_u32 m0, s36, 117760
    s_add_u32 s38, s34, 1343616
    buffer_load_dwordx4 v16, s[16:19], s38 offen lds
    s_waitcnt vmcnt(18)
    s_barrier
    s_add_u32 m0, s35, 40960
    s_add_u32 s38, s33, 2883584
    buffer_load_dwordx4 v14, s[12:15], s38 offen lds
    s_add_u32 m0, s35, 41984
    s_add_u32 s38, s33, 2883584
    buffer_load_dwordx4 v15, s[12:15], s38 offen lds
    s_add_u32 m0, s36, 131072
    s_add_u32 s38, s34, 1441792
    buffer_load_dwordx4 v16, s[16:19], s38 offen lds
    s_add_u32 m0, s36, 132096
    s_add_u32 s38, s34, 1441920
    buffer_load_dwordx4 v16, s[16:19], s38 offen lds
    s_add_u32 m0, s36, 133120
    s_add_u32 s38, s34, 1474560
    buffer_load_dwordx4 v16, s[16:19], s38 offen lds
    s_add_u32 m0, s36, 134144
    s_add_u32 s38, s34, 1474688
    buffer_load_dwordx4 v16, s[16:19], s38 offen lds
    s_waitcnt vmcnt(18)
    s_barrier
    s_add_u32 m0, s35, 0
    s_add_u32 s38, s33, 3145728
    buffer_load_dwordx4 v14, s[12:15], s38 offen lds
    s_add_u32 m0, s35, 1024
    s_add_u32 s38, s33, 3145728
    buffer_load_dwordx4 v15, s[12:15], s38 offen lds
    s_add_u32 m0, s36, 49152
    s_add_u32 s38, s34, 1572864
    buffer_load_dwordx4 v16, s[16:19], s38 offen lds
    s_add_u32 m0, s36, 50176
    s_add_u32 s38, s34, 1572992
    buffer_load_dwordx4 v16, s[16:19], s38 offen lds
    s_add_u32 m0, s36, 51200
    s_add_u32 s38, s34, 1605632
    buffer_load_dwordx4 v16, s[16:19], s38 offen lds
    s_add_u32 m0, s36, 52224
    s_add_u32 s38, s34, 1605760
    buffer_load_dwordx4 v16, s[16:19], s38 offen lds
    s_waitcnt vmcnt(18)
    s_barrier
    s_add_u32 m0, s35, 8192
    s_add_u32 s38, s33, 3407872
    buffer_load_dwordx4 v14, s[12:15], s38 offen lds
    s_add_u32 m0, s35, 9216
    s_add_u32 s38, s33, 3407872
    buffer_load_dwordx4 v15, s[12:15], s38 offen lds
    s_add_u32 m0, s36, 65536
    s_add_u32 s38, s34, 1703936
    buffer_load_dwordx4 v16, s[16:19], s38 offen lds
    s_add_u32 m0, s36, 66560
    s_add_u32 s38, s34, 1704064
    buffer_load_dwordx4 v16, s[16:19], s38 offen lds
    s_add_u32 m0, s36, 67584
    s_add_u32 s38, s34, 1736704
    buffer_load_dwordx4 v16, s[16:19], s38 offen lds
    s_add_u32 m0, s36, 68608
    s_add_u32 s38, s34, 1736832
    buffer_load_dwordx4 v16, s[16:19], s38 offen lds
    s_waitcnt vmcnt(18)
    s_barrier
    s_add_u32 m0, s35, 16384
    s_add_u32 s38, s33, 3670016
    buffer_load_dwordx4 v14, s[12:15], s38 offen lds
    s_add_u32 m0, s35, 17408
    s_add_u32 s38, s33, 3670016
    buffer_load_dwordx4 v15, s[12:15], s38 offen lds
    s_add_u32 m0, s36, 81920
    s_add_u32 s38, s34, 1835008
    buffer_load_dwordx4 v16, s[16:19], s38 offen lds
    s_add_u32 m0, s36, 82944
    s_add_u32 s38, s34, 1835136
    buffer_load_dwordx4 v16, s[16:19], s38 offen lds
    s_add_u32 m0, s36, 83968
    s_add_u32 s38, s34, 1867776
    buffer_load_dwordx4 v16, s[16:19], s38 offen lds
    s_add_u32 m0, s36, 84992
    s_add_u32 s38, s34, 1867904
    buffer_load_dwordx4 v16, s[16:19], s38 offen lds
    s_waitcnt vmcnt(18)
    s_barrier
    s_add_u32 m0, s35, 24576
    s_add_u32 s38, s33, 3932160
    buffer_load_dwordx4 v14, s[12:15], s38 offen lds
    s_add_u32 m0, s35, 25600
    s_add_u32 s38, s33, 3932160
    buffer_load_dwordx4 v15, s[12:15], s38 offen lds
    s_add_u32 m0, s36, 98304
    s_add_u32 s38, s34, 1966080
    buffer_load_dwordx4 v16, s[16:19], s38 offen lds
    s_add_u32 m0, s36, 99328
    s_add_u32 s38, s34, 1966208
    buffer_load_dwordx4 v16, s[16:19], s38 offen lds
    s_add_u32 m0, s36, 100352
    s_add_u32 s38, s34, 1998848
    buffer_load_dwordx4 v16, s[16:19], s38 offen lds
    s_add_u32 m0, s36, 101376
    s_add_u32 s38, s34, 1998976
    buffer_load_dwordx4 v16, s[16:19], s38 offen lds
    buffer_load_dwordx4 v[132:135], v17, s[44:47], s39 offen
    buffer_load_dwordx4 v[136:139], v17, s[44:47], s40 offen
    ds_read_b128 v[140:143], v18 offset:0
    ds_read_b128 v[148:151], v18 offset:512
    ds_read_b128 v[144:147], v18 offset:16
    ds_read_b128 v[152:155], v18 offset:528
    s_waitcnt vmcnt(20)
    s_barrier
    s_waitcnt vmcnt(14)
    s_barrier
    s_waitcnt vmcnt(8)
    s_barrier
    s_waitcnt vmcnt(2)
    s_barrier
    s_branch L_ke_phase2
L_ke_compute:
    v_and_b32 v3, 31, v2
    v_lshrrev_b32 v4, 5, v2
    v_and_b32 v5, 127, v0
    v_lshlrev_b32 v6, 2, v5
    v_lshlrev_b32 v7, 1, v5
    v_lshlrev_b32 v23, 2, v2
    s_lshl_b32 s37, s27, 9
    s_lshl_b32 s38, s32, 13
    s_add_u32 s37, s37, s38
    s_add_u32 s37, s37, 8192
    s_add_u32 s38, s37, 4096
    s_mov_b32 s36, 133120
    s_waitcnt lgkmcnt(0)
    s_mov_b32 s48, s8
    s_mov_b32 s49, s9
    s_mov_b32 s50, 0x21000
    s_mov_b32 s51, 0x00020000
    s_mov_b32 s52, s10
    s_mov_b32 s53, s11
    s_mov_b32 s54, 0x800
    s_mov_b32 s55, 0x00020000
    buffer_load_dword v24, v6, s[48:51], s37 offen
    buffer_load_ushort v25, v7, s[52:55], s34 offen
    buffer_load_dword v27, v6, s[48:51], s38 offen
    buffer_load_dword v28, v23, s[48:51], s36 offen
    s_mov_b32 s20, s60
    s_mov_b32 s21, s61
    s_mov_b32 s22, 0x400000
    s_mov_b32 s23, 0x00020000
    s_mov_b32 s44, s6
    s_mov_b32 s45, s7
    s_mov_b32 s46, 0x400000
    s_mov_b32 s47, 0x00020000
    s_add_u32 s56, s8, 0x1c00000
    s_addc_u32 s57, s9, 0
    s_mov_b32 s58, 0x118000
    s_mov_b32 s59, 0x00020000
    s_mov_b32 s64, s76
    s_mov_b32 s65, s77
    s_mov_b32 s66, 0x700000
    s_mov_b32 s67, 0x00020000
    s_mov_b32 s68, s78
    s_mov_b32 s69, s79
    s_mov_b32 s70, 0x700000
    s_mov_b32 s71, 0x00020000
    s_mov_b32 s72, s62
    s_mov_b32 s73, s63
    s_mov_b32 s74, 0x700000
    s_mov_b32 s75, 0x00020000
    s_cmp_lt_u32 s2, 224
    s_cselect_b32 s66, s66, 0
    s_cselect_b32 s70, s70, 0
    s_cselect_b32 s74, s74, 0
    s_lshl_b32 s35, s29, 2
    s_add_u32 s35, s35, s30
    s_lshl_b32 s36, s35, 7
    s_mul_i32 s35, s35, 458752
    s_lshl_b32 s37, s28, 7
    s_add_u32 s35, s35, s37
    s_lshl_b32 s37, s28, 17
    s_add_u32 s36, s36, s37
    v_lshrrev_b32 v5, 3, v2
    v_and_b32 v6, 7, v2
    s_mov_b32 s37, 57344
    v_mul_lo_u32 v21, v5, s37
    v_lshl_add_u32 v21, v6, 4, v21
    v_lshlrev_b32 v22, 14, v5
    v_lshl_add_u32 v22, v6, 4, v22
    v_bfe_u32 v5, v2, 1, 3
    s_lshl_b32 s37, s32, 12
    v_lshlrev_b32 v6, 7, v3
    v_add_u32 v6, s37, v6
    v_add_u32 v7, 0, v4
    v_xor_b32 v7, v7, v5
    v_lshl_add_u32 v8, v7, 4, v6
    v_add_u32 v7, 2, v4
    v_xor_b32 v7, v7, v5
    v_lshl_add_u32 v9, v7, 4, v6
    v_add_u32 v7, 4, v4
    v_xor_b32 v7, v7, v5
    v_lshl_add_u32 v10, v7, 4, v6
    v_add_u32 v7, 6, v4
    v_xor_b32 v7, v7, v5
    v_lshl_add_u32 v11, v7, 4, v6
    v_lshlrev_b32 v6, 11, v4
    v_bfe_u32 v7, v2, 2, 2
    v_lshl_add_u32 v6, v7, 6, v6
    v_and_b32 v7, 1, v2
    v_lshl_add_u32 v6, v7, 5, v6
    v_bfe_u32 v7, v2, 4, 1
    v_lshl_add_u32 v6, v7, 4, v6
    v_bfe_u32 v7, v2, 1, 1
    v_lshl_add_u32 v6, v7, 3, v6
    s_lshl_b32 s37, s31, 10
    s_add_u32 s37, s37, 49152
    v_add_u32 v12, s37, v6
    v_add_u32 v13, 49152, v12
    v_lshlrev_b32 v6, 1, v4
    s_lshl_b32 s37, s31, 3
    v_or_b32 v6, s37, v6
    v_and_b32 v7, 15, v3
    v_xor_b32 v6, v6, v7
    v_lshlrev_b32 v6, 4, v6
    v_lshl_add_u32 v6, v3, 9, v6
    s_lshl_b32 s37, s32, 14
    s_add_u32 s37, s37, 49152
    v_add_u32 v41, s37, v6
    v_xor_b32 v42, 16, v41
    v_xor_b32 v43, 64, v41
    v_xor_b32 v44, 80, v41
    v_lshlrev_b32 v6, 2, v0
    v_add_u32 v6, 147456, v6
    v_mov_b32 v7, 0
    ds_write_b32 v6, v7 offset:2560
    v_lshlrev_b32 v7, 2, v4
    v_add_u32 v7, 151040, v7
    s_cmp_ge_u32 s30, 2
    s_cselect_b64 vcc, -1, 0
    s_waitcnt vmcnt(0)
    v_add_f32_dpp v28, v28, v28 quad_perm:[1,0,3,2] row_mask:0xf bank_mask:0xf
    v_cvt_pk_bf16_f32 v24, v24, v27
    v_lshlrev_b32 v25, 16, v25
    v_add_f32_dpp v28, v28, v28 quad_perm:[2,3,0,1] row_mask:0xf bank_mask:0xf
    v_and_b32 v27, 0xffff0000, v24
    v_lshlrev_b32 v24, 16, v24
    v_add_f32_dpp v28, v28, v28 row_half_mirror row_mask:0xf bank_mask:0xf
    v_add_f32 v26, 1.0, v24
    v_cvt_pk_bf16_f32 v26, v26, v26
    v_add_f32_dpp v28, v28, v28 row_mirror row_mask:0xf bank_mask:0xf
    v_lshlrev_b32 v26, 16, v26
    v_mul_f32 v25, v26, v25
    v_mov_b32 v29, v28
    v_cndmask_b32 v24, v24, v25, vcc
    ds_write_b32 v6, v24
    v_permlane16_swap_b32 v29, v28
    ds_write_b32 v6, v27 offset:1024
    v_add_f32 v28, v28, v29
    ds_write_b32 v7, v28
    s_mov_b64 exec, vcc
    ds_write_b32 v6, v26 offset:1536
    s_mov_b64 exec, -1
    s_waitcnt lgkmcnt(0)
    s_barrier
    ds_read_b128 v[96:99], v8 offset:0
    ds_read_b64_tr_b16 v[100:101], v12 offset:0
    ds_read_b64_tr_b16 v[102:103], v12 offset:256
    ds_read_b64_tr_b16 v[104:105], v12 offset:512
    ds_read_b64_tr_b16 v[106:107], v12 offset:768
    ds_read_b128 v[108:111], v9 offset:0
    ds_read_b64_tr_b16 v[112:113], v12 offset:4096
    ds_read_b64_tr_b16 v[114:115], v12 offset:4352
    ds_read_b64_tr_b16 v[116:117], v12 offset:4608
    ds_read_b64_tr_b16 v[118:119], v12 offset:4864
    s_waitcnt lgkmcnt(5)
    v_mfma_f32_32x32x16_bf16 v[64:79], v[100:103], v[96:99], 0
    ds_read_b128 v[120:123], v10 offset:0
    ds_read_b64_tr_b16 v[124:125], v12 offset:8192
    ds_read_b64_tr_b16 v[126:127], v12 offset:8448
    v_mfma_f32_32x32x16_bf16 v[80:95], v[104:107], v[96:99], 0
    ds_read_b64_tr_b16 v[128:129], v12 offset:8704
    ds_read_b64_tr_b16 v[130:131], v12 offset:8960
    s_waitcnt lgkmcnt(5)
    v_mfma_f32_32x32x16_bf16 v[64:79], v[112:115], v[108:111], v[64:79]
    ds_read_b128 v[96:99], v11 offset:0
    ds_read_b64_tr_b16 v[100:101], v12 offset:12288
    ds_read_b64_tr_b16 v[102:103], v12 offset:12544
    v_mfma_f32_32x32x16_bf16 v[80:95], v[116:119], v[108:111], v[80:95]
    ds_read_b64_tr_b16 v[104:105], v12 offset:12800
    ds_read_b64_tr_b16 v[106:107], v12 offset:13056
    s_waitcnt lgkmcnt(5)
    v_mfma_f32_32x32x16_bf16 v[64:79], v[124:127], v[120:123], v[64:79]
    s_barrier
    ds_read_b128 v[108:111], v8 offset:8192
    ds_read_b64_tr_b16 v[112:113], v12 offset:16384
    ds_read_b64_tr_b16 v[114:115], v12 offset:16640
    v_mfma_f32_32x32x16_bf16 v[80:95], v[128:131], v[120:123], v[80:95]
    ds_read_b64_tr_b16 v[116:117], v12 offset:16896
    ds_read_b64_tr_b16 v[118:119], v12 offset:17152
    s_waitcnt lgkmcnt(5)
    v_mfma_f32_32x32x16_bf16 v[64:79], v[100:103], v[96:99], v[64:79]
    ds_read_b128 v[120:123], v9 offset:8192
    ds_read_b64_tr_b16 v[124:125], v12 offset:20480
    ds_read_b64_tr_b16 v[126:127], v12 offset:20736
    v_mfma_f32_32x32x16_bf16 v[80:95], v[104:107], v[96:99], v[80:95]
    ds_read_b64_tr_b16 v[128:129], v12 offset:20992
    ds_read_b64_tr_b16 v[130:131], v12 offset:21248
    s_waitcnt lgkmcnt(5)
    v_mfma_f32_32x32x16_bf16 v[64:79], v[112:115], v[108:111], v[64:79]
    ds_read_b128 v[96:99], v10 offset:8192
    ds_read_b64_tr_b16 v[100:101], v12 offset:24576
    ds_read_b64_tr_b16 v[102:103], v12 offset:24832
    v_mfma_f32_32x32x16_bf16 v[80:95], v[116:119], v[108:111], v[80:95]
    ds_read_b64_tr_b16 v[104:105], v12 offset:25088
    ds_read_b64_tr_b16 v[106:107], v12 offset:25344
    buffer_load_dwordx4 v[132:135], v17, s[44:47], s39 offen
    buffer_load_dwordx4 v[136:139], v17, s[44:47], s40 offen
    s_waitcnt lgkmcnt(5)
    v_mfma_f32_32x32x16_bf16 v[64:79], v[124:127], v[120:123], v[64:79]
    ds_read_b128 v[108:111], v11 offset:8192
    ds_read_b64_tr_b16 v[112:113], v12 offset:28672
    ds_read_b64_tr_b16 v[114:115], v12 offset:28928
    v_mfma_f32_32x32x16_bf16 v[80:95], v[128:131], v[120:123], v[80:95]
    ds_read_b64_tr_b16 v[116:117], v12 offset:29184
    ds_read_b64_tr_b16 v[118:119], v12 offset:29440
    s_waitcnt lgkmcnt(5)
    v_mfma_f32_32x32x16_bf16 v[64:79], v[100:103], v[96:99], v[64:79]
    s_barrier
    ds_read_b128 v[120:123], v8 offset:16384
    ds_read_b64_tr_b16 v[124:125], v12 offset:32768
    ds_read_b64_tr_b16 v[126:127], v12 offset:33024
    v_mfma_f32_32x32x16_bf16 v[80:95], v[104:107], v[96:99], v[80:95]
    ds_read_b64_tr_b16 v[128:129], v12 offset:33280
    ds_read_b64_tr_b16 v[130:131], v12 offset:33536
    s_waitcnt lgkmcnt(5)
    v_mfma_f32_32x32x16_bf16 v[64:79], v[112:115], v[108:111], v[64:79]
    ds_read_b128 v[96:99], v9 offset:16384
    ds_read_b64_tr_b16 v[100:101], v12 offset:36864
    ds_read_b64_tr_b16 v[102:103], v12 offset:37120
    v_mfma_f32_32x32x16_bf16 v[80:95], v[116:119], v[108:111], v[80:95]
    ds_read_b64_tr_b16 v[104:105], v12 offset:37376
    ds_read_b64_tr_b16 v[106:107], v12 offset:37632
    s_waitcnt lgkmcnt(5)
    v_mfma_f32_32x32x16_bf16 v[64:79], v[124:127], v[120:123], v[64:79]
    ds_read_b128 v[108:111], v10 offset:16384
    ds_read_b64_tr_b16 v[112:113], v12 offset:40960
    ds_read_b64_tr_b16 v[114:115], v12 offset:41216
    v_mfma_f32_32x32x16_bf16 v[80:95], v[128:131], v[120:123], v[80:95]
    ds_read_b64_tr_b16 v[116:117], v12 offset:41472
    ds_read_b64_tr_b16 v[118:119], v12 offset:41728
    s_waitcnt lgkmcnt(5)
    v_mfma_f32_32x32x16_bf16 v[64:79], v[100:103], v[96:99], v[64:79]
    ds_read_b128 v[120:123], v11 offset:16384
    ds_read_b64_tr_b16 v[124:125], v12 offset:45056
    ds_read_b64_tr_b16 v[126:127], v12 offset:45312
    v_mfma_f32_32x32x16_bf16 v[80:95], v[104:107], v[96:99], v[80:95]
    ds_read_b64_tr_b16 v[128:129], v12 offset:45568
    ds_read_b64_tr_b16 v[130:131], v12 offset:45824
    s_waitcnt lgkmcnt(5)
    v_mfma_f32_32x32x16_bf16 v[64:79], v[112:115], v[108:111], v[64:79]
    s_barrier
    ds_read_b128 v[96:99], v8 offset:24576
    ds_read_b64_tr_b16 v[100:101], v13 offset:0
    ds_read_b64_tr_b16 v[102:103], v13 offset:256
    v_mfma_f32_32x32x16_bf16 v[80:95], v[116:119], v[108:111], v[80:95]
    ds_read_b64_tr_b16 v[104:105], v13 offset:512
    ds_read_b64_tr_b16 v[106:107], v13 offset:768
    s_waitcnt lgkmcnt(5)
    v_mfma_f32_32x32x16_bf16 v[64:79], v[124:127], v[120:123], v[64:79]
    ds_read_b128 v[108:111], v9 offset:24576
    ds_read_b64_tr_b16 v[112:113], v13 offset:4096
    ds_read_b64_tr_b16 v[114:115], v13 offset:4352
    v_mfma_f32_32x32x16_bf16 v[80:95], v[128:131], v[120:123], v[80:95]
    ds_read_b64_tr_b16 v[116:117], v13 offset:4608
    ds_read_b64_tr_b16 v[118:119], v13 offset:4864
    s_waitcnt lgkmcnt(5)
    v_mfma_f32_32x32x16_bf16 v[64:79], v[100:103], v[96:99], v[64:79]
    ds_read_b128 v[120:123], v10 offset:24576
    ds_read_b64_tr_b16 v[124:125], v13 offset:8192
    ds_read_b64_tr_b16 v[126:127], v13 offset:8448
    v_mfma_f32_32x32x16_bf16 v[80:95], v[104:107], v[96:99], v[80:95]
    ds_read_b64_tr_b16 v[128:129], v13 offset:8704
    ds_read_b64_tr_b16 v[130:131], v13 offset:8960
    s_waitcnt lgkmcnt(5)
    v_mfma_f32_32x32x16_bf16 v[64:79], v[112:115], v[108:111], v[64:79]
    ds_read_b128 v[96:99], v11 offset:24576
    ds_read_b64_tr_b16 v[100:101], v13 offset:12288
    ds_read_b64_tr_b16 v[102:103], v13 offset:12544
    v_mfma_f32_32x32x16_bf16 v[80:95], v[116:119], v[108:111], v[80:95]
    ds_read_b64_tr_b16 v[104:105], v13 offset:12800
    ds_read_b64_tr_b16 v[106:107], v13 offset:13056
    s_waitcnt lgkmcnt(5)
    v_mfma_f32_32x32x16_bf16 v[64:79], v[124:127], v[120:123], v[64:79]
    s_barrier
    ds_read_b128 v[108:111], v8 offset:32768
    ds_read_b64_tr_b16 v[112:113], v13 offset:16384
    ds_read_b64_tr_b16 v[114:115], v13 offset:16640
    v_mfma_f32_32x32x16_bf16 v[80:95], v[128:131], v[120:123], v[80:95]
    ds_read_b64_tr_b16 v[116:117], v13 offset:16896
    ds_read_b64_tr_b16 v[118:119], v13 offset:17152
    s_waitcnt lgkmcnt(5)
    v_mfma_f32_32x32x16_bf16 v[64:79], v[100:103], v[96:99], v[64:79]
    ds_read_b128 v[120:123], v9 offset:32768
    ds_read_b64_tr_b16 v[124:125], v13 offset:20480
    ds_read_b64_tr_b16 v[126:127], v13 offset:20736
    v_mfma_f32_32x32x16_bf16 v[80:95], v[104:107], v[96:99], v[80:95]
    ds_read_b64_tr_b16 v[128:129], v13 offset:20992
    ds_read_b64_tr_b16 v[130:131], v13 offset:21248
    s_waitcnt lgkmcnt(5)
    v_mfma_f32_32x32x16_bf16 v[64:79], v[112:115], v[108:111], v[64:79]
    ds_read_b128 v[96:99], v10 offset:32768
    ds_read_b64_tr_b16 v[100:101], v13 offset:24576
    ds_read_b64_tr_b16 v[102:103], v13 offset:24832
    v_mfma_f32_32x32x16_bf16 v[80:95], v[116:119], v[108:111], v[80:95]
    ds_read_b64_tr_b16 v[104:105], v13 offset:25088
    ds_read_b64_tr_b16 v[106:107], v13 offset:25344
    s_waitcnt lgkmcnt(5)
    v_mfma_f32_32x32x16_bf16 v[64:79], v[124:127], v[120:123], v[64:79]
    ds_read_b128 v[108:111], v11 offset:32768
    ds_read_b64_tr_b16 v[112:113], v13 offset:28672
    ds_read_b64_tr_b16 v[114:115], v13 offset:28928
    v_mfma_f32_32x32x16_bf16 v[80:95], v[128:131], v[120:123], v[80:95]
    ds_read_b64_tr_b16 v[116:117], v13 offset:29184
    ds_read_b64_tr_b16 v[118:119], v13 offset:29440
    s_waitcnt lgkmcnt(5)
    v_mfma_f32_32x32x16_bf16 v[64:79], v[100:103], v[96:99], v[64:79]
    s_barrier
    ds_read_b128 v[120:123], v8 offset:40960
    ds_read_b64_tr_b16 v[124:125], v13 offset:32768
    ds_read_b64_tr_b16 v[126:127], v13 offset:33024
    v_mfma_f32_32x32x16_bf16 v[80:95], v[104:107], v[96:99], v[80:95]
    ds_read_b64_tr_b16 v[128:129], v13 offset:33280
    ds_read_b64_tr_b16 v[130:131], v13 offset:33536
    s_waitcnt lgkmcnt(5)
    v_mfma_f32_32x32x16_bf16 v[64:79], v[112:115], v[108:111], v[64:79]
    ds_read_b128 v[96:99], v9 offset:40960
    ds_read_b64_tr_b16 v[100:101], v13 offset:36864
    ds_read_b64_tr_b16 v[102:103], v13 offset:37120
    v_mfma_f32_32x32x16_bf16 v[80:95], v[116:119], v[108:111], v[80:95]
    ds_read_b64_tr_b16 v[104:105], v13 offset:37376
    ds_read_b64_tr_b16 v[106:107], v13 offset:37632
    s_waitcnt lgkmcnt(5)
    v_mfma_f32_32x32x16_bf16 v[64:79], v[124:127], v[120:123], v[64:79]
    ds_read_b128 v[108:111], v10 offset:40960
    ds_read_b64_tr_b16 v[112:113], v13 offset:40960
    ds_read_b64_tr_b16 v[114:115], v13 offset:41216
    v_mfma_f32_32x32x16_bf16 v[80:95], v[128:131], v[120:123], v[80:95]
    ds_read_b64_tr_b16 v[116:117], v13 offset:41472
    ds_read_b64_tr_b16 v[118:119], v13 offset:41728
    s_waitcnt lgkmcnt(5)
    v_mfma_f32_32x32x16_bf16 v[64:79], v[100:103], v[96:99], v[64:79]
    ds_read_b128 v[120:123], v11 offset:40960
    ds_read_b64_tr_b16 v[124:125], v13 offset:45056
    ds_read_b64_tr_b16 v[126:127], v13 offset:45312
    v_mfma_f32_32x32x16_bf16 v[80:95], v[104:107], v[96:99], v[80:95]
    ds_read_b64_tr_b16 v[128:129], v13 offset:45568
    ds_read_b64_tr_b16 v[130:131], v13 offset:45824
    s_waitcnt lgkmcnt(5)
    v_mfma_f32_32x32x16_bf16 v[64:79], v[112:115], v[108:111], v[64:79]
    s_barrier
    ds_read_b128 v[96:99], v8 offset:0
    ds_read_b64_tr_b16 v[100:101], v12 offset:0
    ds_read_b64_tr_b16 v[102:103], v12 offset:256
    v_mfma_f32_32x32x16_bf16 v[80:95], v[116:119], v[108:111], v[80:95]
    ds_read_b64_tr_b16 v[104:105], v12 offset:512
    ds_read_b64_tr_b16 v[106:107], v12 offset:768
    s_waitcnt lgkmcnt(5)
    v_mfma_f32_32x32x16_bf16 v[64:79], v[124:127], v[120:123], v[64:79]
    ds_read_b128 v[108:111], v9 offset:0
    ds_read_b64_tr_b16 v[112:113], v12 offset:4096
    ds_read_b64_tr_b16 v[114:115], v12 offset:4352
    v_mfma_f32_32x32x16_bf16 v[80:95], v[128:131], v[120:123], v[80:95]
    ds_read_b64_tr_b16 v[116:117], v12 offset:4608
    ds_read_b64_tr_b16 v[118:119], v12 offset:4864
    s_waitcnt lgkmcnt(5)
    v_mfma_f32_32x32x16_bf16 v[64:79], v[100:103], v[96:99], v[64:79]
    ds_read_b128 v[120:123], v10 offset:0
    ds_read_b64_tr_b16 v[124:125], v12 offset:8192
    ds_read_b64_tr_b16 v[126:127], v12 offset:8448
    v_mfma_f32_32x32x16_bf16 v[80:95], v[104:107], v[96:99], v[80:95]
    ds_read_b64_tr_b16 v[128:129], v12 offset:8704
    ds_read_b64_tr_b16 v[130:131], v12 offset:8960
    s_waitcnt lgkmcnt(5)
    v_mfma_f32_32x32x16_bf16 v[64:79], v[112:115], v[108:111], v[64:79]
    ds_read_b128 v[96:99], v11 offset:0
    ds_read_b64_tr_b16 v[100:101], v12 offset:12288
    ds_read_b64_tr_b16 v[102:103], v12 offset:12544
    v_mfma_f32_32x32x16_bf16 v[80:95], v[116:119], v[108:111], v[80:95]
    ds_read_b64_tr_b16 v[104:105], v12 offset:12800
    ds_read_b64_tr_b16 v[106:107], v12 offset:13056
    s_waitcnt lgkmcnt(5)
    v_mfma_f32_32x32x16_bf16 v[64:79], v[124:127], v[120:123], v[64:79]
    s_barrier
    ds_read_b128 v[108:111], v8 offset:8192
    ds_read_b64_tr_b16 v[112:113], v12 offset:16384
    ds_read_b64_tr_b16 v[114:115], v12 offset:16640
    v_mfma_f32_32x32x16_bf16 v[80:95], v[128:131], v[120:123], v[80:95]
    ds_read_b64_tr_b16 v[116:117], v12 offset:16896
    ds_read_b64_tr_b16 v[118:119], v12 offset:17152
    s_waitcnt lgkmcnt(5)
    v_mfma_f32_32x32x16_bf16 v[64:79], v[100:103], v[96:99], v[64:79]
    ds_read_b128 v[120:123], v9 offset:8192
    ds_read_b64_tr_b16 v[124:125], v12 offset:20480
    ds_read_b64_tr_b16 v[126:127], v12 offset:20736
    v_mfma_f32_32x32x16_bf16 v[80:95], v[104:107], v[96:99], v[80:95]
    ds_read_b64_tr_b16 v[128:129], v12 offset:20992
    ds_read_b64_tr_b16 v[130:131], v12 offset:21248
    s_waitcnt lgkmcnt(5)
    v_mfma_f32_32x32x16_bf16 v[64:79], v[112:115], v[108:111], v[64:79]
    ds_read_b128 v[96:99], v10 offset:8192
    ds_read_b64_tr_b16 v[100:101], v12 offset:24576
    ds_read_b64_tr_b16 v[102:103], v12 offset:24832
    v_mfma_f32_32x32x16_bf16 v[80:95], v[116:119], v[108:111], v[80:95]
    ds_read_b64_tr_b16 v[104:105], v12 offset:25088
    ds_read_b64_tr_b16 v[106:107], v12 offset:25344
    s_waitcnt lgkmcnt(5)
    v_mfma_f32_32x32x16_bf16 v[64:79], v[124:127], v[120:123], v[64:79]
    ds_read_b128 v[108:111], v11 offset:8192
    ds_read_b64_tr_b16 v[112:113], v12 offset:28672
    ds_read_b64_tr_b16 v[114:115], v12 offset:28928
    v_mfma_f32_32x32x16_bf16 v[80:95], v[128:131], v[120:123], v[80:95]
    ds_read_b64_tr_b16 v[116:117], v12 offset:29184
    ds_read_b64_tr_b16 v[118:119], v12 offset:29440
    s_waitcnt lgkmcnt(5)
    v_mfma_f32_32x32x16_bf16 v[64:79], v[100:103], v[96:99], v[64:79]
    s_barrier
    ds_read_b128 v[120:123], v8 offset:16384
    ds_read_b64_tr_b16 v[124:125], v12 offset:32768
    ds_read_b64_tr_b16 v[126:127], v12 offset:33024
    v_mfma_f32_32x32x16_bf16 v[80:95], v[104:107], v[96:99], v[80:95]
    ds_read_b64_tr_b16 v[128:129], v12 offset:33280
    ds_read_b64_tr_b16 v[130:131], v12 offset:33536
    s_waitcnt lgkmcnt(5)
    v_mfma_f32_32x32x16_bf16 v[64:79], v[112:115], v[108:111], v[64:79]
    ds_read_b128 v[96:99], v9 offset:16384
    ds_read_b64_tr_b16 v[100:101], v12 offset:36864
    ds_read_b64_tr_b16 v[102:103], v12 offset:37120
    v_mfma_f32_32x32x16_bf16 v[80:95], v[116:119], v[108:111], v[80:95]
    ds_read_b64_tr_b16 v[104:105], v12 offset:37376
    ds_read_b64_tr_b16 v[106:107], v12 offset:37632
    s_waitcnt lgkmcnt(5)
    v_mfma_f32_32x32x16_bf16 v[64:79], v[124:127], v[120:123], v[64:79]
    ds_read_b128 v[108:111], v10 offset:16384
    ds_read_b64_tr_b16 v[112:113], v12 offset:40960
    ds_read_b64_tr_b16 v[114:115], v12 offset:41216
    v_mfma_f32_32x32x16_bf16 v[80:95], v[128:131], v[120:123], v[80:95]
    ds_read_b64_tr_b16 v[116:117], v12 offset:41472
    ds_read_b64_tr_b16 v[118:119], v12 offset:41728
    s_waitcnt lgkmcnt(5)
    v_mfma_f32_32x32x16_bf16 v[64:79], v[100:103], v[96:99], v[64:79]
    ds_read_b128 v[120:123], v11 offset:16384
    ds_read_b64_tr_b16 v[124:125], v12 offset:45056
    ds_read_b64_tr_b16 v[126:127], v12 offset:45312
    v_mfma_f32_32x32x16_bf16 v[80:95], v[104:107], v[96:99], v[80:95]
    ds_read_b64_tr_b16 v[128:129], v12 offset:45568
    ds_read_b64_tr_b16 v[130:131], v12 offset:45824
    s_waitcnt lgkmcnt(5)
    v_mfma_f32_32x32x16_bf16 v[64:79], v[112:115], v[108:111], v[64:79]
    s_barrier
    ds_read_b128 v[96:99], v8 offset:24576
    ds_read_b64_tr_b16 v[100:101], v13 offset:0
    ds_read_b64_tr_b16 v[102:103], v13 offset:256
    v_mfma_f32_32x32x16_bf16 v[80:95], v[116:119], v[108:111], v[80:95]
    ds_read_b64_tr_b16 v[104:105], v13 offset:512
    ds_read_b64_tr_b16 v[106:107], v13 offset:768
    s_waitcnt lgkmcnt(5)
    v_mfma_f32_32x32x16_bf16 v[64:79], v[124:127], v[120:123], v[64:79]
    ds_read_b128 v[108:111], v9 offset:24576
    ds_read_b64_tr_b16 v[112:113], v13 offset:4096
    ds_read_b64_tr_b16 v[114:115], v13 offset:4352
    v_mfma_f32_32x32x16_bf16 v[80:95], v[128:131], v[120:123], v[80:95]
    ds_read_b64_tr_b16 v[116:117], v13 offset:4608
    ds_read_b64_tr_b16 v[118:119], v13 offset:4864
    s_waitcnt lgkmcnt(5)
    v_mfma_f32_32x32x16_bf16 v[64:79], v[100:103], v[96:99], v[64:79]
    ds_read_b128 v[120:123], v10 offset:24576
    ds_read_b64_tr_b16 v[124:125], v13 offset:8192
    ds_read_b64_tr_b16 v[126:127], v13 offset:8448
    v_mfma_f32_32x32x16_bf16 v[80:95], v[104:107], v[96:99], v[80:95]
    ds_read_b64_tr_b16 v[128:129], v13 offset:8704
    ds_read_b64_tr_b16 v[130:131], v13 offset:8960
    s_waitcnt lgkmcnt(5)
    v_mfma_f32_32x32x16_bf16 v[64:79], v[112:115], v[108:111], v[64:79]
    ds_read_b128 v[96:99], v11 offset:24576
    ds_read_b64_tr_b16 v[100:101], v13 offset:12288
    ds_read_b64_tr_b16 v[102:103], v13 offset:12544
    v_mfma_f32_32x32x16_bf16 v[80:95], v[116:119], v[108:111], v[80:95]
    ds_read_b64_tr_b16 v[104:105], v13 offset:12800
    ds_read_b64_tr_b16 v[106:107], v13 offset:13056
    s_waitcnt lgkmcnt(5)
    v_mfma_f32_32x32x16_bf16 v[64:79], v[124:127], v[120:123], v[64:79]
    s_barrier
    ds_read_b128 v[108:111], v8 offset:32768
    ds_read_b64_tr_b16 v[112:113], v13 offset:16384
    ds_read_b64_tr_b16 v[114:115], v13 offset:16640
    v_mfma_f32_32x32x16_bf16 v[80:95], v[128:131], v[120:123], v[80:95]
    ds_read_b64_tr_b16 v[116:117], v13 offset:16896
    ds_read_b64_tr_b16 v[118:119], v13 offset:17152
    s_waitcnt lgkmcnt(5)
    v_mfma_f32_32x32x16_bf16 v[64:79], v[100:103], v[96:99], v[64:79]
    ds_read_b128 v[120:123], v9 offset:32768
    ds_read_b64_tr_b16 v[124:125], v13 offset:20480
    ds_read_b64_tr_b16 v[126:127], v13 offset:20736
    v_mfma_f32_32x32x16_bf16 v[80:95], v[104:107], v[96:99], v[80:95]
    ds_read_b64_tr_b16 v[128:129], v13 offset:20992
    ds_read_b64_tr_b16 v[130:131], v13 offset:21248
    s_waitcnt lgkmcnt(5)
    v_mfma_f32_32x32x16_bf16 v[64:79], v[112:115], v[108:111], v[64:79]
    ds_read_b128 v[96:99], v10 offset:32768
    ds_read_b64_tr_b16 v[100:101], v13 offset:24576
    ds_read_b64_tr_b16 v[102:103], v13 offset:24832
    v_mfma_f32_32x32x16_bf16 v[80:95], v[116:119], v[108:111], v[80:95]
    ds_read_b64_tr_b16 v[104:105], v13 offset:25088
    ds_read_b64_tr_b16 v[106:107], v13 offset:25344
    buffer_load_dwordx4 v[160:163], v21, s[64:67], s35 offen
    s_waitcnt lgkmcnt(5)
    v_mfma_f32_32x32x16_bf16 v[64:79], v[124:127], v[120:123], v[64:79]
    ds_read_b128 v[108:111], v11 offset:32768
    ds_read_b64_tr_b16 v[112:113], v13 offset:28672
    ds_read_b64_tr_b16 v[114:115], v13 offset:28928
    v_mfma_f32_32x32x16_bf16 v[80:95], v[128:131], v[120:123], v[80:95]
    ds_read_b64_tr_b16 v[116:117], v13 offset:29184
    ds_read_b64_tr_b16 v[118:119], v13 offset:29440
    buffer_load_dwordx4 v[192:195], v21, s[68:71], s35 offen
    s_add_u32 s35, s35, 7168
    s_waitcnt lgkmcnt(5)
    v_mfma_f32_32x32x16_bf16 v[64:79], v[100:103], v[96:99], v[64:79]
    s_barrier
    ds_read_b128 v[120:123], v8 offset:40960
    ds_read_b64_tr_b16 v[124:125], v13 offset:32768
    ds_read_b64_tr_b16 v[126:127], v13 offset:33024
    v_mfma_f32_32x32x16_bf16 v[80:95], v[104:107], v[96:99], v[80:95]
    ds_read_b64_tr_b16 v[128:129], v13 offset:33280
    ds_read_b64_tr_b16 v[130:131], v13 offset:33536
    buffer_load_dwordx4 v[164:167], v21, s[64:67], s35 offen
    s_waitcnt lgkmcnt(5)
    v_mfma_f32_32x32x16_bf16 v[64:79], v[112:115], v[108:111], v[64:79]
    ds_read_b128 v[96:99], v9 offset:40960
    ds_read_b64_tr_b16 v[100:101], v13 offset:36864
    ds_read_b64_tr_b16 v[102:103], v13 offset:37120
    v_mfma_f32_32x32x16_bf16 v[80:95], v[116:119], v[108:111], v[80:95]
    ds_read_b64_tr_b16 v[104:105], v13 offset:37376
    ds_read_b64_tr_b16 v[106:107], v13 offset:37632
    buffer_load_dwordx4 v[196:199], v21, s[68:71], s35 offen
    s_add_u32 s35, s35, 7168
    s_waitcnt lgkmcnt(5)
    v_mfma_f32_32x32x16_bf16 v[64:79], v[124:127], v[120:123], v[64:79]
    ds_read_b128 v[108:111], v10 offset:40960
    ds_read_b64_tr_b16 v[112:113], v13 offset:40960
    ds_read_b64_tr_b16 v[114:115], v13 offset:41216
    v_mfma_f32_32x32x16_bf16 v[80:95], v[128:131], v[120:123], v[80:95]
    ds_read_b64_tr_b16 v[116:117], v13 offset:41472
    ds_read_b64_tr_b16 v[118:119], v13 offset:41728
    buffer_load_dwordx4 v[168:171], v21, s[64:67], s35 offen
    s_waitcnt lgkmcnt(5)
    v_mfma_f32_32x32x16_bf16 v[64:79], v[100:103], v[96:99], v[64:79]
    ds_read_b128 v[120:123], v11 offset:40960
    ds_read_b64_tr_b16 v[124:125], v13 offset:45056
    ds_read_b64_tr_b16 v[126:127], v13 offset:45312
    v_mfma_f32_32x32x16_bf16 v[80:95], v[104:107], v[96:99], v[80:95]
    ds_read_b64_tr_b16 v[128:129], v13 offset:45568
    ds_read_b64_tr_b16 v[130:131], v13 offset:45824
    buffer_load_dwordx4 v[200:203], v21, s[68:71], s35 offen
    s_add_u32 s35, s35, 7168
    s_waitcnt lgkmcnt(5)
    v_mfma_f32_32x32x16_bf16 v[64:79], v[112:115], v[108:111], v[64:79]
    s_barrier
    ds_read_b128 v[96:99], v8 offset:0
    ds_read_b64_tr_b16 v[100:101], v12 offset:0
    ds_read_b64_tr_b16 v[102:103], v12 offset:256
    v_mfma_f32_32x32x16_bf16 v[80:95], v[116:119], v[108:111], v[80:95]
    ds_read_b64_tr_b16 v[104:105], v12 offset:512
    ds_read_b64_tr_b16 v[106:107], v12 offset:768
    buffer_load_dwordx4 v[172:175], v21, s[64:67], s35 offen
    s_waitcnt lgkmcnt(5)
    v_mfma_f32_32x32x16_bf16 v[64:79], v[124:127], v[120:123], v[64:79]
    ds_read_b128 v[108:111], v9 offset:0
    ds_read_b64_tr_b16 v[112:113], v12 offset:4096
    ds_read_b64_tr_b16 v[114:115], v12 offset:4352
    v_mfma_f32_32x32x16_bf16 v[80:95], v[128:131], v[120:123], v[80:95]
    ds_read_b64_tr_b16 v[116:117], v12 offset:4608
    ds_read_b64_tr_b16 v[118:119], v12 offset:4864
    buffer_load_dwordx4 v[204:207], v21, s[68:71], s35 offen
    s_add_u32 s35, s35, 7168
    s_waitcnt lgkmcnt(5)
    v_mfma_f32_32x32x16_bf16 v[64:79], v[100:103], v[96:99], v[64:79]
    ds_read_b128 v[120:123], v10 offset:0
    ds_read_b64_tr_b16 v[124:125], v12 offset:8192
    ds_read_b64_tr_b16 v[126:127], v12 offset:8448
    v_mfma_f32_32x32x16_bf16 v[80:95], v[104:107], v[96:99], v[80:95]
    ds_read_b64_tr_b16 v[128:129], v12 offset:8704
    ds_read_b64_tr_b16 v[130:131], v12 offset:8960
    buffer_load_dwordx4 v[176:179], v21, s[64:67], s35 offen
    s_waitcnt lgkmcnt(5)
    v_mfma_f32_32x32x16_bf16 v[64:79], v[112:115], v[108:111], v[64:79]
    ds_read_b128 v[96:99], v11 offset:0
    ds_read_b64_tr_b16 v[100:101], v12 offset:12288
    ds_read_b64_tr_b16 v[102:103], v12 offset:12544
    v_mfma_f32_32x32x16_bf16 v[80:95], v[116:119], v[108:111], v[80:95]
    ds_read_b64_tr_b16 v[104:105], v12 offset:12800
    ds_read_b64_tr_b16 v[106:107], v12 offset:13056
    buffer_load_dwordx4 v[208:211], v21, s[68:71], s35 offen
    s_add_u32 s35, s35, 7168
    s_waitcnt lgkmcnt(5)
    v_mfma_f32_32x32x16_bf16 v[64:79], v[124:127], v[120:123], v[64:79]
    s_barrier
    ds_read_b128 v[108:111], v8 offset:8192
    ds_read_b64_tr_b16 v[112:113], v12 offset:16384
    ds_read_b64_tr_b16 v[114:115], v12 offset:16640
    v_mfma_f32_32x32x16_bf16 v[80:95], v[128:131], v[120:123], v[80:95]
    ds_read_b64_tr_b16 v[116:117], v12 offset:16896
    ds_read_b64_tr_b16 v[118:119], v12 offset:17152
    buffer_load_dwordx4 v[180:183], v21, s[64:67], s35 offen
    s_waitcnt lgkmcnt(5)
    v_mfma_f32_32x32x16_bf16 v[64:79], v[100:103], v[96:99], v[64:79]
    ds_read_b128 v[120:123], v9 offset:8192
    ds_read_b64_tr_b16 v[124:125], v12 offset:20480
    ds_read_b64_tr_b16 v[126:127], v12 offset:20736
    v_mfma_f32_32x32x16_bf16 v[80:95], v[104:107], v[96:99], v[80:95]
    ds_read_b64_tr_b16 v[128:129], v12 offset:20992
    ds_read_b64_tr_b16 v[130:131], v12 offset:21248
    buffer_load_dwordx4 v[212:215], v21, s[68:71], s35 offen
    s_add_u32 s35, s35, 7168
    s_waitcnt lgkmcnt(5)
    v_mfma_f32_32x32x16_bf16 v[64:79], v[112:115], v[108:111], v[64:79]
    ds_read_b128 v[96:99], v10 offset:8192
    ds_read_b64_tr_b16 v[100:101], v12 offset:24576
    ds_read_b64_tr_b16 v[102:103], v12 offset:24832
    v_mfma_f32_32x32x16_bf16 v[80:95], v[116:119], v[108:111], v[80:95]
    ds_read_b64_tr_b16 v[104:105], v12 offset:25088
    ds_read_b64_tr_b16 v[106:107], v12 offset:25344
    buffer_load_dwordx4 v[184:187], v21, s[64:67], s35 offen
    s_waitcnt lgkmcnt(5)
    v_mfma_f32_32x32x16_bf16 v[64:79], v[124:127], v[120:123], v[64:79]
    ds_read_b128 v[108:111], v11 offset:8192
    ds_read_b64_tr_b16 v[112:113], v12 offset:28672
    ds_read_b64_tr_b16 v[114:115], v12 offset:28928
    v_mfma_f32_32x32x16_bf16 v[80:95], v[128:131], v[120:123], v[80:95]
    ds_read_b64_tr_b16 v[116:117], v12 offset:29184
    ds_read_b64_tr_b16 v[118:119], v12 offset:29440
    buffer_load_dwordx4 v[216:219], v21, s[68:71], s35 offen
    s_add_u32 s35, s35, 7168
    s_waitcnt lgkmcnt(5)
    v_mfma_f32_32x32x16_bf16 v[64:79], v[100:103], v[96:99], v[64:79]
    s_barrier
    ds_read_b128 v[120:123], v8 offset:16384
    ds_read_b64_tr_b16 v[124:125], v12 offset:32768
    ds_read_b64_tr_b16 v[126:127], v12 offset:33024
    v_mfma_f32_32x32x16_bf16 v[80:95], v[104:107], v[96:99], v[80:95]
    ds_read_b64_tr_b16 v[128:129], v12 offset:33280
    ds_read_b64_tr_b16 v[130:131], v12 offset:33536
    buffer_load_dwordx4 v[188:191], v21, s[64:67], s35 offen
    s_waitcnt lgkmcnt(5)
    v_mfma_f32_32x32x16_bf16 v[64:79], v[112:115], v[108:111], v[64:79]
    ds_read_b128 v[96:99], v9 offset:16384
    ds_read_b64_tr_b16 v[100:101], v12 offset:36864
    ds_read_b64_tr_b16 v[102:103], v12 offset:37120
    v_mfma_f32_32x32x16_bf16 v[80:95], v[116:119], v[108:111], v[80:95]
    ds_read_b64_tr_b16 v[104:105], v12 offset:37376
    ds_read_b64_tr_b16 v[106:107], v12 offset:37632
    buffer_load_dwordx4 v[220:223], v21, s[68:71], s35 offen
    s_add_u32 s35, s35, 7168
    s_waitcnt lgkmcnt(5)
    v_mfma_f32_32x32x16_bf16 v[64:79], v[124:127], v[120:123], v[64:79]
    ds_read_b128 v[108:111], v10 offset:16384
    ds_read_b64_tr_b16 v[112:113], v12 offset:40960
    ds_read_b64_tr_b16 v[114:115], v12 offset:41216
    v_mfma_f32_32x32x16_bf16 v[80:95], v[128:131], v[120:123], v[80:95]
    ds_read_b64_tr_b16 v[116:117], v12 offset:41472
    ds_read_b64_tr_b16 v[118:119], v12 offset:41728
    buffer_load_dwordx4 v[224:227], v22, s[72:75], s36 offen
    s_waitcnt lgkmcnt(5)
    v_mfma_f32_32x32x16_bf16 v[64:79], v[100:103], v[96:99], v[64:79]
    ds_read_b128 v[120:123], v11 offset:16384
    ds_read_b64_tr_b16 v[124:125], v12 offset:45056
    ds_read_b64_tr_b16 v[126:127], v12 offset:45312
    v_mfma_f32_32x32x16_bf16 v[80:95], v[104:107], v[96:99], v[80:95]
    ds_read_b64_tr_b16 v[128:129], v12 offset:45568
    ds_read_b64_tr_b16 v[130:131], v12 offset:45824
    buffer_load_dwordx4 v[228:231], v22, s[72:75], s36 offen offset:2048
    s_add_u32 s36, s36, 4096
    s_waitcnt lgkmcnt(5)
    v_mfma_f32_32x32x16_bf16 v[64:79], v[112:115], v[108:111], v[64:79]
    s_barrier
    ds_read_b128 v[96:99], v8 offset:24576
    ds_read_b64_tr_b16 v[100:101], v13 offset:0
    ds_read_b64_tr_b16 v[102:103], v13 offset:256
    v_mfma_f32_32x32x16_bf16 v[80:95], v[116:119], v[108:111], v[80:95]
    ds_read_b64_tr_b16 v[104:105], v13 offset:512
    ds_read_b64_tr_b16 v[106:107], v13 offset:768
    buffer_load_dwordx4 v[232:235], v22, s[72:75], s36 offen
    s_waitcnt lgkmcnt(5)
    v_mfma_f32_32x32x16_bf16 v[64:79], v[124:127], v[120:123], v[64:79]
    ds_read_b128 v[108:111], v9 offset:24576
    ds_read_b64_tr_b16 v[112:113], v13 offset:4096
    ds_read_b64_tr_b16 v[114:115], v13 offset:4352
    v_mfma_f32_32x32x16_bf16 v[80:95], v[128:131], v[120:123], v[80:95]
    ds_read_b64_tr_b16 v[116:117], v13 offset:4608
    ds_read_b64_tr_b16 v[118:119], v13 offset:4864
    buffer_load_dwordx4 v[236:239], v22, s[72:75], s36 offen offset:2048
    s_add_u32 s36, s36, 4096
    s_waitcnt lgkmcnt(5)
    v_mfma_f32_32x32x16_bf16 v[64:79], v[100:103], v[96:99], v[64:79]
    ds_read_b128 v[120:123], v10 offset:24576
    ds_read_b64_tr_b16 v[124:125], v13 offset:8192
    ds_read_b64_tr_b16 v[126:127], v13 offset:8448
    v_mfma_f32_32x32x16_bf16 v[80:95], v[104:107], v[96:99], v[80:95]
    ds_read_b64_tr_b16 v[128:129], v13 offset:8704
    ds_read_b64_tr_b16 v[130:131], v13 offset:8960
    buffer_load_dwordx4 v[240:243], v22, s[72:75], s36 offen
    s_waitcnt lgkmcnt(5)
    v_mfma_f32_32x32x16_bf16 v[64:79], v[112:115], v[108:111], v[64:79]
    ds_read_b128 v[96:99], v11 offset:24576
    ds_read_b64_tr_b16 v[100:101], v13 offset:12288
    ds_read_b64_tr_b16 v[102:103], v13 offset:12544
    v_mfma_f32_32x32x16_bf16 v[80:95], v[116:119], v[108:111], v[80:95]
    ds_read_b64_tr_b16 v[104:105], v13 offset:12800
    ds_read_b64_tr_b16 v[106:107], v13 offset:13056
    buffer_load_dwordx4 v[244:247], v22, s[72:75], s36 offen offset:2048
    s_add_u32 s36, s36, 4096
    s_waitcnt lgkmcnt(5)
    v_mfma_f32_32x32x16_bf16 v[64:79], v[124:127], v[120:123], v[64:79]
    ds_read_b128 v[140:143], v18 offset:0
    ds_read_b128 v[144:147], v18 offset:16
    v_mfma_f32_32x32x16_bf16 v[80:95], v[128:131], v[120:123], v[80:95]
    ds_read_b128 v[148:151], v18 offset:512
    ds_read_b128 v[152:155], v18 offset:528
    buffer_load_dwordx4 v[248:251], v22, s[72:75], s36 offen
    s_waitcnt lgkmcnt(4)
    v_mfma_f32_32x32x16_bf16 v[64:79], v[100:103], v[96:99], v[64:79]
    v_mfma_f32_32x32x16_bf16 v[80:95], v[104:107], v[96:99], v[80:95]
    buffer_load_dwordx4 v[252:255], v22, s[72:75], s36 offen offset:2048
    s_add_u32 s36, s36, 4096
    s_nop 7
    ds_write_b128 v41, v[64:67] offset:0
    ds_write_b128 v41, v[68:71] offset:256
    ds_write_b128 v42, v[72:75] offset:0
    ds_write_b128 v42, v[76:79] offset:256
    s_nop 3
    ds_write_b128 v43, v[80:83] offset:0
    ds_write_b128 v43, v[84:87] offset:256
    ds_write_b128 v44, v[88:91] offset:0
    ds_write_b128 v44, v[92:95] offset:256
    s_waitcnt vmcnt(24)
    s_branch L_ke_phase2b
L_ke_phase2:
    s_waitcnt vmcnt(0)
L_ke_phase2b:
    s_waitcnt lgkmcnt(0)
    s_barrier
    ds_read_b128 v[96:99], v20 offset:0
    ds_read_b128 v[100:103], v20 offset:256
    ds_read_b128 v[104:107], v40 offset:0
    ds_read_b128 v[108:111], v40 offset:256
    v_mov_b32 v28, 0
    v_mov_b32 v29, 0
    v_mov_b32 v30, 0
    v_mov_b32 v31, 0
    v_mov_b32 v32, 0
    v_mov_b32 v33, 0
    v_mov_b32 v34, 0
    v_mov_b32 v35, 0
    v_mov_b32 v36, 0
    v_mov_b32 v37, 0
    v_mov_b32 v38, 0
    v_mov_b32 v39, 0
    s_waitcnt lgkmcnt(2)
    v_lshlrev_b32 v24, 16, v132
    v_lshlrev_b32 v26, 16, v133
    v_and_b32 v25, 0xffff0000, v132
    v_and_b32 v27, 0xffff0000, v133
    v_pk_fma_f32 v[24:25], v[140:141], v[96:97], v[24:25]
    v_pk_fma_f32 v[26:27], v[142:143], v[98:99], v[26:27]
    v_cvt_pk_bf16_f32 v132, v24, v25
    v_cvt_pk_bf16_f32 v133, v26, v27
    v_lshlrev_b32 v96, 16, v132
    v_lshlrev_b32 v98, 16, v133
    v_and_b32 v97, 0xffff0000, v132
    v_and_b32 v99, 0xffff0000, v133
    v_pk_add_f32 v[28:29], v[28:29], v[96:97]
    v_pk_add_f32 v[28:29], v[28:29], v[98:99]
    v_pk_fma_f32 v[30:31], v[96:97], v[96:97], v[30:31]
    v_pk_fma_f32 v[30:31], v[98:99], v[98:99], v[30:31]
    v_pk_fma_f32 v[32:33], v[96:97], v[148:149], v[32:33]
    v_pk_fma_f32 v[32:33], v[98:99], v[150:151], v[32:33]
    v_lshlrev_b32 v24, 16, v134
    v_lshlrev_b32 v26, 16, v135
    v_and_b32 v25, 0xffff0000, v134
    v_and_b32 v27, 0xffff0000, v135
    v_pk_fma_f32 v[24:25], v[144:145], v[100:101], v[24:25]
    v_pk_fma_f32 v[26:27], v[146:147], v[102:103], v[26:27]
    v_cvt_pk_bf16_f32 v134, v24, v25
    v_cvt_pk_bf16_f32 v135, v26, v27
    v_lshlrev_b32 v100, 16, v134
    v_lshlrev_b32 v102, 16, v135
    v_and_b32 v101, 0xffff0000, v134
    v_and_b32 v103, 0xffff0000, v135
    v_pk_add_f32 v[28:29], v[28:29], v[100:101]
    v_pk_add_f32 v[28:29], v[28:29], v[102:103]
    v_pk_fma_f32 v[30:31], v[100:101], v[100:101], v[30:31]
    v_pk_fma_f32 v[30:31], v[102:103], v[102:103], v[30:31]
    v_pk_fma_f32 v[32:33], v[100:101], v[152:153], v[32:33]
    v_pk_fma_f32 v[32:33], v[102:103], v[154:155], v[32:33]
    s_waitcnt lgkmcnt(0)
    v_lshlrev_b32 v24, 16, v136
    v_lshlrev_b32 v26, 16, v137
    v_and_b32 v25, 0xffff0000, v136
    v_and_b32 v27, 0xffff0000, v137
    v_pk_fma_f32 v[24:25], v[140:141], v[104:105], v[24:25]
    v_pk_fma_f32 v[26:27], v[142:143], v[106:107], v[26:27]
    v_cvt_pk_bf16_f32 v136, v24, v25
    v_cvt_pk_bf16_f32 v137, v26, v27
    v_lshlrev_b32 v104, 16, v136
    v_lshlrev_b32 v106, 16, v137
    v_and_b32 v105, 0xffff0000, v136
    v_and_b32 v107, 0xffff0000, v137
    v_pk_add_f32 v[34:35], v[34:35], v[104:105]
    v_pk_add_f32 v[34:35], v[34:35], v[106:107]
    v_pk_fma_f32 v[36:37], v[104:105], v[104:105], v[36:37]
    v_pk_fma_f32 v[36:37], v[106:107], v[106:107], v[36:37]
    v_pk_fma_f32 v[38:39], v[104:105], v[148:149], v[38:39]
    v_pk_fma_f32 v[38:39], v[106:107], v[150:151], v[38:39]
    v_lshlrev_b32 v24, 16, v138
    v_lshlrev_b32 v26, 16, v139
    v_and_b32 v25, 0xffff0000, v138
    v_and_b32 v27, 0xffff0000, v139
    v_pk_fma_f32 v[24:25], v[144:145], v[108:109], v[24:25]
    v_pk_fma_f32 v[26:27], v[146:147], v[110:111], v[26:27]
    v_cvt_pk_bf16_f32 v138, v24, v25
    v_cvt_pk_bf16_f32 v139, v26, v27
    v_lshlrev_b32 v108, 16, v138
    v_lshlrev_b32 v110, 16, v139
    v_and_b32 v109, 0xffff0000, v138
    v_and_b32 v111, 0xffff0000, v139
    v_pk_add_f32 v[34:35], v[34:35], v[108:109]
    v_pk_add_f32 v[34:35], v[34:35], v[110:111]
    v_pk_fma_f32 v[36:37], v[108:109], v[108:109], v[36:37]
    v_pk_fma_f32 v[36:37], v[110:111], v[110:111], v[36:37]
    v_pk_fma_f32 v[38:39], v[108:109], v[152:153], v[38:39]
    v_pk_fma_f32 v[38:39], v[110:111], v[154:155], v[38:39]
    v_add_f32 v48, v28, v29
    v_add_f32 v49, v30, v31
    v_add_f32 v50, v32, v33
    v_add_f32 v52, v34, v35
    v_add_f32 v53, v36, v37
    v_add_f32 v54, v38, v39
    v_add_f32_dpp v48, v48, v48 quad_perm:[1,0,3,2] row_mask:0xf bank_mask:0xf
    v_add_f32_dpp v49, v49, v49 quad_perm:[1,0,3,2] row_mask:0xf bank_mask:0xf
    v_add_f32_dpp v50, v50, v50 quad_perm:[1,0,3,2] row_mask:0xf bank_mask:0xf
    v_add_f32_dpp v52, v52, v52 quad_perm:[1,0,3,2] row_mask:0xf bank_mask:0xf
    v_add_f32_dpp v53, v53, v53 quad_perm:[1,0,3,2] row_mask:0xf bank_mask:0xf
    v_add_f32_dpp v54, v54, v54 quad_perm:[1,0,3,2] row_mask:0xf bank_mask:0xf
    v_add_f32_dpp v48, v48, v48 quad_perm:[2,3,0,1] row_mask:0xf bank_mask:0xf
    v_add_f32_dpp v49, v49, v49 quad_perm:[2,3,0,1] row_mask:0xf bank_mask:0xf
    v_add_f32_dpp v50, v50, v50 quad_perm:[2,3,0,1] row_mask:0xf bank_mask:0xf
    v_add_f32_dpp v52, v52, v52 quad_perm:[2,3,0,1] row_mask:0xf bank_mask:0xf
    v_add_f32_dpp v53, v53, v53 quad_perm:[2,3,0,1] row_mask:0xf bank_mask:0xf
    v_add_f32_dpp v54, v54, v54 quad_perm:[2,3,0,1] row_mask:0xf bank_mask:0xf
    v_add_f32_dpp v48, v48, v48 row_half_mirror row_mask:0xf bank_mask:0xf
    v_add_f32_dpp v49, v49, v49 row_half_mirror row_mask:0xf bank_mask:0xf
    v_add_f32_dpp v50, v50, v50 row_half_mirror row_mask:0xf bank_mask:0xf
    v_add_f32_dpp v52, v52, v52 row_half_mirror row_mask:0xf bank_mask:0xf
    v_add_f32_dpp v53, v53, v53 row_half_mirror row_mask:0xf bank_mask:0xf
    v_add_f32_dpp v54, v54, v54 row_half_mirror row_mask:0xf bank_mask:0xf
    v_add_f32_dpp v48, v48, v48 row_mirror row_mask:0xf bank_mask:0xf
    v_add_f32_dpp v49, v49, v49 row_mirror row_mask:0xf bank_mask:0xf
    v_add_f32_dpp v50, v50, v50 row_mirror row_mask:0xf bank_mask:0xf
    v_add_f32_dpp v52, v52, v52 row_mirror row_mask:0xf bank_mask:0xf
    v_add_f32_dpp v53, v53, v53 row_mirror row_mask:0xf bank_mask:0xf
    v_add_f32_dpp v54, v54, v54 row_mirror row_mask:0xf bank_mask:0xf
    v_mov_b32_dpp v48, v52 quad_perm:[0,1,2,3] row_mask:0xf bank_mask:0xc
    v_mov_b32_dpp v49, v53 quad_perm:[0,1,2,3] row_mask:0xf bank_mask:0xc
    v_mov_b32_dpp v50, v54 quad_perm:[0,1,2,3] row_mask:0xf bank_mask:0xc
    s_mov_b32 exec_lo, 0x01010101
    s_mov_b32 exec_hi, 0x01010101
    buffer_store_dwordx4 v[48:51], v19, s[56:59], s41 offen
    s_add_u32 s41, s41, 688128
    buffer_store_dwordx4 v[48:51], v19, s[56:59], s41 offen sc1
    s_mov_b64 exec, -1
    buffer_load_dwordx3 v[120:122], v45, s[56:59], s42 offen sc1
    v_mov_b32 v24, 151040
    ds_read_b128 v[112:115], v18 offset:1024
    ds_read_b128 v[140:143], v18 offset:1536
    ds_read_b128 v[148:151], v18 offset:2048
    ds_read_b128 v[116:119], v18 offset:1040
    ds_read_b128 v[144:147], v18 offset:1552
    ds_read_b128 v[152:155], v18 offset:2064
    ds_read_b64 v[128:129], v24
    s_mov_b32 s52, 0x3a800000
    s_mov_b32 s53, 0
    s_cmp_ge_u32 s43, 4
    s_cbranch_scc1 L_ke_x1
    s_mov_b32 s44, 0x05040100
    s_mov_b32 s45, 0x07060302
    v_lshrrev_b32 v5, 3, v2
    v_and_b32 v6, 7, v2
    v_xor_b32 v7, v5, v6
    v_lshlrev_b32 v7, 4, v7
    v_lshl_add_u32 v8, v6, 12, v7
    s_lshl_b32 s37, s30, 7
    s_add_u32 s37, s37, 81920
    v_add_u32 v8, s37, v8
    v_lshl_add_u32 v9, v6, 10, v7
    s_lshl_b32 s37, s30, 13
    v_add_u32 v9, s37, v9
    s_waitcnt vmcnt(3)
    v_perm_b32 v64, v164, v160, s44
    v_perm_b32 v65, v172, v168, s44
    v_perm_b32 v66, v180, v176, s44
    v_perm_b32 v67, v188, v184, s44
    ds_write_b128 v8, v[64:67] offset:0
    v_perm_b32 v68, v164, v160, s45
    v_perm_b32 v69, v172, v168, s45
    v_perm_b32 v70, v180, v176, s45
    v_perm_b32 v71, v188, v184, s45
    ds_write_b128 v8, v[68:71] offset:512
    v_perm_b32 v72, v165, v161, s44
    v_perm_b32 v73, v173, v169, s44
    v_perm_b32 v74, v181, v177, s44
    v_perm_b32 v75, v189, v185, s44
    ds_write_b128 v8, v[72:75] offset:1024
    v_perm_b32 v76, v165, v161, s45
    v_perm_b32 v77, v173, v169, s45
    v_perm_b32 v78, v181, v177, s45
    v_perm_b32 v79, v189, v185, s45
    ds_write_b128 v8, v[76:79] offset:1536
    v_perm_b32 v80, v166, v162, s44
    v_perm_b32 v81, v174, v170, s44
    v_perm_b32 v82, v182, v178, s44
    v_perm_b32 v83, v190, v186, s44
    ds_write_b128 v8, v[80:83] offset:2048
    v_perm_b32 v84, v166, v162, s45
    v_perm_b32 v85, v174, v170, s45
    v_perm_b32 v86, v182, v178, s45
    v_perm_b32 v87, v190, v186, s45
    ds_write_b128 v8, v[84:87] offset:2560
    v_perm_b32 v88, v167, v163, s44
    v_perm_b32 v89, v175, v171, s44
    v_perm_b32 v90, v183, v179, s44
    v_perm_b32 v91, v191, v187, s44
    ds_write_b128 v8, v[88:91] offset:3072
    v_perm_b32 v92, v167, v163, s45
    v_perm_b32 v93, v175, v171, s45
    v_perm_b32 v94, v183, v179, s45
    v_perm_b32 v95, v191, v187, s45
    ds_write_b128 v8, v[92:95] offset:3584
    v_perm_b32 v64, v196, v192, s44
    v_perm_b32 v65, v204, v200, s44
    v_perm_b32 v66, v212, v208, s44
    v_perm_b32 v67, v220, v216, s44
    ds_write_b128 v8, v[64:67] offset:32768
    v_perm_b32 v68, v196, v192, s45
    v_perm_b32 v69, v204, v200, s45
    v_perm_b32 v70, v212, v208, s45
    v_perm_b32 v71, v220, v216, s45
    ds_write_b128 v8, v[68:71] offset:33280
    v_perm_b32 v72, v197, v193, s44
    v_perm_b32 v73, v205, v201, s44
    v_perm_b32 v74, v213, v209, s44
    v_perm_b32 v75, v221, v217, s44
    ds_write_b128 v8, v[72:75] offset:33792
    v_perm_b32 v76, v197, v193, s45
    v_perm_b32 v77, v205, v201, s45
    v_perm_b32 v78, v213, v209, s45
    v_perm_b32 v79, v221, v217, s45
    ds_write_b128 v8, v[76:79] offset:34304
    v_perm_b32 v80, v198, v194, s44
    v_perm_b32 v81, v206, v202, s44
    v_perm_b32 v82, v214, v210, s44
    v_perm_b32 v83, v222, v218, s44
    ds_write_b128 v8, v[80:83] offset:34816
    v_perm_b32 v84, v198, v194, s45
    v_perm_b32 v85, v206, v202, s45
    v_perm_b32 v86, v214, v210, s45
    v_perm_b32 v87, v222, v218, s45
    ds_write_b128 v8, v[84:87] offset:35328
    v_perm_b32 v88, v199, v195, s44
    v_perm_b32 v89, v207, v203, s44
    v_perm_b32 v90, v215, v211, s44
    v_perm_b32 v91, v223, v219, s44
    ds_write_b128 v8, v[88:91] offset:35840
    v_perm_b32 v92, v199, v195, s45
    v_perm_b32 v93, v207, v203, s45
    v_perm_b32 v94, v215, v211, s45
    v_perm_b32 v95, v223, v219, s45
    ds_write_b128 v8, v[92:95] offset:36352
    v_perm_b32 v64, v228, v224, s44
    v_perm_b32 v65, v236, v232, s44
    v_perm_b32 v66, v244, v240, s44
    v_perm_b32 v67, v252, v248, s44
    ds_write_b128 v9, v[64:67] offset:0
    v_perm_b32 v68, v228, v224, s45
    v_perm_b32 v69, v236, v232, s45
    v_perm_b32 v70, v244, v240, s45
    v_perm_b32 v71, v252, v248, s45
    v_xor_b32 v11, 16, v9
    ds_write_b128 v11, v[68:71] offset:128
    v_perm_b32 v72, v229, v225, s44
    v_perm_b32 v73, v237, v233, s44
    v_perm_b32 v74, v245, v241, s44
    v_perm_b32 v75, v253, v249, s44
    v_xor_b32 v10, 32, v9
    ds_write_b128 v10, v[72:75] offset:256
    v_perm_b32 v76, v229, v225, s45
    v_perm_b32 v77, v237, v233, s45
    v_perm_b32 v78, v245, v241, s45
    v_perm_b32 v79, v253, v249, s45
    v_xor_b32 v11, 48, v9
    ds_write_b128 v11, v[76:79] offset:384
    v_perm_b32 v80, v230, v226, s44
    v_perm_b32 v81, v238, v234, s44
    v_perm_b32 v82, v246, v242, s44
    v_perm_b32 v83, v254, v250, s44
    v_xor_b32 v10, 64, v9
    ds_write_b128 v10, v[80:83] offset:512
    v_perm_b32 v84, v230, v226, s45
    v_perm_b32 v85, v238, v234, s45
    v_perm_b32 v86, v246, v242, s45
    v_perm_b32 v87, v254, v250, s45
    v_xor_b32 v11, 80, v9
    ds_write_b128 v11, v[84:87] offset:640
    v_perm_b32 v88, v231, v227, s44
    v_perm_b32 v89, v239, v235, s44
    v_perm_b32 v90, v247, v243, s44
    v_perm_b32 v91, v255, v251, s44
    v_xor_b32 v10, 96, v9
    ds_write_b128 v10, v[88:91] offset:768
    v_perm_b32 v92, v231, v227, s45
    v_perm_b32 v93, v239, v235, s45
    v_perm_b32 v94, v247, v243, s45
    v_perm_b32 v95, v255, v251, s45
    v_xor_b32 v11, 112, v9
    ds_write_b128 v11, v[92:95] offset:896
    s_branch L_ke_x1
L_ke_x1r:
    s_mov_b64 exec, vcc
    buffer_load_dwordx3 v[120:122], v45, s[56:59], s42 offen sc1
    s_mov_b64 exec, -1
L_ke_x1:
    s_add_u32 s53, s53, 1
    s_waitcnt vmcnt(0)
    v_max3_u32 v24, v120, v121, v122
    s_cmp_gt_u32 s53, 40
    v_cmp_eq_u32 vcc, -1, v24
    s_cbranch_scc1 L_ke_x1fb
    s_cbranch_vccnz L_ke_x1r
L_ke_x1done:
    v_add_f32_dpp v120, v120, v120 quad_perm:[1,0,3,2] row_mask:0xf bank_mask:0xf
    v_add_f32_dpp v121, v121, v121 quad_perm:[1,0,3,2] row_mask:0xf bank_mask:0xf
    v_add_f32_dpp v122, v122, v122 quad_perm:[1,0,3,2] row_mask:0xf bank_mask:0xf
    v_add_f32_dpp v120, v120, v120 quad_perm:[2,3,0,1] row_mask:0xf bank_mask:0xf
    v_add_f32_dpp v121, v121, v121 quad_perm:[2,3,0,1] row_mask:0xf bank_mask:0xf
    v_add_f32_dpp v122, v122, v122 quad_perm:[2,3,0,1] row_mask:0xf bank_mask:0xf
    v_add_f32_dpp v120, v120, v120 row_half_mirror row_mask:0xf bank_mask:0xf
    v_add_f32_dpp v121, v121, v121 row_half_mirror row_mask:0xf bank_mask:0xf
    v_add_f32_dpp v122, v122, v122 row_half_mirror row_mask:0xf bank_mask:0xf
    v_mov_b32 v24, 0x3727c5ac
    v_mul_f32 v120, s52, v120
    v_fma_f32 v121, v121, s52, v24
    v_mov_b32 v26, 150016
    v_fma_f32 v121, -v120, v120, v121
    v_mov_b32 v28, v120
    v_rsq_f32 v121, v121
    s_waitcnt lgkmcnt(0)
    v_fma_f32 v122, -v120, v128, v122
    v_mov_b32 v30, v120
    v_fma_f32 v122, v122, v121, v129
    v_mov_b32 v29, v121
    v_cvt_pk_bf16_f32 v24, v122, v122
    v_mov_b32 v31, v121
    v_ashrrev_i32 v25, 31, v24
    v_mov_b32_dpp v28, v120 row_ror:8 row_mask:0xf bank_mask:0xc
    v_or_b32 v25, 0x80000000, v25
    v_mov_b32_dpp v30, v120 row_ror:8 row_mask:0xf bank_mask:0x3
    v_xor_b32 v24, v24, v25
    v_mov_b32_dpp v29, v121 row_ror:8 row_mask:0xf bank_mask:0xc
    v_and_b32 v24, 0xffff0000, v24
    v_mov_b32_dpp v31, v121 row_ror:8 row_mask:0xf bank_mask:0x3
    v_or_b32 v24, v24, v46
    s_mov_b32 exec_lo, 0x01010101
    s_mov_b32 exec_hi, 0x01010101
    ds_max_u32 v26, v24
    s_mov_b64 exec, -1
    v_mov_b32 v32, v24
    v_mov_b32 v33, v24
    v_mov_b32_dpp v32, v24 row_ror:8 row_mask:0xf bank_mask:0xc
    v_mov_b32_dpp v33, v24 row_ror:8 row_mask:0xf bank_mask:0x3
    v_pk_add_f32 v[34:35], v[96:97], v[28:29] op_sel_hi:[1,0] neg_lo:[0,1] neg_hi:[0,1]
    v_pk_add_f32 v[36:37], v[98:99], v[28:29] op_sel_hi:[1,0] neg_lo:[0,1] neg_hi:[0,1]
    v_pk_mul_f32 v[34:35], v[34:35], v[28:29] op_sel:[0,1] op_sel_hi:[1,1]
    v_pk_mul_f32 v[36:37], v[36:37], v[28:29] op_sel:[0,1] op_sel_hi:[1,1]
    v_pk_fma_f32 v[34:35], v[34:35], v[148:149], v[112:113]
    v_pk_fma_f32 v[36:37], v[36:37], v[150:151], v[114:115]
    v_cvt_pk_bf16_f32 v48, v34, v35
    v_cvt_pk_bf16_f32 v49, v36, v37
    v_pk_add_f32 v[34:35], v[100:101], v[28:29] op_sel_hi:[1,0] neg_lo:[0,1] neg_hi:[0,1]
    v_pk_add_f32 v[36:37], v[102:103], v[28:29] op_sel_hi:[1,0] neg_lo:[0,1] neg_hi:[0,1]
    v_pk_mul_f32 v[34:35], v[34:35], v[28:29] op_sel:[0,1] op_sel_hi:[1,1]
    v_pk_mul_f32 v[36:37], v[36:37], v[28:29] op_sel:[0,1] op_sel_hi:[1,1]
    v_pk_fma_f32 v[34:35], v[34:35], v[152:153], v[116:117]
    v_pk_fma_f32 v[36:37], v[36:37], v[154:155], v[118:119]
    v_cvt_pk_bf16_f32 v50, v34, v35
    v_cvt_pk_bf16_f32 v51, v36, v37
    v_pk_add_f32 v[34:35], v[104:105], v[30:31] op_sel_hi:[1,0] neg_lo:[0,1] neg_hi:[0,1]
    v_pk_add_f32 v[36:37], v[106:107], v[30:31] op_sel_hi:[1,0] neg_lo:[0,1] neg_hi:[0,1]
    v_pk_mul_f32 v[34:35], v[34:35], v[30:31] op_sel:[0,1] op_sel_hi:[1,1]
    v_pk_mul_f32 v[36:37], v[36:37], v[30:31] op_sel:[0,1] op_sel_hi:[1,1]
    v_pk_fma_f32 v[34:35], v[34:35], v[148:149], v[112:113]
    v_pk_fma_f32 v[36:37], v[36:37], v[150:151], v[114:115]
    v_cvt_pk_bf16_f32 v52, v34, v35
    v_cvt_pk_bf16_f32 v53, v36, v37
    v_pk_add_f32 v[34:35], v[108:109], v[30:31] op_sel_hi:[1,0] neg_lo:[0,1] neg_hi:[0,1]
    v_pk_add_f32 v[36:37], v[110:111], v[30:31] op_sel_hi:[1,0] neg_lo:[0,1] neg_hi:[0,1]
    v_pk_mul_f32 v[34:35], v[34:35], v[30:31] op_sel:[0,1] op_sel_hi:[1,1]
    v_pk_mul_f32 v[36:37], v[36:37], v[30:31] op_sel:[0,1] op_sel_hi:[1,1]
    v_pk_fma_f32 v[34:35], v[34:35], v[152:153], v[116:117]
    v_pk_fma_f32 v[36:37], v[36:37], v[154:155], v[118:119]
    v_cvt_pk_bf16_f32 v54, v34, v35
    v_cvt_pk_bf16_f32 v55, v36, v37
    s_lshl_b32 s46, s26, 11
    s_add_u32 s46, s46, 262144
    s_lshl_b32 s47, s27, 8
    s_add_u32 s46, s46, s47
    s_lshl_b32 s47, s27, 11
    s_add_u32 s47, s47, 327680
    s_lshl_b32 s48, s26, 2
    s_add_u32 s48, s48, s47
    s_and_b32 s49, s26, 15
    s_lshl_b32 s49, s49, 7
    s_add_u32 s47, s47, s49
    s_waitcnt lgkmcnt(0)
    s_barrier
    ds_read_b32 v38, v26
    v_lshlrev_b32 v34, 16, v48
    v_lshlrev_b32 v36, 16, v49
    v_and_b32 v35, 0xffff0000, v48
    v_and_b32 v37, 0xffff0000, v49
    v_pk_fma_f32 v[34:35], v[34:35], v[140:141], v[96:97]
    v_pk_fma_f32 v[36:37], v[36:37], v[142:143], v[98:99]
    v_cvt_pk_bf16_f32 v56, v34, v35
    v_cvt_pk_bf16_f32 v57, v36, v37
    v_lshlrev_b32 v34, 16, v50
    v_lshlrev_b32 v36, 16, v51
    v_and_b32 v35, 0xffff0000, v50
    v_and_b32 v37, 0xffff0000, v51
    v_pk_fma_f32 v[34:35], v[34:35], v[144:145], v[100:101]
    v_pk_fma_f32 v[36:37], v[36:37], v[146:147], v[102:103]
    v_cvt_pk_bf16_f32 v58, v34, v35
    v_cvt_pk_bf16_f32 v59, v36, v37
    v_add_u32 v24, 151104, v47
    v_lshlrev_b32 v25, 3, v47
    s_waitcnt lgkmcnt(0)
    v_cmp_eq_u32 vcc, v33, v38
    v_cmp_eq_u32 s[50:51], v32, v38
    s_mov_b64 s[54:55], vcc
    v_cndmask_b32 v64, v48, v52, vcc
    v_cndmask_b32 v65, v49, v53, vcc
    v_cndmask_b32 v66, v50, v54, vcc
    v_cndmask_b32 v67, v51, v55, vcc
    v_cndmask_b32 v68, v132, v136, vcc
    v_cndmask_b32 v69, v133, v137, vcc
    v_cndmask_b32 v70, v134, v138, vcc
    v_cndmask_b32 v71, v135, v139, vcc
    s_or_b64 exec, s[50:51], vcc
    s_cbranch_execz L_ke_nocand
    buffer_store_dwordx4 v[64:67], v47, s[56:59], s46 offen sc1
    ds_write_b128 v24, v[68:71]
    ds_write_b128 v24, v[64:67] offset:256
    s_waitcnt lgkmcnt(0)
    buffer_store_dword v38, v25, s[56:59], s48 offen sc1
L_ke_nocand:
    s_mov_b64 exec, -1
    v_lshlrev_b32 v34, 16, v52
    v_lshlrev_b32 v36, 16, v53
    v_and_b32 v35, 0xffff0000, v52
    v_and_b32 v37, 0xffff0000, v53
    v_pk_fma_f32 v[34:35], v[34:35], v[140:141], v[104:105]
    v_pk_fma_f32 v[36:37], v[36:37], v[142:143], v[106:107]
    v_cvt_pk_bf16_f32 v60, v34, v35
    v_cvt_pk_bf16_f32 v61, v36, v37
    v_lshlrev_b32 v34, 16, v54
    v_lshlrev_b32 v36, 16, v55
    v_and_b32 v35, 0xffff0000, v54
    v_and_b32 v37, 0xffff0000, v55
    v_pk_fma_f32 v[34:35], v[34:35], v[144:145], v[108:109]
    v_pk_fma_f32 v[36:37], v[36:37], v[146:147], v[110:111]
    v_cvt_pk_bf16_f32 v62, v34, v35
    v_cvt_pk_bf16_f32 v63, v36, v37
    s_andn2_b64 exec, -1, s[50:51]
    buffer_store_dwordx4 v[56:59], v17, s[20:23], s39 offen sc0 sc1
    s_andn2_b64 exec, -1, s[54:55]
    buffer_store_dwordx4 v[60:63], v17, s[20:23], s40 offen sc0 sc1
    s_mov_b64 exec, -1
    v_and_b32 v8, 31, v2
    v_lshlrev_b32 v8, 2, v8
    s_cmp_ge_u32 s43, 4
    s_cbranch_scc1 L_ke_final
    s_cmp_ge_u32 s2, 224
    s_cbranch_scc1 L_ke_gout
    v_and_b32 v5, 7, v2
    v_lshrrev_b32 v6, 3, v2
    v_lshlrev_b32 v10, 4, v5
    v_add_u32 v10, 151616, v10
    v_mov_b32 v8, 150024
    v_lshlrev_b32 v13, 4, v6
    v_lshrrev_b32 v7, 2, v6
    s_lshl_b32 s37, s30, 1
    v_add_u32 v7, s37, v7
    v_xor_b32 v7, v7, v5
    v_lshlrev_b32 v7, 4, v7
    v_lshl_add_u32 v7, v6, 10, v7
    s_lshl_b32 s37, s30, 13
    s_add_u32 s37, s37, 81920
    v_add_u32 v7, s37, v7
    ds_read_b128 v[160:163], v7 offset:0
    ds_read_b128 v[176:179], v7 offset:32768
    ds_read_b128 v[192:195], v7 offset:512
    ds_read_b128 v[208:211], v7 offset:33280
    ds_read_b128 v[164:167], v7 offset:128
    ds_read_b128 v[180:183], v7 offset:32896
    ds_read_b128 v[196:199], v7 offset:640
    ds_read_b128 v[212:215], v7 offset:33408
    ds_read_b128 v[168:171], v7 offset:256
    ds_read_b128 v[184:187], v7 offset:33024
    ds_read_b128 v[200:203], v7 offset:768
    ds_read_b128 v[216:219], v7 offset:33536
    ds_read_b128 v[172:175], v7 offset:384
    ds_read_b128 v[188:191], v7 offset:33152
    ds_read_b128 v[204:207], v7 offset:896
    ds_read_b128 v[220:223], v7 offset:33664
    v_xor_b32 v7, v5, v6
    v_lshlrev_b32 v7, 4, v7
    v_lshl_add_u32 v7, v2, 7, v7
    s_lshl_b32 s37, s30, 13
    v_add_u32 v7, s37, v7
    ds_read_b128 v[224:227], v7 offset:0
    v_xor_b32 v15, 16, v7
    ds_read_b128 v[228:231], v15 offset:0
    v_xor_b32 v14, 32, v7
    ds_read_b128 v[232:235], v14 offset:0
    v_xor_b32 v15, 48, v7
    ds_read_b128 v[236:239], v15 offset:0
    v_xor_b32 v14, 64, v7
    ds_read_b128 v[240:243], v14 offset:0
    v_xor_b32 v15, 80, v7
    ds_read_b128 v[244:247], v15 offset:0
    v_xor_b32 v14, 96, v7
    ds_read_b128 v[248:251], v14 offset:0
    v_xor_b32 v15, 112, v7
    ds_read_b128 v[252:255], v15 offset:0
    v_lshlrev_b32 v11, 3, v2
    v_lshlrev_b32 v12, 2, v2
    s_lshl_b32 s45, s28, 11
    s_add_u32 s45, s45, 344064
    s_lshl_b32 s46, s29, 2
    s_add_u32 s46, s46, s30
    s_lshl_b32 s46, s46, 7
    s_add_u32 s46, s46, s45
    s_mul_i32 s49, s29, 57344
    s_lshl_b32 s37, s28, 10
    s_add_u32 s49, s49, s37
    s_lshl_b32 s37, s30, 8
    s_add_u32 s49, s49, s37
    s_add_u32 s49, s49, 458752
    s_mov_b32 s52, 0xbfb8aa3b
    v_mov_b32 v80, 0
    v_mov_b32 v81, 0
    v_mov_b32 v82, 0
    v_mov_b32 v83, 0
    s_mov_b32 s53, 0
L_ke_hp:
    ds_read_b32 v9, v8
    ds_read_b128 v[64:67], v10 offset:0
    ds_read_b128 v[68:71], v10 offset:128
    ds_read_b128 v[72:75], v10 offset:256
    ds_read_b128 v[76:79], v10 offset:384
    s_add_u32 s53, s53, 1
    s_waitcnt lgkmcnt(0)
    s_cmp_gt_u32 s53, 1048576
    v_cmp_eq_u32 vcc, 0, v9
    s_cbranch_scc1 L_ke_hpd
    s_cbranch_vccnz L_ke_hp
L_ke_hpd:
    v_dot2c_f32_bf16 v80, v160, v64
    v_dot2c_f32_bf16 v81, v176, v64
    v_dot2c_f32_bf16 v82, v192, v64
    v_dot2c_f32_bf16 v83, v208, v64
    v_dot2c_f32_bf16 v80, v161, v65
    v_dot2c_f32_bf16 v81, v177, v65
    v_dot2c_f32_bf16 v82, v193, v65
    v_dot2c_f32_bf16 v83, v209, v65
    v_dot2c_f32_bf16 v80, v162, v66
    v_dot2c_f32_bf16 v81, v178, v66
    v_dot2c_f32_bf16 v82, v194, v66
    v_dot2c_f32_bf16 v83, v210, v66
    v_dot2c_f32_bf16 v80, v163, v67
    v_dot2c_f32_bf16 v81, v179, v67
    v_dot2c_f32_bf16 v82, v195, v67
    v_dot2c_f32_bf16 v83, v211, v67
    v_dot2c_f32_bf16 v80, v164, v68
    v_dot2c_f32_bf16 v81, v180, v68
    v_dot2c_f32_bf16 v82, v196, v68
    v_dot2c_f32_bf16 v83, v212, v68
    v_dot2c_f32_bf16 v80, v165, v69
    v_dot2c_f32_bf16 v81, v181, v69
    v_dot2c_f32_bf16 v82, v197, v69
    v_dot2c_f32_bf16 v83, v213, v69
    v_dot2c_f32_bf16 v80, v166, v70
    v_dot2c_f32_bf16 v81, v182, v70
    v_dot2c_f32_bf16 v82, v198, v70
    v_dot2c_f32_bf16 v83, v214, v70
    v_dot2c_f32_bf16 v80, v167, v71
    v_dot2c_f32_bf16 v81, v183, v71
    v_dot2c_f32_bf16 v82, v199, v71
    v_dot2c_f32_bf16 v83, v215, v71
    v_dot2c_f32_bf16 v80, v168, v72
    v_dot2c_f32_bf16 v81, v184, v72
    v_dot2c_f32_bf16 v82, v200, v72
    v_dot2c_f32_bf16 v83, v216, v72
    v_dot2c_f32_bf16 v80, v169, v73
    v_dot2c_f32_bf16 v81, v185, v73
    v_dot2c_f32_bf16 v82, v201, v73
    v_dot2c_f32_bf16 v83, v217, v73
    v_dot2c_f32_bf16 v80, v170, v74
    v_dot2c_f32_bf16 v81, v186, v74
    v_dot2c_f32_bf16 v82, v202, v74
    v_dot2c_f32_bf16 v83, v218, v74
    v_dot2c_f32_bf16 v80, v171, v75
    v_dot2c_f32_bf16 v81, v187, v75
    v_dot2c_f32_bf16 v82, v203, v75
    v_dot2c_f32_bf16 v83, v219, v75
    v_dot2c_f32_bf16 v80, v172, v76
    v_dot2c_f32_bf16 v81, v188, v76
    v_dot2c_f32_bf16 v82, v204, v76
    v_dot2c_f32_bf16 v83, v220, v76
    v_dot2c_f32_bf16 v80, v173, v77
    v_dot2c_f32_bf16 v81, v189, v77
    v_dot2c_f32_bf16 v82, v205, v77
    v_dot2c_f32_bf16 v83, v221, v77
    v_dot2c_f32_bf16 v80, v174, v78
    v_dot2c_f32_bf16 v81, v190, v78
    v_dot2c_f32_bf16 v82, v206, v78
    v_dot2c_f32_bf16 v83, v222, v78
    v_dot2c_f32_bf16 v80, v175, v79
    v_dot2c_f32_bf16 v81, v191, v79
    v_dot2c_f32_bf16 v82, v207, v79
    v_dot2c_f32_bf16 v83, v223, v79
    s_nop 1
    v_add_f32_dpp v80, v80, v80 quad_perm:[1,0,3,2] row_mask:0xf bank_mask:0xf
    v_add_f32_dpp v81, v81, v81 quad_perm:[1,0,3,2] row_mask:0xf bank_mask:0xf
    v_add_f32_dpp v82, v82, v82 quad_perm:[1,0,3,2] row_mask:0xf bank_mask:0xf
    v_add_f32_dpp v83, v83, v83 quad_perm:[1,0,3,2] row_mask:0xf bank_mask:0xf
    v_add_f32_dpp v80, v80, v80 quad_perm:[2,3,0,1] row_mask:0xf bank_mask:0xf
    v_add_f32_dpp v81, v81, v81 quad_perm:[2,3,0,1] row_mask:0xf bank_mask:0xf
    v_add_f32_dpp v82, v82, v82 quad_perm:[2,3,0,1] row_mask:0xf bank_mask:0xf
    v_add_f32_dpp v83, v83, v83 quad_perm:[2,3,0,1] row_mask:0xf bank_mask:0xf
    v_add_f32_dpp v80, v80, v80 row_half_mirror row_mask:0xf bank_mask:0xf
    v_add_f32_dpp v81, v81, v81 row_half_mirror row_mask:0xf bank_mask:0xf
    v_add_f32_dpp v82, v82, v82 row_half_mirror row_mask:0xf bank_mask:0xf
    v_add_f32_dpp v83, v83, v83 row_half_mirror row_mask:0xf bank_mask:0xf
    s_mov_b32 exec_lo, 0x01010101
    s_mov_b32 exec_hi, 0x01010101
    buffer_store_dwordx4 v[80:83], v13, s[56:59], s46 offen
    s_add_u32 s46, s46, 606208
    buffer_store_dwordx4 v[80:83], v13, s[56:59], s46 offen sc1
    s_mov_b64 exec, -1
    s_mov_b32 s53, 0
    buffer_load_dwordx2 v[64:65], v11, s[56:59], s45 offen offset:0 sc1
    buffer_load_dwordx2 v[66:67], v11, s[56:59], s45 offen offset:512 sc1
    buffer_load_dwordx2 v[68:69], v11, s[56:59], s45 offen offset:1024 sc1
    buffer_load_dwordx2 v[70:71], v11, s[56:59], s45 offen offset:1536 sc1
    v_mov_b32 v84, 0
    v_mov_b32 v85, 0
    v_mov_b32 v86, 0
    v_mov_b32 v87, 0
    s_branch L_ke_x3
L_ke_x3r:
    s_mov_b64 exec, s[64:65]
    buffer_load_dwordx2 v[64:65], v11, s[56:59], s45 offen offset:0 sc1
    s_mov_b64 exec, s[66:67]
    buffer_load_dwordx2 v[66:67], v11, s[56:59], s45 offen offset:512 sc1
    s_mov_b64 exec, s[68:69]
    buffer_load_dwordx2 v[68:69], v11, s[56:59], s45 offen offset:1024 sc1
    s_mov_b64 exec, s[70:71]
    buffer_load_dwordx2 v[70:71], v11, s[56:59], s45 offen offset:1536 sc1
    s_mov_b64 exec, -1
L_ke_x3:
    s_add_u32 s53, s53, 1
    s_waitcnt vmcnt(0)
    v_max_u32 v24, v64, v65
    v_max_u32 v25, v66, v67
    v_max_u32 v26, v68, v69
    v_max_u32 v27, v70, v71
    v_cmp_eq_u32 s[64:65], -1, v24
    v_cmp_eq_u32 s[66:67], -1, v25
    v_cmp_eq_u32 s[68:69], -1, v26
    v_cmp_eq_u32 s[70:71], -1, v27
    v_pk_add_f32 v[28:29], v[64:65], v[66:67]
    v_pk_add_f32 v[30:31], v[68:69], v[70:71]
    s_cmp_gt_u32 s53, 40
    s_cbranch_scc1 L_ke_x3fb
    s_or_b64 s[72:73], s[64:65], s[66:67]
    s_or_b64 s[74:75], s[68:69], s[70:71]
    s_or_b64 s[72:73], s[72:73], s[74:75]
    s_cbranch_scc1 L_ke_x3r
L_ke_x3d:
    v_pk_add_f32 v[28:29], v[28:29], v[30:31]
    v_cvt_pk_bf16_f32 v28, v28, v29
    v_lshlrev_b32 v29, 16, v28
    v_and_b32 v28, 0xffff0000, v28
    v_mul_f32 v30, s52, v29
    v_exp_f32 v30, v30
    s_nop 0
    v_add_f32 v30, 1.0, v30
    v_rcp_f32 v30, v30
    s_nop 0
    v_mul_f32 v29, v29, v30
    v_cvt_pk_bf16_f32 v29, v29, v29
    v_lshlrev_b32 v29, 16, v29
    v_mul_f32 v28, v28, v29
    s_nop 1
    v_mov_b32_dpp v29, v28 quad_perm:[1,0,3,2] row_mask:0xf bank_mask:0xf
    s_nop 0
    v_cvt_pk_bf16_f32 v28, v28, v29
    s_nop 0
    v_readlane_b32 s64, v28, 0
    v_readlane_b32 s65, v28, 2
    v_readlane_b32 s66, v28, 4
    v_readlane_b32 s67, v28, 6
    v_readlane_b32 s68, v28, 8
    v_dot2c_f32_bf16 v84, s64, v224
    v_readlane_b32 s69, v28, 10
    v_dot2c_f32_bf16 v85, s65, v225
    v_readlane_b32 s70, v28, 12
    v_dot2c_f32_bf16 v86, s66, v226
    v_readlane_b32 s71, v28, 14
    v_dot2c_f32_bf16 v87, s67, v227
    v_readlane_b32 s72, v28, 16
    v_dot2c_f32_bf16 v84, s68, v228
    v_readlane_b32 s73, v28, 18
    v_dot2c_f32_bf16 v85, s69, v229
    v_readlane_b32 s74, v28, 20
    v_dot2c_f32_bf16 v86, s70, v230
    v_readlane_b32 s75, v28, 22
    v_dot2c_f32_bf16 v87, s71, v231
    v_readlane_b32 s76, v28, 24
    v_dot2c_f32_bf16 v84, s72, v232
    v_readlane_b32 s77, v28, 26
    v_dot2c_f32_bf16 v85, s73, v233
    v_readlane_b32 s78, v28, 28
    v_dot2c_f32_bf16 v86, s74, v234
    v_readlane_b32 s79, v28, 30
    v_dot2c_f32_bf16 v87, s75, v235
    v_readlane_b32 s4, v28, 32
    v_dot2c_f32_bf16 v84, s76, v236
    v_readlane_b32 s5, v28, 34
    v_dot2c_f32_bf16 v85, s77, v237
    v_readlane_b32 s6, v28, 36
    v_dot2c_f32_bf16 v86, s78, v238
    v_readlane_b32 s7, v28, 38
    v_dot2c_f32_bf16 v87, s79, v239
    v_readlane_b32 s10, v28, 40
    v_dot2c_f32_bf16 v84, s4, v240
    v_readlane_b32 s11, v28, 42
    v_dot2c_f32_bf16 v85, s5, v241
    v_readlane_b32 s12, v28, 44
    v_dot2c_f32_bf16 v86, s6, v242
    v_readlane_b32 s13, v28, 46
    v_dot2c_f32_bf16 v87, s7, v243
    v_readlane_b32 s14, v28, 48
    v_dot2c_f32_bf16 v84, s10, v244
    v_readlane_b32 s15, v28, 50
    v_dot2c_f32_bf16 v85, s11, v245
    v_readlane_b32 s16, v28, 52
    v_dot2c_f32_bf16 v86, s12, v246
    v_readlane_b32 s17, v28, 54
    v_dot2c_f32_bf16 v87, s13, v247
    v_readlane_b32 s18, v28, 56
    v_dot2c_f32_bf16 v84, s14, v248
    v_readlane_b32 s19, v28, 58
    v_dot2c_f32_bf16 v85, s15, v249
    v_readlane_b32 s44, v28, 60
    v_dot2c_f32_bf16 v86, s16, v250
    v_readlane_b32 s45, v28, 62
    v_dot2c_f32_bf16 v87, s17, v251
    v_dot2c_f32_bf16 v84, s18, v252
    v_dot2c_f32_bf16 v85, s19, v253
    v_dot2c_f32_bf16 v86, s44, v254
    v_dot2c_f32_bf16 v87, s45, v255
    s_nop 1
    v_add_f32 v84, v84, v85
    v_add_f32 v86, v86, v87
    s_nop 0
    v_add_f32 v84, v84, v86
    buffer_store_dword v84, v12, s[56:59], s49 offen sc1
L_ke_gout:
    s_branch L_ke_end
L_ke_final:
    s_cmp_eq_u32 s43, 4
    s_cbranch_scc1 L_ke_w4
    v_lshlrev_b32 v6, 2, v2
    v_lshlrev_b32 v7, 3, v2
    v_add_u32 v5, 148992, v7
    ds_read_b64 v[12:13], v5
    v_add_u32 v4, 151104, v6
    v_add_u32 v5, 150080, v7
    v_mov_b32 v14, 0
    v_mov_b32 v15, 0
    v_readfirstlane_b32 s46, v38
    s_lshr_b32 s44, s27, 1
    s_mul_i32 s44, s44, 57344
    s_mul_i32 s45, s30, 14336
    s_add_u32 s44, s44, s45
    s_and_b32 s45, s27, 1
    s_lshl_b32 s45, s45, 9
    s_add_u32 s44, s44, s45
    s_add_u32 s64, s44, 458752
    s_add_u32 s65, s64, 4096
    s_add_u32 s66, s64, 8192
    s_add_u32 s67, s64, 12288
    s_and_b32 s46, s46, 0x7ff
    s_sub_u32 s46, 2047, s46
    s_lshl_b32 s46, s46, 11
    s_lshl_b32 s45, s27, 8
    s_add_u32 s46, s46, s45
    s_mov_b32 s52, 0xbfb8aa3b
    v_mov_b32 v8, 150024
    s_mov_b32 s53, 0
L_ke_ws:
    ds_read_b32 v9, v8
    s_add_u32 s53, s53, 1
    s_waitcnt lgkmcnt(0)
    s_cmp_gt_u32 s53, 1048576
    v_cmp_eq_u32 vcc, 0, v9
    s_cbranch_scc1 L_ke_wsd
    s_cbranch_vccnz L_ke_ws
L_ke_wsd:
    v_readfirstlane_b32 s62, v9
    s_nop 3
    s_and_b32 s63, s62, 0x7ff
    s_sub_u32 s63, 2047, s63
    s_lshr_b32 s63, s63, 6
    s_branch L_ke_known
L_ke_w4:
    buffer_load_dword v9, v8, s[56:59], s47 offen sc1
    v_lshlrev_b32 v6, 2, v2
    v_lshlrev_b32 v7, 3, v2
    v_add_u32 v5, 148992, v7
    ds_read_b64 v[12:13], v5
    v_add_u32 v4, 151104, v6
    v_add_u32 v5, 150080, v7
    v_mov_b32 v14, 0
    v_mov_b32 v15, 0
    v_readfirstlane_b32 s46, v38
    s_lshr_b32 s44, s27, 1
    s_mul_i32 s44, s44, 57344
    s_mul_i32 s45, s30, 14336
    s_add_u32 s44, s44, s45
    s_and_b32 s45, s27, 1
    s_lshl_b32 s45, s45, 9
    s_add_u32 s44, s44, s45
    s_add_u32 s64, s44, 458752
    s_add_u32 s65, s64, 4096
    s_add_u32 s66, s64, 8192
    s_add_u32 s67, s64, 12288
    s_and_b32 s46, s46, 0x7ff
    s_sub_u32 s46, 2047, s46
    s_lshl_b32 s46, s46, 11
    s_lshl_b32 s45, s27, 8
    s_add_u32 s46, s46, s45
    s_mov_b32 s52, 0xbfb8aa3b
    s_lshl_b32 s68, s29, 9
    s_add_u32 s68, s68, 262144
    v_add_u32 v16, 151616, v7
    v_mov_b32 v3, 150024
    s_mov_b32 s53, 0
L_ke_kp2:
    buffer_load_dword v9, v8, s[56:59], s47 offen sc1
    s_add_u32 s53, s53, 1
    s_waitcnt vmcnt(1)
    s_cmp_gt_u32 s53, 131072
    v_cmp_eq_u32 vcc, -1, v9
    s_cbranch_scc1 L_ke_kp2d
    s_cbranch_vccnz L_ke_kp2
L_ke_kp2d:
    v_max_u32_dpp v24, v9, v9 quad_perm:[1,0,3,2] row_mask:0xf bank_mask:0xf
    s_nop 1
    v_max_u32_dpp v24, v24, v24 quad_perm:[2,3,0,1] row_mask:0xf bank_mask:0xf
    s_nop 1
    v_max_u32_dpp v24, v24, v24 row_half_mirror row_mask:0xf bank_mask:0xf
    s_nop 1
    v_max_u32_dpp v24, v24, v24 row_mirror row_mask:0xf bank_mask:0xf
    s_nop 1
    v_readlane_b32 s62, v24, 0
    v_readlane_b32 s63, v24, 16
    s_nop 1
    s_max_u32 s62, s62, s63
    s_and_b32 s63, s62, 0x7ff
    s_sub_u32 s63, 2047, s63
    s_lshr_b32 s63, s63, 6
    s_lshl_b32 s69, s63, 11
    s_add_u32 s68, s68, s69
    s_or_b32 s69, s62, 0x8000
    s_cmp_ge_u32 s2, 224
    s_cbranch_scc1 L_ke_h2d
    buffer_load_dwordx2 v[24:25], v7, s[56:59], s68 offen
    s_mov_b32 s53, 0
    s_branch L_ke_h2
L_ke_h2r:
    buffer_load_dwordx2 v[24:25], v7, s[56:59], s68 offen sc1
L_ke_h2:
    s_add_u32 s53, s53, 1
    s_waitcnt vmcnt(0)
    v_max_u32 v26, v24, v25
    s_cmp_gt_u32 s53, 131072
    v_cmp_eq_u32 vcc, -1, v26
    s_cbranch_scc1 L_ke_h2w
    s_cbranch_vccnz L_ke_h2r
L_ke_h2w:
    ds_write_b64 v16, v[24:25]
L_ke_h2d:
    v_mov_b32 v27, s69
    ds_write_b32 v3, v27
L_ke_known:
    ds_read_b32 v10, v4
    ds_read_b32 v11, v4 offset:256
    s_cmp_eq_u32 s63, s26
    s_cbranch_scc1 L_ke_win
    s_cmp_eq_u32 s43, 4
    s_cbranch_scc1 L_ke_fin2
    s_branch L_ke_end
L_ke_win:
    buffer_load_dwordx2 v[64:65], v7, s[56:59], s64 offen offset:0 sc1
    buffer_load_dwordx2 v[66:67], v7, s[56:59], s64 offen offset:1024 sc1
    buffer_load_dwordx2 v[68:69], v7, s[56:59], s64 offen offset:2048 sc1
    buffer_load_dwordx2 v[70:71], v7, s[56:59], s64 offen offset:3072 sc1
    buffer_load_dwordx2 v[72:73], v7, s[56:59], s65 offen offset:0 sc1
    buffer_load_dwordx2 v[74:75], v7, s[56:59], s65 offen offset:1024 sc1
    buffer_load_dwordx2 v[76:77], v7, s[56:59], s65 offen offset:2048 sc1
    buffer_load_dwordx2 v[78:79], v7, s[56:59], s65 offen offset:3072 sc1
    buffer_load_dwordx2 v[80:81], v7, s[56:59], s66 offen offset:0 sc1
    buffer_load_dwordx2 v[82:83], v7, s[56:59], s66 offen offset:1024 sc1
    buffer_load_dwordx2 v[84:85], v7, s[56:59], s66 offen offset:2048 sc1
    buffer_load_dwordx2 v[86:87], v7, s[56:59], s66 offen offset:3072 sc1
    buffer_load_dwordx2 v[88:89], v7, s[56:59], s67 offen offset:0 sc1
    buffer_load_dwordx2 v[90:91], v7, s[56:59], s67 offen offset:1024 sc1
    s_mov_b32 s53, 0
L_ke_x4:
    buffer_load_dwordx2 v[64:65], v7, s[56:59], s64 offen offset:0 sc1
    buffer_load_dwordx2 v[66:67], v7, s[56:59], s64 offen offset:1024 sc1
    buffer_load_dwordx2 v[68:69], v7, s[56:59], s64 offen offset:2048 sc1
    buffer_load_dwordx2 v[70:71], v7, s[56:59], s64 offen offset:3072 sc1
    buffer_load_dwordx2 v[72:73], v7, s[56:59], s65 offen offset:0 sc1
    buffer_load_dwordx2 v[74:75], v7, s[56:59], s65 offen offset:1024 sc1
    buffer_load_dwordx2 v[76:77], v7, s[56:59], s65 offen offset:2048 sc1
    buffer_load_dwordx2 v[78:79], v7, s[56:59], s65 offen offset:3072 sc1
    buffer_load_dwordx2 v[80:81], v7, s[56:59], s66 offen offset:0 sc1
    buffer_load_dwordx2 v[82:83], v7, s[56:59], s66 offen offset:1024 sc1
    buffer_load_dwordx2 v[84:85], v7, s[56:59], s66 offen offset:2048 sc1
    buffer_load_dwordx2 v[86:87], v7, s[56:59], s66 offen offset:3072 sc1
    buffer_load_dwordx2 v[88:89], v7, s[56:59], s67 offen offset:0 sc1
    buffer_load_dwordx2 v[90:91], v7, s[56:59], s67 offen offset:1024 sc1
    s_add_u32 s53, s53, 1
    s_waitcnt vmcnt(14)
    v_max3_u32 v24, v64, v65, v66
    v_max3_u32 v25, v67, v68, v69
    v_max3_u32 v24, v24, v70, v71
    v_max3_u32 v25, v25, v72, v73
    v_max3_u32 v24, v24, v74, v75
    v_max3_u32 v25, v25, v76, v77
    v_max3_u32 v24, v24, v78, v79
    v_max3_u32 v25, v25, v80, v81
    v_max3_u32 v24, v24, v82, v83
    v_max3_u32 v25, v25, v84, v85
    v_max3_u32 v24, v24, v86, v87
    v_max3_u32 v25, v25, v88, v89
    v_max3_u32 v24, v24, v90, v91
    s_cmp_gt_u32 s53, 131072
    v_max_u32 v24, v24, v25
    s_cbranch_scc1 L_ke_x4d
    v_cmp_eq_u32 vcc, -1, v24
    s_cbranch_vccnz L_ke_x4
L_ke_x4d:
    v_pk_add_f32 v[28:29], v[64:65], v[66:67]
    v_pk_add_f32 v[30:31], v[68:69], v[70:71]
    v_pk_add_f32 v[28:29], v[28:29], v[72:73]
    v_pk_add_f32 v[30:31], v[30:31], v[74:75]
    v_pk_add_f32 v[28:29], v[28:29], v[76:77]
    v_pk_add_f32 v[30:31], v[30:31], v[78:79]
    v_pk_add_f32 v[28:29], v[28:29], v[80:81]
    v_pk_add_f32 v[30:31], v[30:31], v[82:83]
    v_pk_add_f32 v[28:29], v[28:29], v[84:85]
    v_pk_add_f32 v[30:31], v[30:31], v[86:87]
    v_pk_add_f32 v[28:29], v[28:29], v[88:89]
    v_pk_add_f32 v[30:31], v[30:31], v[90:91]
    v_pk_add_f32 v[28:29], v[28:29], v[30:31]
    v_mov_b32 v24, 150020
    v_mov_b32 v25, 1
    ds_add_f32 v5, v28
    ds_add_f32 v5, v29 offset:4
    s_mov_b64 exec, 1
    ds_add_rtn_u32 v25, v24, v25
    s_mov_b64 exec, -1
    ds_read_b64 v[14:15], v5
    s_waitcnt lgkmcnt(0)
    v_readfirstlane_b32 s44, v25
    s_nop 3
    s_cmp_lg_u32 s44, 3
    s_cbranch_scc1 L_ke_end
L_ke_fin2:
    s_and_b32 s62, s62, 0xffff0000
    s_cmp_lt_i32 s62, 0
    s_mov_b32 s45, 0xffff0000
    s_cselect_b32 s44, 0x80000000, s45
    s_xor_b32 s62, s62, s44
    v_mov_b32 v31, s62
    v_mul_f32 v32, s52, v31
    v_exp_f32 v32, v32
    v_cvt_pk_bf16_f32 v24, v14, v15
    v_add_f32 v32, 1.0, v32
    v_rcp_f32 v32, v32
    v_and_b32 v25, 0xffff0000, v24
    v_lshlrev_b32 v24, 16, v24
    v_cvt_pk_bf16_f32 v32, v32, v32
    v_lshlrev_b32 v32, 16, v32
    s_waitcnt lgkmcnt(0)
    v_lshlrev_b32 v26, 16, v10
    v_and_b32 v27, 0xffff0000, v10
    v_lshlrev_b32 v28, 16, v11
    v_and_b32 v29, 0xffff0000, v11
    v_mul_f32 v24, v24, v32
    v_mul_f32 v25, v25, v32
    v_cvt_pk_bf16_f32 v24, v24, v25
    v_and_b32 v25, 0xffff0000, v24
    v_lshlrev_b32 v24, 16, v24
    v_add_f32 v24, v24, v28
    v_add_f32 v25, v25, v29
    v_cvt_pk_bf16_f32 v24, v24, v25
    v_and_b32 v25, 0xffff0000, v24
    v_lshlrev_b32 v24, 16, v24
    v_fma_f32 v24, v24, v12, v26
    v_fma_f32 v25, v25, v13, v27
    v_cvt_pk_bf16_f32 v24, v24, v25
    buffer_store_dword v24, v6, s[20:23], s46 offen
L_ke_end:
L_ke_done:
    s_endpgm
L_ke_x1fb:
    s_add_u32 s42, s42, 688128
    s_branch L_ke_x1b
L_ke_x1br:
    s_mov_b64 exec, vcc
    buffer_load_dwordx3 v[120:122], v45, s[56:59], s42 offen sc1
    s_mov_b64 exec, -1
L_ke_x1b:
    s_add_u32 s53, s53, 1
    s_waitcnt vmcnt(0)
    v_max3_u32 v24, v120, v121, v122
    s_cmp_gt_u32 s53, 131072
    v_cmp_eq_u32 vcc, -1, v24
    s_cbranch_scc1 L_ke_x1done
    s_cbranch_vccnz L_ke_x1br
    s_branch L_ke_x1done
L_ke_x3fb:
    s_add_u32 s45, s45, 606208
    s_branch L_ke_x3b
L_ke_x3br:
    s_mov_b64 exec, s[64:65]
    buffer_load_dwordx2 v[64:65], v11, s[56:59], s45 offen offset:0 sc1
    s_mov_b64 exec, s[66:67]
    buffer_load_dwordx2 v[66:67], v11, s[56:59], s45 offen offset:512 sc1
    s_mov_b64 exec, s[68:69]
    buffer_load_dwordx2 v[68:69], v11, s[56:59], s45 offen offset:1024 sc1
    s_mov_b64 exec, s[70:71]
    buffer_load_dwordx2 v[70:71], v11, s[56:59], s45 offen offset:1536 sc1
    s_mov_b64 exec, -1
L_ke_x3b:
    s_add_u32 s53, s53, 1
    s_waitcnt vmcnt(0)
    v_max_u32 v24, v64, v65
    v_max_u32 v25, v66, v67
    v_max_u32 v26, v68, v69
    v_max_u32 v27, v70, v71
    v_cmp_eq_u32 s[64:65], -1, v24
    v_cmp_eq_u32 s[66:67], -1, v25
    v_cmp_eq_u32 s[68:69], -1, v26
    v_cmp_eq_u32 s[70:71], -1, v27
    v_pk_add_f32 v[28:29], v[64:65], v[66:67]
    v_pk_add_f32 v[30:31], v[68:69], v[70:71]
    s_cmp_gt_u32 s53, 131072
    s_cbranch_scc1 L_ke_x3d
    s_or_b64 s[72:73], s[64:65], s[66:67]
    s_or_b64 s[74:75], s[68:69], s[70:71]
    s_or_b64 s[72:73], s[72:73], s[74:75]
    s_cbranch_scc1 L_ke_x3br
    s_branch L_ke_x3d
L_text_end:
.section .rodata,"a"
.p2align 6
.amdhsa_kernel ka_mod_kernel
  .amdhsa_next_free_vgpr 176
  .amdhsa_next_free_sgpr 102
  .amdhsa_accum_offset 176
  .amdhsa_group_segment_fixed_size 0
  .amdhsa_kernarg_size 104
  .amdhsa_user_sgpr_count 2
  .amdhsa_user_sgpr_kernarg_segment_ptr 1
  .amdhsa_system_sgpr_workgroup_id_x 1
.end_amdhsa_kernel
.p2align 6
.amdhsa_kernel kb_qkv_kernel
  .amdhsa_next_free_vgpr 208
  .amdhsa_next_free_sgpr 102
  .amdhsa_accum_offset 208
  .amdhsa_group_segment_fixed_size 0
  .amdhsa_kernarg_size 104
  .amdhsa_user_sgpr_count 2
  .amdhsa_user_sgpr_kernarg_segment_ptr 1
  .amdhsa_system_sgpr_workgroup_id_x 1
.end_amdhsa_kernel
.p2align 6
.amdhsa_kernel kc_attn_kernel
  .amdhsa_next_free_vgpr 216
  .amdhsa_next_free_sgpr 102
  .amdhsa_accum_offset 216
  .amdhsa_group_segment_fixed_size 0
  .amdhsa_kernarg_size 104
  .amdhsa_user_sgpr_count 2
  .amdhsa_user_sgpr_kernarg_segment_ptr 1
  .amdhsa_system_sgpr_workgroup_id_x 1
.end_amdhsa_kernel
.p2align 6
.amdhsa_kernel ke_tail_kernel
  .amdhsa_next_free_vgpr 256
  .amdhsa_next_free_sgpr 102
  .amdhsa_accum_offset 256
  .amdhsa_group_segment_fixed_size 0
  .amdhsa_kernarg_size 104
  .amdhsa_user_sgpr_count 2
  .amdhsa_user_sgpr_kernarg_segment_ptr 1
  .amdhsa_system_sgpr_workgroup_id_x 1
.end_amdhsa_kernel
```
